```python
import torch

def _softmax(x, axis=-1):
    return torch.softmax(x, dim=axis)
def _gelu(x):
    return torch.nn.functional.gelu(x, approximate="tanh")
def _silu(x):
    return torch.nn.functional.silu(x)
def _sigmoid(x):
    return torch.sigmoid(x)
def _layernorm(x, axis=-1, eps=1e-5):
    m = x.mean(dim=axis, keepdim=True)
    v = x.var(dim=axis, keepdim=True, unbiased=False)
    return (x - m) / torch.sqrt(v + eps)
def _scatter_add(tgt, idx, src, axis=0):
    return tgt.clone().index_add_(axis, idx, src)
def _segment_sum(src, seg, n):
    out = torch.zeros((n,) + src.shape[1:], dtype=src.dtype)
    return out.index_add_(0, seg, src)
def _pad(x, pw):
    flat = tuple(v for pair in reversed(pw) for v in pair)
    return torch.nn.functional.pad(x, flat)

kernel_name = 'interleave_layers__softmax_full_mha__glu_gated_swiglu__prompt'

def setup_inputs():

    _w = (lambda a: (lambda t: t.to(torch.bfloat16) if t.is_floating_point() else t)(torch.as_tensor(a)))
    def _A_setup():
        B, S, D = 1, 2048, 576
        return {
            "x": _w((lambda *s: torch.randn(*s, dtype=torch.bfloat16) * 0.05)(B, S, D)),
            "wqkv": _w((lambda *s: torch.randn(*s, dtype=torch.bfloat16) * 0.05)(D, 3 * D)),
            "wo": _w((lambda *s: torch.randn(*s, dtype=torch.bfloat16) * 0.05)(D, D)),
        }
    _A_in = _A_setup()

    def _B_setup():
        B, S, D, F = 1, 2048, 576, 4608
        return {
            "x": _w((lambda *s: torch.randn(*s, dtype=torch.bfloat16) * 0.05)(B, S, D)),
            "w1": _w((lambda *s: torch.randn(*s, dtype=torch.bfloat16) * 0.4)(D, F) * (2.0 / D) ** 0.5),
            "w3": _w((lambda *s: torch.randn(*s, dtype=torch.bfloat16) * 0.4)(D, F) * (2.0 / D) ** 0.5),
            "w2": _w((lambda *s: torch.randn(*s, dtype=torch.bfloat16) * 0.4)(F, D) * (2.0 / F) ** 0.5),
        }
    _B_in = _B_setup()

    return {
        "A_x": _A_in["x"],
        "A_wqkv": _A_in["wqkv"],
        "A_wo": _A_in["wo"],
        "B_x": _B_in["x"],
        "B_w1": _B_in["w1"],
        "B_w3": _B_in["w3"],
        "B_w2": _B_in["w2"],
    }

def reference(A_x, A_wqkv, A_wo, B_x, B_w1, B_w3, B_w2):
    def _A_ref(x, wqkv, wo):
        B, S, D = x.shape
        H = 32; Dh = D // H
        qkv = (lambda x, *d: x.permute(*d))((x @ wqkv).reshape(B, S, 3, H, Dh), 2, 0, 3, 1, 4)
        q, k, v = qkv[0], qkv[1], qkv[2]
        scale = Dh ** -0.5
        scores = torch.einsum("bhqd,bhkd->bhqk", q, k) * scale
        p = _softmax(scores, axis=-1)
        o = torch.einsum("bhqk,bhkd->bhqd", p, v)
        return (lambda x, *d: x.permute(*d))(o, 0, 2, 1, 3).reshape(B, S, D) @ wo

    def _B_ref(x, w1, w3, w2):
        gate = torch.einsum("bsd,df->bsf", x, w1)
        up = torch.einsum("bsd,df->bsf", x, w3)
        h = _silu(gate) * up
        out = torch.einsum("bsf,fd->bsd", h, w2)
        return out

    x = A_x
    x = x + _A_ref(_layernorm(x, axis=-1), A_wqkv, A_wo)
    x = x + _B_ref(_layernorm(x, axis=-1), B_w1, B_w3, B_w2)
    x = x + _A_ref(_layernorm(x, axis=-1), A_wqkv, A_wo)
    x = x + _B_ref(_layernorm(x, axis=-1), B_w1, B_w3, B_w2)
    return x
```

```asm
; @launch grid=(256,1,1) block=(512,1,1) lds=149504
.amdgcn_target "amdgcn-amd-amdhsa--gfx950"
.text
.globl interleave_layers__softmax_full_mha__glu_gated_swiglu__prompt_kernel
.p2align 8
.type interleave_layers__softmax_full_mha__glu_gated_swiglu__prompt_kernel,@function
interleave_layers__softmax_full_mha__glu_gated_swiglu__prompt_kernel:
    s_cmp_ge_u32 s2, 256
    s_cbranch_scc1 Lm1_exit
    s_load_dwordx2 s[4:5], s[0:1], 72
    s_load_dwordx2 s[6:7], s[0:1], 56
    s_load_dwordx4 s[40:43], s[0:1], 0
    s_load_dwordx2 s[44:45], s[0:1], 16
    s_load_dwordx2 s[46:47], s[0:1], 64
    s_load_dwordx4 s[68:71], s[0:1], 24
    s_load_dwordx4 s[72:75], s[0:1], 40
    s_memrealtime s[38:39]
    v_lshrrev_b32 v1, 6, v0
    s_mov_b32 s79, 0
    s_mov_b32 s80, 0
    v_readfirstlane_b32 s16, v1
    v_mbcnt_lo_u32_b32 v0, -1, 0
    v_mbcnt_hi_u32_b32 v0, -1, v0
    v_lshlrev_b32 v1, 4, v0
    v_and_b32 v2, 15, v0
    v_lshrrev_b32 v3, 4, v0
    s_mul_hi_u32 s18, s2, 238609295
    s_mul_i32 s19, s18, 18
    s_sub_u32 s17, s2, s19
    s_mov_b32 s20, 0
    s_mov_b32 s21, 3456
    s_mov_b32 s22, 6912
    s_mov_b32 s23, 10368
    s_mov_b32 s24, 13824
    s_mov_b32 s25, 17280
    s_mov_b32 s26, 20736
    s_mov_b32 s27, 24192
    v_mov_b32 v28, 0x3f803f80
    v_mov_b32 v29, 0x3f803f80
    v_mov_b32 v30, 0x3f803f80
    v_mov_b32 v31, 0x3f803f80
    s_mov_b32 s36, 0x05040100
    s_mov_b32 s37, 0x07060302
    s_mov_b32 s51, 0x20000
    s_lshl_b32 s30, s16, 4
    v_add_u32 v5, s30, v2
    s_lshl_b32 s30, s17, 5
    v_lshl_add_u32 v10, v3, 3, s30
    v_mul_u32_u24 v10, 3456, v10
    s_mul_i32 s30, s18, 288
    v_lshl_add_u32 v9, v5, 4, s30
    v_add_u32 v10, v10, v9
    v_cmp_gt_u32 vcc, 18, v5
    s_waitcnt lgkmcnt(0)
    s_mov_b32 s8, s4
    s_mov_b32 s9, s5
    s_mov_b32 s10, 67371008
    s_mov_b32 s11, 0x20000
    s_add_u32 s12, s4, 22020096
    s_addc_u32 s13, s5, 0
    s_mov_b32 s14, 45350912
    s_mov_b32 s15, 0x20000
    s_cmp_lg_u32 s2, 255
    s_cbranch_scc1 Lm3_nn
    s_cmp_lg_u32 s16, 0
    s_cbranch_scc1 Lm3_nn
    s_or_b32 s38, s38, 1
    v_mov_b32 v6, s38
    v_mov_b32 v7, 0
    s_mov_b64 exec, 1
    global_store_dword v7, v6, s[46:47] sc1
    s_mov_b64 exec, -1
Lm3_nn:
    s_cmp_ge_u32 s2, 216
    s_cbranch_scc1 Lm6_o
    s_cmp_ge_u32 s16, 2
    s_cbranch_scc1 Lm16_nq
    s_mov_b32 s48, s42
    s_mov_b32 s49, s43
    s_mov_b32 s50, 1990656
    s_and_saveexec_b64 s[34:35], vcc
    buffer_load_dwordx4 v[32:35], v10, s[48:51], s20 offen
    buffer_load_dwordx4 v[36:39], v10, s[48:51], s21 offen
    buffer_load_dwordx4 v[40:43], v10, s[48:51], s22 offen
    buffer_load_dwordx4 v[44:47], v10, s[48:51], s23 offen
    buffer_load_dwordx4 v[48:51], v10, s[48:51], s24 offen
    buffer_load_dwordx4 v[52:55], v10, s[48:51], s25 offen
    buffer_load_dwordx4 v[56:59], v10, s[48:51], s26 offen
    buffer_load_dwordx4 v[60:63], v10, s[48:51], s27 offen
    v_lshlrev_b32 v5, 3, v5
    v_lshlrev_b32 v11, 8, v3
    s_cmp_lt_u32 s18, 8
    s_cselect_b64 s[32:33], -1, 0
    v_add_u32 v6, 0, v5
    v_mul_u32_u24 v9, 3641, v6
    v_lshrrev_b32 v9, 16, v9
    v_mul_u32_u24 v8, 18, v9
    v_sub_u32 v8, v6, v8
    v_lshrrev_b32 v64, 3, v8
    v_lshlrev_b32 v64, 2, v64
    v_and_or_b32 v64, v8, 3, v64
    v_bfe_u32 v65, v8, 2, 1
    v_and_b32 v66, 6, v9
    v_add_u32 v66, v66, v65
    v_lshlrev_b32 v66, 4, v66
    v_and_b32 v67, 1, v9
    v_lshl_add_u32 v66, v67, 3, v66
    v_lshlrev_b32 v67, 4, v9
    v_lshl_add_u32 v67, v65, 3, v67
    v_cmp_gt_u32 vcc, 16, v8
    v_lshl_add_u32 v68, v9, 1, v8
    v_add_u32 v68, 112, v68
    v_cndmask_b32 v66, v67, v66, s[32:33]
    v_add_u32 v66, v66, v64
    v_cndmask_b32 v66, v68, v66, vcc
    v_lshrrev_b32 v67, 4, v66
    v_and_b32 v66, 15, v66
    v_lshl_add_u32 v66, v66, 4, v11
    v_lshl_add_u32 v12, v67, 10, v66
    v_add_u32 v6, 2, v5
    v_mul_u32_u24 v9, 3641, v6
    v_lshrrev_b32 v9, 16, v9
    v_mul_u32_u24 v8, 18, v9
    v_sub_u32 v8, v6, v8
    v_lshrrev_b32 v64, 3, v8
    v_lshlrev_b32 v64, 2, v64
    v_and_or_b32 v64, v8, 3, v64
    v_bfe_u32 v65, v8, 2, 1
    v_and_b32 v66, 6, v9
    v_add_u32 v66, v66, v65
    v_lshlrev_b32 v66, 4, v66
    v_and_b32 v67, 1, v9
    v_lshl_add_u32 v66, v67, 3, v66
    v_lshlrev_b32 v67, 4, v9
    v_lshl_add_u32 v67, v65, 3, v67
    v_cmp_gt_u32 vcc, 16, v8
    v_lshl_add_u32 v68, v9, 1, v8
    v_add_u32 v68, 112, v68
    v_cndmask_b32 v66, v67, v66, s[32:33]
    v_add_u32 v66, v66, v64
    v_cndmask_b32 v66, v68, v66, vcc
    v_lshrrev_b32 v67, 4, v66
    v_and_b32 v66, 15, v66
    v_lshl_add_u32 v66, v66, 4, v11
    v_lshl_add_u32 v14, v67, 10, v66
    v_add_u32 v6, 4, v5
    v_mul_u32_u24 v9, 3641, v6
    v_lshrrev_b32 v9, 16, v9
    v_mul_u32_u24 v8, 18, v9
    v_sub_u32 v8, v6, v8
    v_lshrrev_b32 v64, 3, v8
    v_lshlrev_b32 v64, 2, v64
    v_and_or_b32 v64, v8, 3, v64
    v_bfe_u32 v65, v8, 2, 1
    v_and_b32 v66, 6, v9
    v_add_u32 v66, v66, v65
    v_lshlrev_b32 v66, 4, v66
    v_and_b32 v67, 1, v9
    v_lshl_add_u32 v66, v67, 3, v66
    v_lshlrev_b32 v67, 4, v9
    v_lshl_add_u32 v67, v65, 3, v67
    v_cmp_gt_u32 vcc, 16, v8
    v_lshl_add_u32 v68, v9, 1, v8
    v_add_u32 v68, 112, v68
    v_cndmask_b32 v66, v67, v66, s[32:33]
    v_add_u32 v66, v66, v64
    v_cndmask_b32 v66, v68, v66, vcc
    v_lshrrev_b32 v67, 4, v66
    v_and_b32 v66, 15, v66
    v_lshl_add_u32 v66, v66, 4, v11
    v_lshl_add_u32 v16, v67, 10, v66
    v_add_u32 v6, 6, v5
    v_mul_u32_u24 v9, 3641, v6
    v_lshrrev_b32 v9, 16, v9
    v_mul_u32_u24 v8, 18, v9
    v_sub_u32 v8, v6, v8
    v_lshrrev_b32 v64, 3, v8
    v_lshlrev_b32 v64, 2, v64
    v_and_or_b32 v64, v8, 3, v64
    v_bfe_u32 v65, v8, 2, 1
    v_and_b32 v66, 6, v9
    v_add_u32 v66, v66, v65
    v_lshlrev_b32 v66, 4, v66
    v_and_b32 v67, 1, v9
    v_lshl_add_u32 v66, v67, 3, v66
    v_lshlrev_b32 v67, 4, v9
    v_lshl_add_u32 v67, v65, 3, v67
    v_cmp_gt_u32 vcc, 16, v8
    v_lshl_add_u32 v68, v9, 1, v8
    v_add_u32 v68, 112, v68
    v_cndmask_b32 v66, v67, v66, s[32:33]
    v_add_u32 v66, v66, v64
    v_cndmask_b32 v66, v68, v66, vcc
    v_lshrrev_b32 v67, 4, v66
    v_and_b32 v66, 15, v66
    v_lshl_add_u32 v66, v66, 4, v11
    v_lshl_add_u32 v18, v67, 10, v66
    s_waitcnt vmcnt(0)
    v_perm_b32 v64, v36, v32, s36
    v_perm_b32 v65, v44, v40, s36
    v_perm_b32 v66, v52, v48, s36
    v_perm_b32 v67, v60, v56, s36
    ds_write_b128 v12, v[64:67] offset:0
    v_perm_b32 v68, v36, v32, s37
    v_perm_b32 v69, v44, v40, s37
    v_perm_b32 v70, v52, v48, s37
    v_perm_b32 v71, v60, v56, s37
    ds_write_b128 v12, v[68:71] offset:16
    v_perm_b32 v72, v37, v33, s36
    v_perm_b32 v73, v45, v41, s36
    v_perm_b32 v74, v53, v49, s36
    v_perm_b32 v75, v61, v57, s36
    ds_write_b128 v14, v[72:75] offset:0
    v_perm_b32 v76, v37, v33, s37
    v_perm_b32 v77, v45, v41, s37
    v_perm_b32 v78, v53, v49, s37
    v_perm_b32 v79, v61, v57, s37
    ds_write_b128 v14, v[76:79] offset:16
    v_perm_b32 v80, v38, v34, s36
    v_perm_b32 v81, v46, v42, s36
    v_perm_b32 v82, v54, v50, s36
    v_perm_b32 v83, v62, v58, s36
    ds_write_b128 v16, v[80:83] offset:0
    v_perm_b32 v84, v38, v34, s37
    v_perm_b32 v85, v46, v42, s37
    v_perm_b32 v86, v54, v50, s37
    v_perm_b32 v87, v62, v58, s37
    ds_write_b128 v16, v[84:87] offset:16
    v_perm_b32 v88, v39, v35, s36
    v_perm_b32 v89, v47, v43, s36
    v_perm_b32 v90, v55, v51, s36
    v_perm_b32 v91, v63, v59, s36
    ds_write_b128 v18, v[88:91] offset:0
    v_perm_b32 v92, v39, v35, s37
    v_perm_b32 v93, v47, v43, s37
    v_perm_b32 v94, v55, v51, s37
    v_perm_b32 v95, v63, v59, s37
    ds_write_b128 v18, v[92:95] offset:16
    s_mov_b64 exec, -1
    s_waitcnt lgkmcnt(0)
    s_branch Lm10_q2
Lm16_nq:
    s_cmp_ge_u32 s16, 5
    s_cbranch_scc1 Lm10_q2
    s_cmp_ge_u32 s2, 128
    s_cbranch_scc1 Lm10_q2
    s_mov_b32 s48, s40
    s_mov_b32 s49, s41
    s_mov_b32 s50, 2359296
    s_sub_u32 s22, s16, 2
    s_mul_i32 s23, s22, 384
    s_mul_i32 s30, s2, 18432
    s_add_u32 s23, s23, s30
    v_mul_u32_u24 v10, 1152, v2
    v_lshl_add_u32 v10, v3, 4, v10
    buffer_load_dwordx4 v[32:35], v10, s[48:51], s23 offen offset:0
    buffer_load_dwordx4 v[36:39], v10, s[48:51], s23 offen offset:64
    buffer_load_dwordx4 v[40:43], v10, s[48:51], s23 offen offset:128
    buffer_load_dwordx4 v[44:47], v10, s[48:51], s23 offen offset:192
    buffer_load_dwordx4 v[48:51], v10, s[48:51], s23 offen offset:256
    buffer_load_dwordx4 v[52:55], v10, s[48:51], s23 offen offset:320
    s_mul_i32 s20, s2, 18432
    s_mul_i32 s21, s22, 6144
    s_add_u32 s20, s20, s21
    s_add_u32 s20, s20, 65536
    v_mov_b32 v12, 0
    v_mov_b32 v13, 0
    s_lshl_b32 s21, s2, 11
    s_add_u32 s21, s21, 45088768
    v_lshlrev_b32 v14, 3, v0
    buffer_store_dwordx2 v[12:13], v14, s[12:15], s21 offen offset:1536 sc1
    s_lshl_b32 s22, s22, 9
    s_add_u32 s21, s21, s22
    s_waitcnt vmcnt(6)
    buffer_store_dwordx4 v[32:35], v1, s[12:15], s20 offen offset:0 sc1
    v_dot2c_f32_bf16 v12, v32, v28
    v_dot2c_f32_bf16 v13, v32, v32
    v_dot2c_f32_bf16 v12, v33, v28
    v_dot2c_f32_bf16 v13, v33, v33
    v_dot2c_f32_bf16 v12, v34, v28
    v_dot2c_f32_bf16 v13, v34, v34
    v_dot2c_f32_bf16 v12, v35, v28
    v_dot2c_f32_bf16 v13, v35, v35
    s_waitcnt vmcnt(6)
    buffer_store_dwordx4 v[36:39], v1, s[12:15], s20 offen offset:1024 sc1
    v_dot2c_f32_bf16 v12, v36, v28
    v_dot2c_f32_bf16 v13, v36, v36
    v_dot2c_f32_bf16 v12, v37, v28
    v_dot2c_f32_bf16 v13, v37, v37
    v_dot2c_f32_bf16 v12, v38, v28
    v_dot2c_f32_bf16 v13, v38, v38
    v_dot2c_f32_bf16 v12, v39, v28
    v_dot2c_f32_bf16 v13, v39, v39
    s_waitcnt vmcnt(6)
    buffer_store_dwordx4 v[40:43], v1, s[12:15], s20 offen offset:2048 sc1
    v_dot2c_f32_bf16 v12, v40, v28
    v_dot2c_f32_bf16 v13, v40, v40
    v_dot2c_f32_bf16 v12, v41, v28
    v_dot2c_f32_bf16 v13, v41, v41
    v_dot2c_f32_bf16 v12, v42, v28
    v_dot2c_f32_bf16 v13, v42, v42
    v_dot2c_f32_bf16 v12, v43, v28
    v_dot2c_f32_bf16 v13, v43, v43
    s_waitcnt vmcnt(6)
    buffer_store_dwordx4 v[44:47], v1, s[12:15], s20 offen offset:3072 sc1
    v_dot2c_f32_bf16 v12, v44, v28
    v_dot2c_f32_bf16 v13, v44, v44
    v_dot2c_f32_bf16 v12, v45, v28
    v_dot2c_f32_bf16 v13, v45, v45
    v_dot2c_f32_bf16 v12, v46, v28
    v_dot2c_f32_bf16 v13, v46, v46
    v_dot2c_f32_bf16 v12, v47, v28
    v_dot2c_f32_bf16 v13, v47, v47
    s_waitcnt vmcnt(6)
    s_add_u32 s20, s20, 4096
    buffer_store_dwordx4 v[48:51], v1, s[12:15], s20 offen offset:0 sc1
    v_dot2c_f32_bf16 v12, v48, v28
    v_dot2c_f32_bf16 v13, v48, v48
    v_dot2c_f32_bf16 v12, v49, v28
    v_dot2c_f32_bf16 v13, v49, v49
    v_dot2c_f32_bf16 v12, v50, v28
    v_dot2c_f32_bf16 v13, v50, v50
    v_dot2c_f32_bf16 v12, v51, v28
    v_dot2c_f32_bf16 v13, v51, v51
    s_waitcnt vmcnt(6)
    buffer_store_dwordx4 v[52:55], v1, s[12:15], s20 offen offset:1024 sc1
    v_dot2c_f32_bf16 v12, v52, v28
    v_dot2c_f32_bf16 v13, v52, v52
    v_dot2c_f32_bf16 v12, v53, v28
    v_dot2c_f32_bf16 v13, v53, v53
    v_dot2c_f32_bf16 v12, v54, v28
    v_dot2c_f32_bf16 v13, v54, v54
    v_dot2c_f32_bf16 v12, v55, v28
    v_dot2c_f32_bf16 v13, v55, v55
    s_nop 2
    buffer_store_dwordx2 v[12:13], v14, s[12:15], s21 offen sc1
Lm10_q2:
    s_mul_hi_u32 s32, s17, 477218589
    s_mul_i32 s19, s32, 9
    s_sub_u32 s33, s17, s19
    s_mul_i32 s30, s18, 9
    s_add_u32 s30, s30, s33
    s_lshl_b32 s30, s30, 1
    s_add_u32 s30, s30, s32
    s_mul_i32 s30, s30, 9216
    s_lshl_b32 s31, s16, 10
    s_add_u32 s30, s30, s31
    s_add_u32 s30, s30, 0
    v_add_u32 v5, s31, v1
    s_mul_i32 s31, s17, 12
    s_add_u32 s31, s31, s18
    s_mul_i32 s31, s31, 576
    s_lshl_b32 s34, s16, 6
    s_add_u32 s31, s31, s34
    s_add_u32 s31, s31, 20185088
    v_lshlrev_b32 v6, 2, v0
    s_barrier
    ds_read_b128 v[16:19], v5
    ds_read_b128 v[20:23], v5 offset:8192
    s_waitcnt lgkmcnt(0)
    buffer_store_dwordx4 v[16:19], v1, s[8:11], s30 offen sc1
    v_mfma_f32_16x16x32_bf16 v[24:27], v[28:31], v[16:19], 0
    v_mfma_f32_16x16x32_bf16 v[8:11], v[28:31], v[20:23], 0
    s_add_u32 s30, s30, 8192
    s_mov_b64 exec, 0xffff
    s_nop 4
    buffer_store_dword v24, v6, s[8:11], s31 offen sc1
    s_mov_b64 exec, -1
    s_cmp_lg_u32 s16, 0
    s_cbranch_scc1 Lm13_p0pub
    buffer_store_dwordx4 v[20:23], v1, s[8:11], s30 offen sc1
    s_mov_b64 exec, 0xffff
    buffer_store_dword v8, v6, s[8:11], s31 offen offset:512 sc1
    s_mov_b64 exec, -1
    s_branch Lm13_p0pub
Lm6_o:
    s_sub_u32 s38, s2, 216
    s_lshl_b32 s38, s38, 3
    s_add_u32 s38, s38, s16
    s_cmp_ge_u32 s38, 96
    s_cbranch_scc1 Lm7_t
    s_cmp_ge_u32 s38, 90
    s_cbranch_scc1 Lm13_p0pub
    s_mul_hi_u32 s17, s38, 858993460
    s_mul_i32 s19, s17, 5
    s_sub_u32 s18, s38, s19
    s_mov_b32 s48, s44
    s_mov_b32 s49, s45
    s_mov_b32 s50, 663552
    s_lshl_b32 s30, s18, 3
    v_lshrrev_b32 v5, 1, v2
    v_add_u32 v5, s30, v5
    v_and_b32 v6, 1, v2
    v_lshlrev_b32 v6, 7, v6
    v_lshl_add_u32 v6, v3, 8, v6
    s_lshl_b32 s30, s18, 8
    v_lshlrev_b32 v7, 4, v2
    v_add_u32 v7, s30, v7
    s_cmp_ge_u32 s17, 16
    s_cbranch_scc1 Lm11_wt
    s_mov_b32 s20, 0
    s_mov_b32 s21, 1152
    s_mov_b32 s22, 2304
    s_mov_b32 s23, 3456
    s_mov_b32 s24, 4608
    s_mov_b32 s25, 5760
    s_mov_b32 s26, 6912
    s_mov_b32 s27, 8064
    s_mul_i32 s30, s17, 36
    v_lshrrev_b32 v10, 1, v3
    v_mul_u32_u24 v10, 18, v10
    v_and_b32 v9, 1, v3
    v_lshl_add_u32 v10, v9, 3, v10
    v_add_u32 v10, s30, v10
    s_branch Lm12_wj
Lm11_wt:
    s_mov_b32 s20, 0
    s_mov_b32 s21, 1152
    s_mov_b32 s22, 20736
    s_mov_b32 s23, 21888
    s_mov_b32 s24, 41472
    s_mov_b32 s25, 42624
    s_mov_b32 s26, 62208
    s_mov_b32 s27, 63360
    s_sub_u32 s30, s17, 16
    s_mul_i32 s30, s30, 288
    s_add_u32 s30, s30, 16
    v_mul_u32_u24 v10, 72, v3
    v_add_u32 v10, s30, v10
Lm12_wj:
    v_mul_u32_u24 v10, 1152, v10
    v_add_u32 v10, v10, v7
    buffer_load_dwordx4 v[32:35], v10, s[48:51], s20 offen
    buffer_load_dwordx4 v[36:39], v10, s[48:51], s21 offen
    buffer_load_dwordx4 v[40:43], v10, s[48:51], s22 offen
    buffer_load_dwordx4 v[44:47], v10, s[48:51], s23 offen
    buffer_load_dwordx4 v[48:51], v10, s[48:51], s24 offen
    buffer_load_dwordx4 v[52:55], v10, s[48:51], s25 offen
    buffer_load_dwordx4 v[56:59], v10, s[48:51], s26 offen
    buffer_load_dwordx4 v[60:63], v10, s[48:51], s27 offen
    s_mul_i32 s20, s18, 144
    s_add_u32 s20, s20, s17
    s_lshl_b32 s20, s20, 10
    s_add_u32 s20, s20, 2097152
    s_add_u32 s21, s20, 18432
    s_add_u32 s22, s20, 36864
    s_add_u32 s23, s20, 55296
    s_add_u32 s24, s20, 73728
    s_add_u32 s25, s20, 92160
    s_add_u32 s26, s20, 110592
    s_add_u32 s27, s20, 129024
    s_branch Lm8_d16
Lm7_t:
    s_sub_u32 s17, s38, 96
    s_cmp_ge_u32 s17, 72
    s_cbranch_scc1 Lm_code
    s_mov_b32 s48, s74
    s_mov_b32 s49, s75
    s_mov_b32 s50, 5308416
    s_mul_hi_u32 s31, s17, 238609295
    s_mul_i32 s33, s31, 18
    s_sub_u32 s32, s17, s33
    s_mul_i32 s33, s32, 22
    s_lshr_b32 s33, s33, 6
    s_mul_i32 s33, s33, 3
    s_lshl_b32 s28, s32, 1
    s_add_u32 s33, s33, s28
    s_mul_i32 s28, s32, 9
    s_sub_u32 s28, s28, 102
    s_cmp_ge_u32 s32, 12
    s_cselect_b32 s33, s28, s33
    s_mul_i32 s28, s32, 18
    s_sub_u32 s28, s28, 280
    s_cmp_ge_u32 s32, 16
    s_cselect_b32 s33, s28, s33
    s_cselect_b32 s28, 9, 1
    s_cselect_b32 s32, 8, 0
    s_mul_i32 s31, s31, 36
    s_add_u32 s33, s33, s31
    s_add_u32 s28, s28, s33
    s_lshr_b32 s31, s33, 3
    s_lshl_b32 s31, s31, 7
    s_and_b32 s21, s33, 7
    s_add_u32 s31, s31, s21
    s_mul_i32 s20, s31, 1152
    s_lshr_b32 s31, s28, 3
    s_lshl_b32 s31, s31, 7
    s_and_b32 s21, s28, 7
    s_add_u32 s31, s31, s21
    s_mul_i32 s24, s31, 1152
    s_sub_u32 s33, s24, s20
    s_add_u32 s31, s20, 36864
    s_cmp_eq_u32 s32, 8
    s_cselect_b32 s33, s33, 73728
    s_cselect_b32 s24, s31, s24
    s_cselect_b32 s28, 2, 1
    s_mul_i32 s28, s28, 36864
    v_lshrrev_b32 v5, 1, v3
    v_mul_lo_u32 v10, v5, s33
    v_and_b32 v5, 1, v3
    v_mul_lo_u32 v5, v5, s28
    v_add_u32 v10, v10, v5
    s_add_u32 s21, s20, 9216
    s_add_u32 s22, s20, 18432
    s_add_u32 s23, s20, 27648
    s_add_u32 s25, s24, 9216
    s_add_u32 s26, s24, 18432
    s_add_u32 s27, s24, 27648
    s_mul_hi_u32 s31, s17, 119304648
    s_mul_i32 s33, s31, 36
    s_sub_u32 s32, s17, s33
    s_mul_i32 s31, s31, 36
    s_cmp_ge_u32 s32, 18
    s_cselect_b32 s33, 35, 0
    s_lshl_b32 s32, s32, 1
    s_sub_u32 s32, s32, s33
    s_add_u32 s31, s31, s32
    s_mul_i32 s31, s31, 9216
    v_bfe_u32 v5, v2, 1, 2
    v_mul_u32_u24 v6, 288, v5
    v_add_u32 v10, v10, v6
    v_mul_u32_u24 v12, 1327104, v5
    v_and_b32 v5, 1, v2
    v_lshl_add_u32 v10, v5, 4, v10
    v_add_u32 v10, 256, v10
    v_lshl_add_u32 v12, v5, 7, v12
    v_lshl_add_u32 v12, v3, 8, v12
    v_lshrrev_b32 v5, 3, v2
    v_mul_u32_u24 v6, 2654208, v5
    v_add_u32 v10, v10, v6
    buffer_load_dwordx4 v[32:35], v10, s[48:51], s20 offen
    buffer_load_dwordx4 v[36:39], v10, s[48:51], s21 offen
    buffer_load_dwordx4 v[40:43], v10, s[48:51], s22 offen
    buffer_load_dwordx4 v[44:47], v10, s[48:51], s23 offen
    buffer_load_dwordx4 v[48:51], v10, s[48:51], s24 offen
    buffer_load_dwordx4 v[52:55], v10, s[48:51], s25 offen
    buffer_load_dwordx4 v[56:59], v10, s[48:51], s26 offen
    buffer_load_dwordx4 v[60:63], v10, s[48:51], s27 offen
    s_add_u32 s20, s31, 14688256
    s_add_u32 s21, s31, 16015360
    s_add_u32 s22, s31, 17342464
    s_add_u32 s23, s31, 18669568
    s_add_u32 s24, s31, 15351808
    s_add_u32 s25, s31, 16678912
    s_add_u32 s26, s31, 18006016
    s_add_u32 s27, s31, 19333120
Lm8_d16:
    s_lshl_b32 s30, s16, 13
    v_lshrrev_b32 v12, 1, v2
    v_lshlrev_b32 v12, 10, v12
    v_and_b32 v5, 1, v2
    v_lshl_add_u32 v12, v5, 7, v12
    v_lshl_add_u32 v12, v3, 8, v12
    v_add_u32 v12, s30, v12
    v_add_u32 v13, s30, v1
    s_waitcnt vmcnt(0)
    v_perm_b32 v64, v36, v32, s36
    v_perm_b32 v65, v44, v40, s36
    v_perm_b32 v66, v52, v48, s36
    v_perm_b32 v67, v60, v56, s36
    ds_write_b128 v12, v[64:67] offset:0
    v_perm_b32 v68, v36, v32, s37
    v_perm_b32 v69, v44, v40, s37
    v_perm_b32 v70, v52, v48, s37
    v_perm_b32 v71, v60, v56, s37
    ds_write_b128 v12, v[68:71] offset:16
    v_perm_b32 v72, v37, v33, s36
    v_perm_b32 v73, v45, v41, s36
    v_perm_b32 v74, v53, v49, s36
    v_perm_b32 v75, v61, v57, s36
    ds_write_b128 v12, v[72:75] offset:32
    v_perm_b32 v76, v37, v33, s37
    v_perm_b32 v77, v45, v41, s37
    v_perm_b32 v78, v53, v49, s37
    v_perm_b32 v79, v61, v57, s37
    ds_write_b128 v12, v[76:79] offset:48
    v_perm_b32 v80, v38, v34, s36
    v_perm_b32 v81, v46, v42, s36
    v_perm_b32 v82, v54, v50, s36
    v_perm_b32 v83, v62, v58, s36
    ds_write_b128 v12, v[80:83] offset:64
    v_perm_b32 v84, v38, v34, s37
    v_perm_b32 v85, v46, v42, s37
    v_perm_b32 v86, v54, v50, s37
    v_perm_b32 v87, v62, v58, s37
    ds_write_b128 v12, v[84:87] offset:80
    v_perm_b32 v88, v39, v35, s36
    v_perm_b32 v89, v47, v43, s36
    v_perm_b32 v90, v55, v51, s36
    v_perm_b32 v91, v63, v59, s36
    ds_write_b128 v12, v[88:91] offset:96
    v_perm_b32 v92, v39, v35, s37
    v_perm_b32 v93, v47, v43, s37
    v_perm_b32 v94, v55, v51, s37
    v_perm_b32 v95, v63, v59, s37
    ds_write_b128 v12, v[92:95] offset:112
    s_waitcnt lgkmcnt(0)
    ds_read_b128 v[32:35], v13 offset:0
    ds_read_b128 v[36:39], v13 offset:1024
    ds_read_b128 v[40:43], v13 offset:2048
    ds_read_b128 v[44:47], v13 offset:3072
    ds_read_b128 v[48:51], v13 offset:4096
    ds_read_b128 v[52:55], v13 offset:5120
    ds_read_b128 v[56:59], v13 offset:6144
    ds_read_b128 v[60:63], v13 offset:7168
    s_waitcnt lgkmcnt(7)
    buffer_store_dwordx4 v[32:35], v1, s[8:11], s20 offen sc1
    s_waitcnt lgkmcnt(6)
    buffer_store_dwordx4 v[36:39], v1, s[8:11], s21 offen sc1
    s_waitcnt lgkmcnt(5)
    buffer_store_dwordx4 v[40:43], v1, s[8:11], s22 offen sc1
    s_waitcnt lgkmcnt(4)
    buffer_store_dwordx4 v[44:47], v1, s[8:11], s23 offen sc1
    s_waitcnt lgkmcnt(3)
    buffer_store_dwordx4 v[48:51], v1, s[8:11], s24 offen sc1
    s_waitcnt lgkmcnt(2)
    buffer_store_dwordx4 v[52:55], v1, s[8:11], s25 offen sc1
    s_waitcnt lgkmcnt(1)
    buffer_store_dwordx4 v[56:59], v1, s[8:11], s26 offen sc1
    s_waitcnt lgkmcnt(0)
    buffer_store_dwordx4 v[60:63], v1, s[8:11], s27 offen sc1
    s_branch Lm13_p0pub
Lm_code:
    s_cmp_ge_u32 s2, 240
    s_cbranch_scc1 Lm17_cc
    s_sub_u32 s30, s17, 72
    s_mul_i32 s30, s30, 24576
    s_add_u32 s30, s30, 44564480
    v_lshlrev_b32 v5, 7, v0
    buffer_load_dword v32, v5, s[12:15], s30 offen sc0 sc1
    s_add_u32 s30, s30, 8192
    buffer_load_dword v33, v5, s[12:15], s30 offen sc0 sc1
    s_add_u32 s30, s30, 8192
    buffer_load_dword v34, v5, s[12:15], s30 offen sc0 sc1
    s_branch Lm13_p0pub
Lm17_cc:
    s_getpc_b64 s[30:31]
    s_bfe_u32 s32, s2, 0x10003
    s_lshl_b32 s32, s32, 3
    s_add_u32 s32, s32, s16
    s_mul_i32 s32, s32, 4096
    v_add_u32 v5, s32, v1
    v_min_u32 v5, 53856, v5
    global_load_dwordx4 v[32:35], v5, s[30:31]
    v_add_u32 v5, 1024, v5
    v_min_u32 v5, 53856, v5
    global_load_dwordx4 v[36:39], v5, s[30:31]
    v_add_u32 v5, 1024, v5
    v_min_u32 v5, 53856, v5
    global_load_dwordx4 v[40:43], v5, s[30:31]
    v_add_u32 v5, 1024, v5
    v_min_u32 v5, 53856, v5
    global_load_dwordx4 v[44:47], v5, s[30:31]
    v_add_u32 v5, 1024, v5
    v_min_u32 v5, 53856, v5
Lm13_p0pub:
    s_mov_b32 s48, s46
    s_mov_b32 s49, s47
    s_mov_b32 s50, 256
    v_mov_b32 v13, 0
    s_mov_b32 s3, 0x40000
    s_mov_b64 exec, 1
Lm18_n:
    buffer_load_dword v14, v13, s[48:51], 0 offen sc1
    s_waitcnt vmcnt(0) lgkmcnt(0)
    v_readfirstlane_b32 s80, v14
    s_sub_u32 s3, s3, 1
    s_cbranch_scc1 Lm19_nd
    s_cmp_eq_u32 s80, 0
    s_cbranch_scc1 Lm18_n
Lm19_nd:
    s_barrier
    s_cmp_lg_u32 s16, 0
    s_cbranch_scc1 Lm14_p4
    s_lshl_b32 s30, s2, 7
    s_add_u32 s30, s30, 44761088
    buffer_store_dword v14, v13, s[12:15], s30 offen sc1
    s_sub_u32 s30, s2, 216
    s_cmp_ge_u32 s30, 12
    s_cbranch_scc1 Lm14_p4
    s_mov_b64 exec, 15
    v_lshlrev_b32 v13, 13, v0
    v_mov_b32 v14, s80
    s_lshl_b32 s30, s30, 7
    s_add_u32 s30, s30, 44570624
    buffer_store_dword v14, v13, s[12:15], s30 offen sc1
Lm14_p4:
    s_mov_b64 exec, -1
Lm9_p0done:
Lm2_loop:
    s_cmp_ge_u32 s2, 192
    s_cbranch_scc1 Lm20_qend
    v_mbcnt_lo_u32_b32 v0, -1, 0
    v_mbcnt_hi_u32_b32 v0, -1, v0
    v_lshlrev_b32 v1, 4, v0
    v_and_b32 v2, 15, v0
    v_lshrrev_b32 v3, 4, v0
    s_and_b32 s17, s16, 3
    s_lshr_b32 s18, s16, 2
    s_mul_i32 s19, s18, 9216
    v_add_u32 v4, s19, v1
    v_add_u32 v5, 36864, v4
    v_add_u32 v6, 73728, v4
    v_add_u32 v7, 110592, v4
    s_mul_i32 s20, s16, 4608
    s_mul_i32 s21, s16, 2304
    s_mov_b32 s22, -1
    s_mov_b32 s23, 0
    s_mov_b32 s24, 0xffff
    s_mov_b32 s25, 0
    s_and_b32 s31, s2, 1
    s_lshl_b32 s31, s31, 3
    s_bfe_u32 s32, s2, 0x30003
    s_add_u32 s31, s31, s32
    s_lshr_b32 s32, s2, 6
    s_lshl_b32 s32, s32, 2
    s_bfe_u32 s33, s2, 0x20001
    s_add_u32 s32, s32, s33
    s_lshl_b32 s47, s33, 6
    s_lshr_b32 s46, s2, 6
    s_lshl_b32 s46, s46, 4
    s_add_u32 s47, s47, s46
    s_add_u32 s47, s47, s31
    s_lshl_b32 s47, s47, 7
    s_add_u32 s47, s47, 44564480
    s_mul_i32 s33, s32, 165888
    s_add_u32 s33, s33, 0
    s_lshl_b32 s34, s31, 3
    s_lshl_b32 s35, s17, 1
    s_add_u32 s34, s34, s35
    s_add_u32 s36, s34, s18
    s_xor_b32 s35, s18, 1
    s_add_u32 s37, s34, s35
    s_mul_i32 s35, s18, 9
    s_mul_i32 s38, s36, 18
    s_add_u32 s38, s38, s35
    s_lshl_b32 s38, s38, 10
    s_add_u32 s38, s38, 65536
    s_mul_i32 s39, s37, 18
    s_add_u32 s39, s39, s35
    s_lshl_b32 s39, s39, 10
    s_add_u32 s39, s39, 65536
    s_lshl_b32 s27, s31, 11
    s_add_u32 s27, s27, 44728320
    s_mul_i32 s40, s32, 576
    s_add_u32 s40, s40, 20185088
    s_lshl_b32 s41, s16, 6
    v_add_u32 v12, s41, v0
    v_lshlrev_b32 v10, 2, v12
    v_add_u32 v11, s40, v10
    v_cmp_gt_u32 vcc, 144, v12
    v_mov_b32 v12, 2147483392
    v_add_u32 v10, 147456, v10
    v_cndmask_b32 v11, v12, v11, vcc
    s_mov_b32 s42, 0
    s_lshl_b32 s41, s36, 11
    s_add_u32 s41, s41, 45088768
    v_lshlrev_b32 v12, 3, v0
    s_cmp_eq_u32 s79, 0
    s_cbranch_scc1 Lm23_qc
    s_cmp_ge_u32 s16, 3
    s_cbranch_scc1 Lm23_qc
    buffer_load_dword v176, v11, s[8:11], s42 offen sc1
    s_add_u32 s42, s42, 6912
    buffer_load_dword v177, v11, s[8:11], s42 offen sc1
    s_add_u32 s42, s42, 6912
    buffer_load_dword v178, v11, s[8:11], s42 offen sc1
    s_add_u32 s42, s42, 6912
    buffer_load_dword v179, v11, s[8:11], s42 offen sc1
    s_add_u32 s42, s42, 6912
    buffer_load_dword v180, v11, s[8:11], s42 offen sc1
    s_add_u32 s42, s42, 6912
    buffer_load_dword v181, v11, s[8:11], s42 offen sc1
    s_add_u32 s42, s42, 6912
    buffer_load_dword v182, v11, s[8:11], s42 offen sc1
    s_add_u32 s42, s42, 6912
    buffer_load_dword v183, v11, s[8:11], s42 offen sc1
    s_add_u32 s42, s42, 6912
    buffer_load_dword v184, v11, s[8:11], s42 offen sc1
    s_add_u32 s42, s42, 6912
    buffer_load_dword v185, v11, s[8:11], s42 offen sc1
    s_add_u32 s42, s42, 6912
    buffer_load_dword v186, v11, s[8:11], s42 offen sc1
    s_add_u32 s42, s42, 6912
    buffer_load_dword v187, v11, s[8:11], s42 offen sc1
    s_add_u32 s42, s42, 6912
    buffer_load_dword v188, v11, s[8:11], s42 offen sc1
    s_add_u32 s42, s42, 6912
    buffer_load_dword v189, v11, s[8:11], s42 offen sc1
    s_add_u32 s42, s42, 6912
    buffer_load_dword v190, v11, s[8:11], s42 offen sc1
    s_add_u32 s42, s42, 6912
    buffer_load_dword v191, v11, s[8:11], s42 offen sc1
    s_add_u32 s42, s42, 6912
    buffer_load_dword v192, v11, s[8:11], s42 offen sc1
    s_add_u32 s42, s42, 6912
    buffer_load_dword v193, v11, s[8:11], s42 offen sc1
    s_add_u32 s42, s42, 6912
Lm23_qc:
    s_cmp_eq_u32 s16, 7
    s_cbranch_scc1 Lm24_p
    s_barrier
    s_branch Lm25_j
Lm24_p:
    v_lshl_add_u32 v13, v0, 7, s79
    s_mov_b32 s3, 0x40000
    s_mov_b32 exec_lo, 65535
    s_mov_b32 exec_hi, 0
    s_cmp_lg_u32 s79, 0
    s_cbranch_scc1 Lm26_l
    s_mov_b64 exec, -1
    s_mul_i32 s27, s32, 18
    v_add_u32 v13, s27, v0
    s_lshl_b32 s27, s31, 3
    s_sub_u32 s27, s27, 18
    v_add_u32 v14, s27, v0
    v_cmp_gt_u32 vcc, 18, v0
    s_mov_b32 s27, 44761088
    s_nop 0
    v_cndmask_b32 v13, v14, v13, vcc
    v_lshlrev_b32 v13, 7, v13
    s_mov_b64 exec, 0x3ffffff
Lm26_l:
    buffer_load_dword v14, v13, s[12:15], s27 offen sc1
    s_waitcnt vmcnt(0)
    v_cmp_ne_u32 vcc, s80, v14
    s_sub_u32 s3, s3, 1
    s_cbranch_scc1 Lm27_d
    s_nop 2
    s_cbranch_vccz Lm27_d
    s_sleep 4
    s_branch Lm26_l
Lm27_d:
    s_mov_b64 exec, -1
    s_barrier
Lm25_j:
    s_cmp_lg_u32 s79, 0
    s_cbranch_scc1 Lm28_qw
    s_add_u32 m0, s20, 0
    s_add_u32 s26, s33, s20
    s_add_u32 s26, s26, 0
    buffer_load_dwordx4 v1, s[8:11], s26 offen offset:0 sc1 lds
    buffer_load_dwordx4 v1, s[8:11], s26 offen offset:1024 sc1 lds
    buffer_load_dwordx4 v1, s[8:11], s26 offen offset:2048 sc1 lds
    buffer_load_dwordx4 v1, s[8:11], s26 offen offset:3072 sc1 lds
    s_add_u32 m0, m0, 4096
    s_add_u32 s26, s26, 4096
    s_mov_b64 exec, s[22:23]
    buffer_load_dwordx4 v1, s[8:11], s26 offen sc1 lds
    s_mov_b64 exec, -1
    s_add_u32 m0, s20, 36864
    s_add_u32 s26, s33, s20
    s_add_u32 s26, s26, 36864
    buffer_load_dwordx4 v1, s[8:11], s26 offen offset:0 sc1 lds
    buffer_load_dwordx4 v1, s[8:11], s26 offen offset:1024 sc1 lds
    buffer_load_dwordx4 v1, s[8:11], s26 offen offset:2048 sc1 lds
    buffer_load_dwordx4 v1, s[8:11], s26 offen offset:3072 sc1 lds
    s_add_u32 m0, m0, 4096
    s_add_u32 s26, s26, 4096
    s_mov_b64 exec, s[22:23]
    buffer_load_dwordx4 v1, s[8:11], s26 offen sc1 lds
    s_mov_b64 exec, -1
Lm28_qw:
    buffer_load_dwordx4 v[112:115], v1, s[12:15], s38 offen offset:0 sc1
    buffer_load_dwordx4 v[116:119], v1, s[12:15], s39 offen offset:0 sc1
    buffer_load_dwordx4 v[120:123], v1, s[12:15], s38 offen offset:1024 sc1
    buffer_load_dwordx4 v[124:127], v1, s[12:15], s39 offen offset:1024 sc1
    buffer_load_dwordx4 v[128:131], v1, s[12:15], s38 offen offset:2048 sc1
    buffer_load_dwordx4 v[132:135], v1, s[12:15], s39 offen offset:2048 sc1
    buffer_load_dwordx4 v[136:139], v1, s[12:15], s38 offen offset:3072 sc1
    buffer_load_dwordx4 v[140:143], v1, s[12:15], s39 offen offset:3072 sc1
    s_cmp_ge_u32 s32, 8
    s_cbranch_scc1 Lm21_qv
    s_waitcnt vmcnt(13)
    s_barrier
    ds_read_b128 v[88:91], v4 offset:0
    ds_read_b128 v[92:95], v4 offset:1024
    ds_read_b128 v[96:99], v4 offset:2048
    ds_read_b128 v[100:103], v4 offset:3072
    ds_read_b128 v[104:107], v4 offset:4096
    s_waitcnt vmcnt(6) lgkmcnt(4)
    v_mfma_f32_16x16x32_bf16 v[16:19], v[88:91], v[112:115], 0
    v_mfma_f32_16x16x32_bf16 v[52:55], v[88:91], v[116:119], 0
    s_add_u32 m0, s20, 73728
    s_add_u32 s26, s33, s20
    s_add_u32 s26, s26, 73728
    buffer_load_dwordx4 v1, s[8:11], s26 offen offset:0 sc1 lds
    ds_read_b128 v[108:111], v4 offset:5120
    s_waitcnt lgkmcnt(4)
    v_mfma_f32_16x16x32_bf16 v[20:23], v[92:95], v[112:115], 0
    v_mfma_f32_16x16x32_bf16 v[56:59], v[92:95], v[116:119], 0
    buffer_load_dwordx4 v1, s[8:11], s26 offen offset:1024 sc1 lds
    ds_read_b128 v[88:91], v4 offset:6144
    s_waitcnt lgkmcnt(4)
    v_mfma_f32_16x16x32_bf16 v[24:27], v[96:99], v[112:115], 0
    v_mfma_f32_16x16x32_bf16 v[60:63], v[96:99], v[116:119], 0
    buffer_load_dwordx4 v1, s[8:11], s26 offen offset:2048 sc1 lds
    ds_read_b128 v[92:95], v4 offset:7168
    s_waitcnt lgkmcnt(4)
    v_mfma_f32_16x16x32_bf16 v[28:31], v[100:103], v[112:115], 0
    v_mfma_f32_16x16x32_bf16 v[64:67], v[100:103], v[116:119], 0
    buffer_load_dwordx4 v1, s[8:11], s26 offen offset:3072 sc1 lds
    ds_read_b128 v[96:99], v4 offset:8192
    s_waitcnt lgkmcnt(4)
    v_mfma_f32_16x16x32_bf16 v[32:35], v[104:107], v[112:115], 0
    v_mfma_f32_16x16x32_bf16 v[68:71], v[104:107], v[116:119], 0
    s_add_u32 m0, m0, 4096
    s_add_u32 s26, s26, 4096
    s_mov_b64 exec, s[22:23]
    buffer_load_dwordx4 v1, s[8:11], s26 offen sc1 lds
    s_mov_b64 exec, -1
    ds_read_b128 v[100:103], v4 offset:18432
    s_waitcnt lgkmcnt(4)
    v_mfma_f32_16x16x32_bf16 v[36:39], v[108:111], v[112:115], 0
    v_mfma_f32_16x16x32_bf16 v[72:75], v[108:111], v[116:119], 0
    ds_read_b128 v[104:107], v4 offset:19456
    s_waitcnt lgkmcnt(4)
    v_mfma_f32_16x16x32_bf16 v[40:43], v[88:91], v[112:115], 0
    v_mfma_f32_16x16x32_bf16 v[76:79], v[88:91], v[116:119], 0
    s_add_u32 s38, s38, 4096
    buffer_load_dwordx4 v[144:147], v1, s[12:15], s38 offen offset:0 sc1
    ds_read_b128 v[108:111], v4 offset:20480
    s_waitcnt lgkmcnt(4)
    v_mfma_f32_16x16x32_bf16 v[44:47], v[92:95], v[112:115], 0
    v_mfma_f32_16x16x32_bf16 v[80:83], v[92:95], v[116:119], 0
    ds_read_b128 v[88:91], v4 offset:21504
    s_waitcnt lgkmcnt(4)
    v_mfma_f32_16x16x32_bf16 v[48:51], v[96:99], v[112:115], 0
    v_mfma_f32_16x16x32_bf16 v[84:87], v[96:99], v[116:119], 0
    s_add_u32 s39, s39, 4096
    buffer_load_dwordx4 v[148:151], v1, s[12:15], s39 offen offset:0 sc1
    ds_read_b128 v[92:95], v4 offset:22528
    s_waitcnt vmcnt(11) lgkmcnt(4)
    v_mfma_f32_16x16x32_bf16 v[16:19], v[100:103], v[120:123], v[16:19]
    v_mfma_f32_16x16x32_bf16 v[52:55], v[100:103], v[124:127], v[52:55]
    ds_read_b128 v[96:99], v4 offset:23552
    s_waitcnt lgkmcnt(4)
    v_mfma_f32_16x16x32_bf16 v[20:23], v[104:107], v[120:123], v[20:23]
    v_mfma_f32_16x16x32_bf16 v[56:59], v[104:107], v[124:127], v[56:59]
    buffer_load_dwordx4 v[152:155], v1, s[12:15], s38 offen offset:1024 sc1
    ds_read_b128 v[100:103], v4 offset:24576
    s_waitcnt lgkmcnt(4)
    v_mfma_f32_16x16x32_bf16 v[24:27], v[108:111], v[120:123], v[24:27]
    v_mfma_f32_16x16x32_bf16 v[60:63], v[108:111], v[124:127], v[60:63]
    ds_read_b128 v[104:107], v4 offset:25600
    s_waitcnt lgkmcnt(4)
    v_mfma_f32_16x16x32_bf16 v[28:31], v[88:91], v[120:123], v[28:31]
    v_mfma_f32_16x16x32_bf16 v[64:67], v[88:91], v[124:127], v[64:67]
    buffer_load_dwordx4 v[156:159], v1, s[12:15], s39 offen offset:1024 sc1
    ds_read_b128 v[108:111], v4 offset:26624
    s_waitcnt lgkmcnt(4)
    v_mfma_f32_16x16x32_bf16 v[32:35], v[92:95], v[120:123], v[32:35]
    v_mfma_f32_16x16x32_bf16 v[68:71], v[92:95], v[124:127], v[68:71]
    s_barrier
    ds_read_b128 v[88:91], v5 offset:0
    s_waitcnt lgkmcnt(4)
    v_mfma_f32_16x16x32_bf16 v[36:39], v[96:99], v[120:123], v[36:39]
    v_mfma_f32_16x16x32_bf16 v[72:75], v[96:99], v[124:127], v[72:75]
    s_add_u32 m0, s20, 110592
    s_add_u32 s26, s33, s20
    s_add_u32 s26, s26, 110592
    buffer_load_dwordx4 v1, s[8:11], s26 offen offset:0 sc1 lds
    ds_read_b128 v[92:95], v5 offset:1024
    s_waitcnt lgkmcnt(4)
    v_mfma_f32_16x16x32_bf16 v[40:43], v[100:103], v[120:123], v[40:43]
    v_mfma_f32_16x16x32_bf16 v[76:79], v[100:103], v[124:127], v[76:79]
    ds_read_b128 v[96:99], v5 offset:2048
    s_waitcnt lgkmcnt(4)
    v_mfma_f32_16x16x32_bf16 v[44:47], v[104:107], v[120:123], v[44:47]
    v_mfma_f32_16x16x32_bf16 v[80:83], v[104:107], v[124:127], v[80:83]
    buffer_load_dwordx4 v1, s[8:11], s26 offen offset:1024 sc1 lds
    ds_read_b128 v[100:103], v5 offset:3072
    s_waitcnt lgkmcnt(4)
    v_mfma_f32_16x16x32_bf16 v[48:51], v[108:111], v[120:123], v[48:51]
    v_mfma_f32_16x16x32_bf16 v[84:87], v[108:111], v[124:127], v[84:87]
    ds_read_b128 v[104:107], v5 offset:4096
    s_waitcnt vmcnt(13) lgkmcnt(4)
    v_mfma_f32_16x16x32_bf16 v[16:19], v[88:91], v[128:131], v[16:19]
    v_mfma_f32_16x16x32_bf16 v[52:55], v[88:91], v[132:135], v[52:55]
    buffer_load_dwordx4 v1, s[8:11], s26 offen offset:2048 sc1 lds
    ds_read_b128 v[108:111], v5 offset:5120
    s_waitcnt lgkmcnt(4)
    v_mfma_f32_16x16x32_bf16 v[20:23], v[92:95], v[128:131], v[20:23]
    v_mfma_f32_16x16x32_bf16 v[56:59], v[92:95], v[132:135], v[56:59]
    ds_read_b128 v[88:91], v5 offset:6144
    s_waitcnt lgkmcnt(4)
    v_mfma_f32_16x16x32_bf16 v[24:27], v[96:99], v[128:131], v[24:27]
    v_mfma_f32_16x16x32_bf16 v[60:63], v[96:99], v[132:135], v[60:63]
    buffer_load_dwordx4 v1, s[8:11], s26 offen offset:3072 sc1 lds
    ds_read_b128 v[92:95], v5 offset:7168
    s_waitcnt lgkmcnt(4)
    v_mfma_f32_16x16x32_bf16 v[28:31], v[100:103], v[128:131], v[28:31]
    v_mfma_f32_16x16x32_bf16 v[64:67], v[100:103], v[132:135], v[64:67]
    ds_read_b128 v[96:99], v5 offset:8192
    s_waitcnt lgkmcnt(4)
    v_mfma_f32_16x16x32_bf16 v[32:35], v[104:107], v[128:131], v[32:35]
    v_mfma_f32_16x16x32_bf16 v[68:71], v[104:107], v[132:135], v[68:71]
    s_add_u32 m0, m0, 4096
    s_add_u32 s26, s26, 4096
    s_mov_b64 exec, s[22:23]
    buffer_load_dwordx4 v1, s[8:11], s26 offen sc1 lds
    s_mov_b64 exec, -1
    ds_read_b128 v[100:103], v5 offset:18432
    s_waitcnt lgkmcnt(4)
    v_mfma_f32_16x16x32_bf16 v[36:39], v[108:111], v[128:131], v[36:39]
    v_mfma_f32_16x16x32_bf16 v[72:75], v[108:111], v[132:135], v[72:75]
    ds_read_b128 v[104:107], v5 offset:19456
    s_waitcnt lgkmcnt(4)
    v_mfma_f32_16x16x32_bf16 v[40:43], v[88:91], v[128:131], v[40:43]
    v_mfma_f32_16x16x32_bf16 v[76:79], v[88:91], v[132:135], v[76:79]
    buffer_load_dwordx4 v[160:163], v1, s[12:15], s38 offen offset:2048 sc1
    ds_read_b128 v[108:111], v5 offset:20480
    s_waitcnt lgkmcnt(4)
    v_mfma_f32_16x16x32_bf16 v[44:47], v[92:95], v[128:131], v[44:47]
    v_mfma_f32_16x16x32_bf16 v[80:83], v[92:95], v[132:135], v[80:83]
    ds_read_b128 v[88:91], v5 offset:21504
    s_waitcnt lgkmcnt(4)
    v_mfma_f32_16x16x32_bf16 v[48:51], v[96:99], v[128:131], v[48:51]
    v_mfma_f32_16x16x32_bf16 v[84:87], v[96:99], v[132:135], v[84:87]
    buffer_load_dwordx4 v[164:167], v1, s[12:15], s39 offen offset:2048 sc1
    ds_read_b128 v[92:95], v5 offset:22528
    s_waitcnt vmcnt(16) lgkmcnt(4)
    v_mfma_f32_16x16x32_bf16 v[16:19], v[100:103], v[136:139], v[16:19]
    v_mfma_f32_16x16x32_bf16 v[52:55], v[100:103], v[140:143], v[52:55]
    ds_read_b128 v[96:99], v5 offset:23552
    s_waitcnt lgkmcnt(4)
    v_mfma_f32_16x16x32_bf16 v[20:23], v[104:107], v[136:139], v[20:23]
    v_mfma_f32_16x16x32_bf16 v[56:59], v[104:107], v[140:143], v[56:59]
    buffer_load_dwordx4 v[168:171], v1, s[12:15], s38 offen offset:3072 sc1
    ds_read_b128 v[100:103], v5 offset:24576
    s_waitcnt lgkmcnt(4)
    v_mfma_f32_16x16x32_bf16 v[24:27], v[108:111], v[136:139], v[24:27]
    v_mfma_f32_16x16x32_bf16 v[60:63], v[108:111], v[140:143], v[60:63]
    ds_read_b128 v[104:107], v5 offset:25600
    s_waitcnt lgkmcnt(4)
    v_mfma_f32_16x16x32_bf16 v[28:31], v[88:91], v[136:139], v[28:31]
    v_mfma_f32_16x16x32_bf16 v[64:67], v[88:91], v[140:143], v[64:67]
    buffer_load_dwordx4 v[172:175], v1, s[12:15], s39 offen offset:3072 sc1
    ds_read_b128 v[108:111], v5 offset:26624
    s_waitcnt lgkmcnt(4)
    v_mfma_f32_16x16x32_bf16 v[32:35], v[92:95], v[136:139], v[32:35]
    v_mfma_f32_16x16x32_bf16 v[68:71], v[92:95], v[140:143], v[68:71]
    s_waitcnt vmcnt(13)
    s_barrier
    ds_read_b128 v[88:91], v6 offset:0
    s_waitcnt lgkmcnt(4)
    v_mfma_f32_16x16x32_bf16 v[36:39], v[96:99], v[136:139], v[36:39]
    v_mfma_f32_16x16x32_bf16 v[72:75], v[96:99], v[140:143], v[72:75]
    s_add_u32 m0, s21, 0
    s_add_u32 s26, s33, s21
    s_add_u32 s26, s26, 147456
    buffer_load_dwordx4 v1, s[8:11], s26 offen offset:0 sc1 lds
    ds_read_b128 v[92:95], v6 offset:1024
    s_waitcnt lgkmcnt(4)
    v_mfma_f32_16x16x32_bf16 v[40:43], v[100:103], v[136:139], v[40:43]
    v_mfma_f32_16x16x32_bf16 v[76:79], v[100:103], v[140:143], v[76:79]
    buffer_load_dwordx4 v1, s[8:11], s26 offen offset:1024 sc1 lds
    ds_read_b128 v[96:99], v6 offset:2048
    s_waitcnt lgkmcnt(4)
    v_mfma_f32_16x16x32_bf16 v[44:47], v[104:107], v[136:139], v[44:47]
    v_mfma_f32_16x16x32_bf16 v[80:83], v[104:107], v[140:143], v[80:83]
    s_add_u32 m0, m0, 2048
    s_add_u32 s26, s26, 2048
    s_mov_b64 exec, s[24:25]
    buffer_load_dwordx4 v1, s[8:11], s26 offen sc1 lds
    s_mov_b64 exec, -1
    ds_read_b128 v[100:103], v6 offset:3072
    s_waitcnt lgkmcnt(4)
    v_mfma_f32_16x16x32_bf16 v[48:51], v[108:111], v[136:139], v[48:51]
    v_mfma_f32_16x16x32_bf16 v[84:87], v[108:111], v[140:143], v[84:87]
    ds_read_b128 v[104:107], v6 offset:4096
    s_waitcnt vmcnt(14) lgkmcnt(4)
    v_mfma_f32_16x16x32_bf16 v[16:19], v[88:91], v[144:147], v[16:19]
    v_mfma_f32_16x16x32_bf16 v[52:55], v[88:91], v[148:151], v[52:55]
    s_add_u32 s38, s38, 4096
    buffer_load_dwordx4 v[112:115], v1, s[12:15], s38 offen offset:0 sc1
    ds_read_b128 v[108:111], v6 offset:5120
    s_waitcnt lgkmcnt(4)
    v_mfma_f32_16x16x32_bf16 v[20:23], v[92:95], v[144:147], v[20:23]
    v_mfma_f32_16x16x32_bf16 v[56:59], v[92:95], v[148:151], v[56:59]
    ds_read_b128 v[88:91], v6 offset:6144
    s_waitcnt lgkmcnt(4)
    v_mfma_f32_16x16x32_bf16 v[24:27], v[96:99], v[144:147], v[24:27]
    v_mfma_f32_16x16x32_bf16 v[60:63], v[96:99], v[148:151], v[60:63]
    s_add_u32 s39, s39, 4096
    buffer_load_dwordx4 v[116:119], v1, s[12:15], s39 offen offset:0 sc1
    ds_read_b128 v[92:95], v6 offset:7168
    s_waitcnt lgkmcnt(4)
    v_mfma_f32_16x16x32_bf16 v[28:31], v[100:103], v[144:147], v[28:31]
    v_mfma_f32_16x16x32_bf16 v[64:67], v[100:103], v[148:151], v[64:67]
    ds_read_b128 v[96:99], v6 offset:8192
    s_waitcnt lgkmcnt(4)
    v_mfma_f32_16x16x32_bf16 v[32:35], v[104:107], v[144:147], v[32:35]
    v_mfma_f32_16x16x32_bf16 v[68:71], v[104:107], v[148:151], v[68:71]
    s_cmp_lg_u32 s79, 0
    s_cbranch_scc1 Lm29_qc0
    s_cmp_ge_u32 s16, 3
    s_cbranch_scc1 Lm29_qc0
    buffer_load_dword v176, v11, s[8:11], s42 offen sc1
    s_add_u32 s42, s42, 6912
    buffer_load_dword v177, v11, s[8:11], s42 offen sc1
    s_add_u32 s42, s42, 6912
    buffer_load_dword v178, v11, s[8:11], s42 offen sc1
    s_add_u32 s42, s42, 6912
    buffer_load_dword v179, v11, s[8:11], s42 offen sc1
    s_add_u32 s42, s42, 6912
    buffer_load_dword v180, v11, s[8:11], s42 offen sc1
    s_add_u32 s42, s42, 6912
    buffer_load_dword v181, v11, s[8:11], s42 offen sc1
    s_add_u32 s42, s42, 6912
    buffer_load_dword v182, v11, s[8:11], s42 offen sc1
    s_add_u32 s42, s42, 6912
    buffer_load_dword v183, v11, s[8:11], s42 offen sc1
    s_add_u32 s42, s42, 6912
    buffer_load_dword v184, v11, s[8:11], s42 offen sc1
    s_add_u32 s42, s42, 6912
    buffer_load_dword v185, v11, s[8:11], s42 offen sc1
    s_add_u32 s42, s42, 6912
    buffer_load_dword v186, v11, s[8:11], s42 offen sc1
    s_add_u32 s42, s42, 6912
    buffer_load_dword v187, v11, s[8:11], s42 offen sc1
    s_add_u32 s42, s42, 6912
    buffer_load_dword v188, v11, s[8:11], s42 offen sc1
    s_add_u32 s42, s42, 6912
    buffer_load_dword v189, v11, s[8:11], s42 offen sc1
    s_add_u32 s42, s42, 6912
    buffer_load_dword v190, v11, s[8:11], s42 offen sc1
    s_add_u32 s42, s42, 6912
    buffer_load_dword v191, v11, s[8:11], s42 offen sc1
    s_add_u32 s42, s42, 6912
    buffer_load_dword v192, v11, s[8:11], s42 offen sc1
    s_add_u32 s42, s42, 6912
    buffer_load_dword v193, v11, s[8:11], s42 offen sc1
    s_add_u32 s42, s42, 6912
Lm29_qc0:
    ds_read_b128 v[100:103], v6 offset:18432
    s_waitcnt lgkmcnt(4)
    v_mfma_f32_16x16x32_bf16 v[36:39], v[108:111], v[144:147], v[36:39]
    v_mfma_f32_16x16x32_bf16 v[72:75], v[108:111], v[148:151], v[72:75]
    ds_read_b128 v[104:107], v6 offset:19456
    s_waitcnt lgkmcnt(4)
    v_mfma_f32_16x16x32_bf16 v[40:43], v[88:91], v[144:147], v[40:43]
    v_mfma_f32_16x16x32_bf16 v[76:79], v[88:91], v[148:151], v[76:79]
    buffer_load_dwordx2 v[196:197], v12, s[12:15], s41 offen offset:0 sc1
    ds_read_b128 v[108:111], v6 offset:20480
    s_waitcnt lgkmcnt(4)
    v_mfma_f32_16x16x32_bf16 v[44:47], v[92:95], v[144:147], v[44:47]
    v_mfma_f32_16x16x32_bf16 v[80:83], v[92:95], v[148:151], v[80:83]
    ds_read_b128 v[88:91], v6 offset:21504
    s_waitcnt lgkmcnt(4)
    v_mfma_f32_16x16x32_bf16 v[48:51], v[96:99], v[144:147], v[48:51]
    v_mfma_f32_16x16x32_bf16 v[84:87], v[96:99], v[148:151], v[84:87]
    buffer_load_dwordx2 v[198:199], v12, s[12:15], s41 offen offset:512 sc1
    ds_read_b128 v[92:95], v6 offset:22528
    s_waitcnt vmcnt(16) lgkmcnt(4)
    v_mfma_f32_16x16x32_bf16 v[16:19], v[100:103], v[152:155], v[16:19]
    v_mfma_f32_16x16x32_bf16 v[52:55], v[100:103], v[156:159], v[52:55]
    ds_read_b128 v[96:99], v6 offset:23552
    s_waitcnt lgkmcnt(4)
    v_mfma_f32_16x16x32_bf16 v[20:23], v[104:107], v[152:155], v[20:23]
    v_mfma_f32_16x16x32_bf16 v[56:59], v[104:107], v[156:159], v[56:59]
    buffer_load_dwordx2 v[200:201], v12, s[12:15], s41 offen offset:1024 sc1
    ds_read_b128 v[100:103], v6 offset:24576
    s_waitcnt lgkmcnt(4)
    v_mfma_f32_16x16x32_bf16 v[24:27], v[108:111], v[152:155], v[24:27]
    v_mfma_f32_16x16x32_bf16 v[60:63], v[108:111], v[156:159], v[60:63]
    ds_read_b128 v[104:107], v6 offset:25600
    s_waitcnt lgkmcnt(4)
    v_mfma_f32_16x16x32_bf16 v[28:31], v[88:91], v[152:155], v[28:31]
    v_mfma_f32_16x16x32_bf16 v[64:67], v[88:91], v[156:159], v[64:67]
    buffer_load_dwordx2 v[202:203], v12, s[12:15], s41 offen offset:1536 sc1
    ds_read_b128 v[108:111], v6 offset:26624
    s_waitcnt lgkmcnt(4)
    v_mfma_f32_16x16x32_bf16 v[32:35], v[92:95], v[152:155], v[32:35]
    v_mfma_f32_16x16x32_bf16 v[68:71], v[92:95], v[156:159], v[68:71]
    s_waitcnt vmcnt(13)
    s_barrier
    ds_read_b128 v[88:91], v7 offset:0
    s_waitcnt lgkmcnt(4)
    v_mfma_f32_16x16x32_bf16 v[36:39], v[96:99], v[152:155], v[36:39]
    v_mfma_f32_16x16x32_bf16 v[72:75], v[96:99], v[156:159], v[72:75]
    ds_read_b128 v[92:95], v7 offset:1024
    s_waitcnt lgkmcnt(4)
    v_mfma_f32_16x16x32_bf16 v[40:43], v[100:103], v[152:155], v[40:43]
    v_mfma_f32_16x16x32_bf16 v[76:79], v[100:103], v[156:159], v[76:79]
    ds_read_b128 v[96:99], v7 offset:2048
    s_waitcnt lgkmcnt(4)
    v_mfma_f32_16x16x32_bf16 v[44:47], v[104:107], v[152:155], v[44:47]
    v_mfma_f32_16x16x32_bf16 v[80:83], v[104:107], v[156:159], v[80:83]
    ds_read_b128 v[100:103], v7 offset:3072
    s_waitcnt lgkmcnt(4)
    v_mfma_f32_16x16x32_bf16 v[48:51], v[108:111], v[152:155], v[48:51]
    v_mfma_f32_16x16x32_bf16 v[84:87], v[108:111], v[156:159], v[84:87]
    ds_read_b128 v[104:107], v7 offset:4096
    s_waitcnt vmcnt(11) lgkmcnt(4)
    v_mfma_f32_16x16x32_bf16 v[16:19], v[88:91], v[160:163], v[16:19]
    v_mfma_f32_16x16x32_bf16 v[52:55], v[88:91], v[164:167], v[52:55]
    ds_read_b128 v[108:111], v7 offset:5120
    s_waitcnt lgkmcnt(4)
    v_mfma_f32_16x16x32_bf16 v[20:23], v[92:95], v[160:163], v[20:23]
    v_mfma_f32_16x16x32_bf16 v[56:59], v[92:95], v[164:167], v[56:59]
    ds_read_b128 v[88:91], v7 offset:6144
    s_waitcnt lgkmcnt(4)
    v_mfma_f32_16x16x32_bf16 v[24:27], v[96:99], v[160:163], v[24:27]
    v_mfma_f32_16x16x32_bf16 v[60:63], v[96:99], v[164:167], v[60:63]
    ds_read_b128 v[92:95], v7 offset:7168
    s_waitcnt lgkmcnt(4)
    v_mfma_f32_16x16x32_bf16 v[28:31], v[100:103], v[160:163], v[28:31]
    v_mfma_f32_16x16x32_bf16 v[64:67], v[100:103], v[164:167], v[64:67]
    ds_read_b128 v[96:99], v7 offset:8192
    s_waitcnt lgkmcnt(4)
    v_mfma_f32_16x16x32_bf16 v[32:35], v[104:107], v[160:163], v[32:35]
    v_mfma_f32_16x16x32_bf16 v[68:71], v[104:107], v[164:167], v[68:71]
    ds_read_b128 v[100:103], v7 offset:18432
    s_waitcnt lgkmcnt(4)
    v_mfma_f32_16x16x32_bf16 v[36:39], v[108:111], v[160:163], v[36:39]
    v_mfma_f32_16x16x32_bf16 v[72:75], v[108:111], v[164:167], v[72:75]
    ds_read_b128 v[104:107], v7 offset:19456
    s_waitcnt lgkmcnt(4)
    v_mfma_f32_16x16x32_bf16 v[40:43], v[88:91], v[160:163], v[40:43]
    v_mfma_f32_16x16x32_bf16 v[76:79], v[88:91], v[164:167], v[76:79]
    ds_read_b128 v[108:111], v7 offset:20480
    s_waitcnt lgkmcnt(4)
    v_mfma_f32_16x16x32_bf16 v[44:47], v[92:95], v[160:163], v[44:47]
    v_mfma_f32_16x16x32_bf16 v[80:83], v[92:95], v[164:167], v[80:83]
    ds_read_b128 v[88:91], v7 offset:21504
    s_waitcnt lgkmcnt(4)
    v_mfma_f32_16x16x32_bf16 v[48:51], v[96:99], v[160:163], v[48:51]
    v_mfma_f32_16x16x32_bf16 v[84:87], v[96:99], v[164:167], v[84:87]
    ds_read_b128 v[92:95], v7 offset:22528
    s_waitcnt vmcnt(9) lgkmcnt(4)
    v_mfma_f32_16x16x32_bf16 v[16:19], v[100:103], v[168:171], v[16:19]
    v_mfma_f32_16x16x32_bf16 v[52:55], v[100:103], v[172:175], v[52:55]
    ds_read_b128 v[96:99], v7 offset:23552
    s_waitcnt lgkmcnt(4)
    v_mfma_f32_16x16x32_bf16 v[20:23], v[104:107], v[168:171], v[20:23]
    v_mfma_f32_16x16x32_bf16 v[56:59], v[104:107], v[172:175], v[56:59]
    ds_read_b128 v[100:103], v7 offset:24576
    s_waitcnt lgkmcnt(4)
    v_mfma_f32_16x16x32_bf16 v[24:27], v[108:111], v[168:171], v[24:27]
    v_mfma_f32_16x16x32_bf16 v[60:63], v[108:111], v[172:175], v[60:63]
    ds_read_b128 v[104:107], v7 offset:25600
    s_waitcnt lgkmcnt(4)
    v_mfma_f32_16x16x32_bf16 v[28:31], v[88:91], v[168:171], v[28:31]
    v_mfma_f32_16x16x32_bf16 v[64:67], v[88:91], v[172:175], v[64:67]
    ds_read_b128 v[108:111], v7 offset:26624
    s_waitcnt lgkmcnt(4)
    v_mfma_f32_16x16x32_bf16 v[32:35], v[92:95], v[168:171], v[32:35]
    v_mfma_f32_16x16x32_bf16 v[68:71], v[92:95], v[172:175], v[68:71]
    s_waitcnt vmcnt(6)
    s_waitcnt vmcnt(0)
    v_add_f32 v176, v176, v177
    v_add_f32 v176, v176, v178
    v_add_f32 v176, v176, v179
    v_add_f32 v176, v176, v180
    v_add_f32 v176, v176, v181
    v_add_f32 v176, v176, v182
    v_add_f32 v176, v176, v183
    v_add_f32 v176, v176, v184
    v_add_f32 v176, v176, v185
    v_add_f32 v176, v176, v186
    v_add_f32 v176, v176, v187
    v_add_f32 v176, v176, v188
    v_add_f32 v176, v176, v189
    v_add_f32 v176, v176, v190
    v_add_f32 v176, v176, v191
    v_add_f32 v176, v176, v192
    v_add_f32 v176, v176, v193
    ds_write_b32 v10, v176
    v_add_f32 v196, v196, v198
    v_add_f32 v197, v197, v199
    v_add_f32 v196, v196, v200
    v_add_f32 v197, v197, v201
    v_add_f32 v196, v196, v202
    v_add_f32 v197, v197, v203
    v_mov_b32 v198, v196
    v_mov_b32 v199, v197
    s_nop 0
    v_permlane32_swap_b32 v196, v198
    v_permlane32_swap_b32 v197, v199
    v_add_f32 v196, v196, v198
    v_add_f32 v197, v197, v199
    v_mov_b32 v198, v196
    v_mov_b32 v199, v197
    s_nop 0
    v_permlane16_swap_b32 v196, v198
    v_permlane16_swap_b32 v197, v199
    v_add_f32 v196, v196, v198
    v_add_f32 v197, v197, v199
    v_mul_f32 v12, 0x3ae38e39, v196
    v_mul_f32 v14, 0x3ae38e39, v197
    v_fma_f32 v14, -v12, v12, v14
    v_max_f32 v14, 0, v14
    v_add_f32 v14, 0x3727c5ac, v14
    v_rsq_f32 v13, v14
    s_waitcnt lgkmcnt(0)
    s_barrier
    ds_read_b128 v[88:91], v4 offset:0
    v_mfma_f32_16x16x32_bf16 v[36:39], v[96:99], v[168:171], v[36:39]
    v_mfma_f32_16x16x32_bf16 v[72:75], v[96:99], v[172:175], v[72:75]
    ds_read_b128 v[92:95], v4 offset:1024
    v_mfma_f32_16x16x32_bf16 v[40:43], v[100:103], v[168:171], v[40:43]
    v_mfma_f32_16x16x32_bf16 v[76:79], v[100:103], v[172:175], v[76:79]
    ds_read_b128 v[96:99], v4 offset:2048
    v_mfma_f32_16x16x32_bf16 v[44:47], v[104:107], v[168:171], v[44:47]
    v_mfma_f32_16x16x32_bf16 v[80:83], v[104:107], v[172:175], v[80:83]
    ds_read_b128 v[100:103], v4 offset:3072
    v_mfma_f32_16x16x32_bf16 v[48:51], v[108:111], v[168:171], v[48:51]
    v_mfma_f32_16x16x32_bf16 v[84:87], v[108:111], v[172:175], v[84:87]
    ds_read_b128 v[104:107], v4 offset:4096
    s_waitcnt lgkmcnt(4)
    v_mfma_f32_16x16x32_bf16 v[16:19], v[88:91], v[112:115], v[16:19]
    v_mfma_f32_16x16x32_bf16 v[52:55], v[88:91], v[116:119], v[52:55]
    ds_read_b128 v[108:111], v4 offset:5120
    s_waitcnt lgkmcnt(4)
    v_mfma_f32_16x16x32_bf16 v[20:23], v[92:95], v[112:115], v[20:23]
    v_mfma_f32_16x16x32_bf16 v[56:59], v[92:95], v[116:119], v[56:59]
    ds_read_b128 v[88:91], v4 offset:6144
    s_waitcnt lgkmcnt(4)
    v_mfma_f32_16x16x32_bf16 v[24:27], v[96:99], v[112:115], v[24:27]
    v_mfma_f32_16x16x32_bf16 v[60:63], v[96:99], v[116:119], v[60:63]
    ds_read_b128 v[92:95], v4 offset:7168
    s_waitcnt lgkmcnt(4)
    v_mfma_f32_16x16x32_bf16 v[28:31], v[100:103], v[112:115], v[28:31]
    v_mfma_f32_16x16x32_bf16 v[64:67], v[100:103], v[116:119], v[64:67]
    ds_read_b128 v[96:99], v4 offset:8192
    s_waitcnt lgkmcnt(4)
    v_mfma_f32_16x16x32_bf16 v[32:35], v[104:107], v[112:115], v[32:35]
    v_mfma_f32_16x16x32_bf16 v[68:71], v[104:107], v[116:119], v[68:71]
    s_waitcnt lgkmcnt(3)
    v_mfma_f32_16x16x32_bf16 v[36:39], v[108:111], v[112:115], v[36:39]
    v_mfma_f32_16x16x32_bf16 v[72:75], v[108:111], v[116:119], v[72:75]
    s_waitcnt lgkmcnt(2)
    v_mfma_f32_16x16x32_bf16 v[40:43], v[88:91], v[112:115], v[40:43]
    v_mfma_f32_16x16x32_bf16 v[76:79], v[88:91], v[116:119], v[76:79]
    s_waitcnt lgkmcnt(1)
    v_mfma_f32_16x16x32_bf16 v[44:47], v[92:95], v[112:115], v[44:47]
    v_mfma_f32_16x16x32_bf16 v[80:83], v[92:95], v[116:119], v[80:83]
    s_waitcnt lgkmcnt(0)
    v_mfma_f32_16x16x32_bf16 v[48:51], v[96:99], v[112:115], v[48:51]
    v_mfma_f32_16x16x32_bf16 v[84:87], v[96:99], v[116:119], v[84:87]
    v_lshlrev_b32 v8, 4, v3
    v_add_u32 v8, 147456, v8
    ds_read_b128 v[204:207], v8 offset:0
    ds_read_b128 v[208:211], v8 offset:64
    ds_read_b128 v[212:215], v8 offset:128
    ds_read_b128 v[216:219], v8 offset:192
    ds_read_b128 v[220:223], v8 offset:256
    ds_read_b128 v[224:227], v8 offset:320
    ds_read_b128 v[228:231], v8 offset:384
    ds_read_b128 v[232:235], v8 offset:448
    ds_read_b128 v[236:239], v8 offset:512
    s_mul_i32 s26, s16, 9216
    s_add_u32 s26, s26, 36864
    v_add_u32 v8, s26, v1
    s_xor_b32 s26, s16, 4
    s_mul_i32 s26, s26, 9216
    s_add_u32 s26, s26, 36864
    v_add_u32 v9, s26, v1
    ds_write_b128 v8, v[52:55] offset:0
    ds_write_b128 v8, v[56:59] offset:1024
    ds_write_b128 v8, v[60:63] offset:2048
    ds_write_b128 v8, v[64:67] offset:3072
    ds_write_b128 v8, v[68:71] offset:4096
    ds_write_b128 v8, v[72:75] offset:5120
    ds_write_b128 v8, v[76:79] offset:6144
    ds_write_b128 v8, v[80:83] offset:7168
    ds_write_b128 v8, v[84:87] offset:8192
    s_mov_b32 s42, 0x3eae1a93
    s_cmp_lt_u32 s32, 4
    s_cselect_b32 s42, s42, 1.0
    s_cselect_b32 s43, 5505024, 0
    s_cselect_b32 s44, 9699328, 0
    s_cselect_b32 s45, 0, 7602176
    s_cselect_b32 s46, 0, 9961472
    s_add_u32 s43, s43, s45
    s_add_u32 s44, s44, s46
    s_and_b32 s45, s32, 3
    s_lshl_b32 s46, s45, 19
    s_add_u32 s43, s43, s46
    s_lshr_b32 s46, s36, 1
    s_lshl_b32 s46, s46, 10
    s_add_u32 s43, s43, s46
    s_and_b32 s46, s36, 1
    s_lshl_b32 s46, s46, 8
    s_add_u32 s43, s43, s46
    v_lshrrev_b32 v11, 1, v3
    v_lshlrev_b32 v11, 16, v11
    v_and_b32 v10, 1, v3
    v_lshl_add_u32 v11, v10, 9, v11
    v_lshl_add_u32 v11, v2, 4, v11
    s_lshl_b32 s46, s45, 16
    s_add_u32 s44, s44, s46
    s_lshl_b32 s46, s36, 7
    s_add_u32 s44, s44, s46
    v_lshlrev_b32 v10, 14, v3
    v_lshl_add_u32 v10, v2, 3, v10
    v_mul_f32 v13, s42, v13
    s_waitcnt lgkmcnt(15)
    v_fma_f32 v16, -v12, v204, v16
    v_mul_f32 v16, v13, v16
    v_fma_f32 v17, -v12, v205, v17
    v_mul_f32 v17, v13, v17
    v_fma_f32 v18, -v12, v206, v18
    v_mul_f32 v18, v13, v18
    v_fma_f32 v19, -v12, v207, v19
    v_mul_f32 v19, v13, v19
    v_fma_f32 v20, -v12, v208, v20
    v_mul_f32 v20, v13, v20
    v_fma_f32 v21, -v12, v209, v21
    v_mul_f32 v21, v13, v21
    v_fma_f32 v22, -v12, v210, v22
    v_mul_f32 v22, v13, v22
    v_fma_f32 v23, -v12, v211, v23
    v_mul_f32 v23, v13, v23
    v_fma_f32 v24, -v12, v212, v24
    v_mul_f32 v24, v13, v24
    v_fma_f32 v25, -v12, v213, v25
    v_mul_f32 v25, v13, v25
    v_fma_f32 v26, -v12, v214, v26
    v_mul_f32 v26, v13, v26
    v_fma_f32 v27, -v12, v215, v27
    v_mul_f32 v27, v13, v27
    s_waitcnt lgkmcnt(14)
    v_fma_f32 v28, -v12, v216, v28
    v_mul_f32 v28, v13, v28
    v_fma_f32 v29, -v12, v217, v29
    v_mul_f32 v29, v13, v29
    v_fma_f32 v30, -v12, v218, v30
    v_mul_f32 v30, v13, v30
    v_fma_f32 v31, -v12, v219, v31
    v_mul_f32 v31, v13, v31
    s_waitcnt lgkmcnt(13)
    v_fma_f32 v32, -v12, v220, v32
    v_mul_f32 v32, v13, v32
    v_fma_f32 v33, -v12, v221, v33
    v_mul_f32 v33, v13, v33
    v_fma_f32 v34, -v12, v222, v34
    v_mul_f32 v34, v13, v34
    v_fma_f32 v35, -v12, v223, v35
    v_mul_f32 v35, v13, v35
    s_waitcnt lgkmcnt(12)
    v_fma_f32 v36, -v12, v224, v36
    v_mul_f32 v36, v13, v36
    v_fma_f32 v37, -v12, v225, v37
    v_mul_f32 v37, v13, v37
    v_fma_f32 v38, -v12, v226, v38
    v_mul_f32 v38, v13, v38
    v_fma_f32 v39, -v12, v227, v39
    v_mul_f32 v39, v13, v39
    s_waitcnt lgkmcnt(11)
    v_fma_f32 v40, -v12, v228, v40
    v_mul_f32 v40, v13, v40
    v_fma_f32 v41, -v12, v229, v41
    v_mul_f32 v41, v13, v41
    v_fma_f32 v42, -v12, v230, v42
    v_mul_f32 v42, v13, v42
    v_fma_f32 v43, -v12, v231, v43
    v_mul_f32 v43, v13, v43
    s_waitcnt lgkmcnt(10)
    v_fma_f32 v44, -v12, v232, v44
    v_mul_f32 v44, v13, v44
    v_fma_f32 v45, -v12, v233, v45
    v_mul_f32 v45, v13, v45
    v_fma_f32 v46, -v12, v234, v46
    v_mul_f32 v46, v13, v46
    v_fma_f32 v47, -v12, v235, v47
    v_mul_f32 v47, v13, v47
    s_waitcnt lgkmcnt(9)
    v_fma_f32 v48, -v12, v236, v48
    v_mul_f32 v48, v13, v48
    v_fma_f32 v49, -v12, v237, v49
    v_mul_f32 v49, v13, v49
    v_fma_f32 v50, -v12, v238, v50
    v_mul_f32 v50, v13, v50
    v_fma_f32 v51, -v12, v239, v51
    v_mul_f32 v51, v13, v51
    s_waitcnt lgkmcnt(0)
    s_barrier
    ds_read_b128 v[52:55], v9 offset:0
    ds_read_b128 v[56:59], v9 offset:1024
    ds_read_b128 v[60:63], v9 offset:2048
    ds_read_b128 v[64:67], v9 offset:3072
    ds_read_b128 v[68:71], v9 offset:4096
    ds_read_b128 v[72:75], v9 offset:5120
    ds_read_b128 v[76:79], v9 offset:6144
    ds_read_b128 v[80:83], v9 offset:7168
    ds_read_b128 v[84:87], v9 offset:8192
    s_waitcnt lgkmcnt(8)
    v_fmac_f32 v16, v13, v52
    v_fmac_f32 v17, v13, v53
    v_fmac_f32 v18, v13, v54
    v_fmac_f32 v19, v13, v55
    v_cvt_pk_bf16_f32 v88, v16, v17
    v_cvt_pk_bf16_f32 v89, v18, v19
    s_waitcnt lgkmcnt(7)
    v_fmac_f32 v20, v13, v56
    v_fmac_f32 v21, v13, v57
    v_fmac_f32 v22, v13, v58
    v_fmac_f32 v23, v13, v59
    v_cvt_pk_bf16_f32 v90, v20, v21
    v_cvt_pk_bf16_f32 v91, v22, v23
    buffer_store_dwordx4 v[88:91], v11, s[12:15], s43 offen sc1
    s_add_u32 s43, s43, 131072
    s_waitcnt lgkmcnt(6)
    v_fmac_f32 v24, v13, v60
    v_fmac_f32 v25, v13, v61
    v_fmac_f32 v26, v13, v62
    v_fmac_f32 v27, v13, v63
    v_cvt_pk_bf16_f32 v92, v24, v25
    v_cvt_pk_bf16_f32 v93, v26, v27
    s_waitcnt lgkmcnt(5)
    v_fmac_f32 v28, v13, v64
    v_fmac_f32 v29, v13, v65
    v_fmac_f32 v30, v13, v66
    v_fmac_f32 v31, v13, v67
    v_cvt_pk_bf16_f32 v94, v28, v29
    v_cvt_pk_bf16_f32 v95, v30, v31
    buffer_store_dwordx4 v[92:95], v11, s[12:15], s43 offen sc1
    s_add_u32 s43, s43, 131072
    s_waitcnt lgkmcnt(4)
    v_fmac_f32 v32, v13, v68
    v_fmac_f32 v33, v13, v69
    v_fmac_f32 v34, v13, v70
    v_fmac_f32 v35, v13, v71
    v_cvt_pk_bf16_f32 v96, v32, v33
    v_cvt_pk_bf16_f32 v97, v34, v35
    s_waitcnt lgkmcnt(3)
    v_fmac_f32 v36, v13, v72
    v_fmac_f32 v37, v13, v73
    v_fmac_f32 v38, v13, v74
    v_fmac_f32 v39, v13, v75
    v_cvt_pk_bf16_f32 v98, v36, v37
    v_cvt_pk_bf16_f32 v99, v38, v39
    buffer_store_dwordx4 v[96:99], v11, s[12:15], s43 offen sc1
    s_add_u32 s43, s43, 131072
    s_waitcnt lgkmcnt(2)
    v_fmac_f32 v40, v13, v76
    v_fmac_f32 v41, v13, v77
    v_fmac_f32 v42, v13, v78
    v_fmac_f32 v43, v13, v79
    v_cvt_pk_bf16_f32 v100, v40, v41
    v_cvt_pk_bf16_f32 v101, v42, v43
    s_waitcnt lgkmcnt(1)
    v_fmac_f32 v44, v13, v80
    v_fmac_f32 v45, v13, v81
    v_fmac_f32 v46, v13, v82
    v_fmac_f32 v47, v13, v83
    v_cvt_pk_bf16_f32 v102, v44, v45
    v_cvt_pk_bf16_f32 v103, v46, v47
    buffer_store_dwordx4 v[100:103], v11, s[12:15], s43 offen sc1
    s_add_u32 s43, s43, 131072
    s_waitcnt lgkmcnt(0)
    v_fmac_f32 v48, v13, v84
    v_fmac_f32 v49, v13, v85
    v_fmac_f32 v50, v13, v86
    v_fmac_f32 v51, v13, v87
    v_cvt_pk_bf16_f32 v104, v48, v49
    v_cvt_pk_bf16_f32 v105, v50, v51
    buffer_store_dwordx2 v[104:105], v10, s[12:15], s44 offen sc1
    s_branch Lm22_qpub
Lm21_qv:
    s_waitcnt vmcnt(13)
    s_barrier
    ds_read_b128 v[88:91], v4 offset:0
    ds_read_b128 v[92:95], v4 offset:1024
    ds_read_b128 v[96:99], v4 offset:2048
    ds_read_b128 v[100:103], v4 offset:3072
    ds_read_b128 v[104:107], v4 offset:4096
    s_waitcnt vmcnt(6) lgkmcnt(4)
    v_mfma_f32_16x16x32_bf16 v[16:19], v[112:115], v[88:91], 0
    v_mfma_f32_16x16x32_bf16 v[52:55], v[116:119], v[88:91], 0
    s_add_u32 m0, s20, 73728
    s_add_u32 s26, s33, s20
    s_add_u32 s26, s26, 73728
    buffer_load_dwordx4 v1, s[8:11], s26 offen offset:0 sc1 lds
    ds_read_b128 v[108:111], v4 offset:5120
    s_waitcnt lgkmcnt(4)
    v_mfma_f32_16x16x32_bf16 v[20:23], v[112:115], v[92:95], 0
    v_mfma_f32_16x16x32_bf16 v[56:59], v[116:119], v[92:95], 0
    buffer_load_dwordx4 v1, s[8:11], s26 offen offset:1024 sc1 lds
    ds_read_b128 v[88:91], v4 offset:6144
    s_waitcnt lgkmcnt(4)
    v_mfma_f32_16x16x32_bf16 v[24:27], v[112:115], v[96:99], 0
    v_mfma_f32_16x16x32_bf16 v[60:63], v[116:119], v[96:99], 0
    buffer_load_dwordx4 v1, s[8:11], s26 offen offset:2048 sc1 lds
    ds_read_b128 v[92:95], v4 offset:7168
    s_waitcnt lgkmcnt(4)
    v_mfma_f32_16x16x32_bf16 v[28:31], v[112:115], v[100:103], 0
    v_mfma_f32_16x16x32_bf16 v[64:67], v[116:119], v[100:103], 0
    buffer_load_dwordx4 v1, s[8:11], s26 offen offset:3072 sc1 lds
    ds_read_b128 v[96:99], v4 offset:8192
    s_waitcnt lgkmcnt(4)
    v_mfma_f32_16x16x32_bf16 v[32:35], v[112:115], v[104:107], 0
    v_mfma_f32_16x16x32_bf16 v[68:71], v[116:119], v[104:107], 0
    s_add_u32 m0, m0, 4096
    s_add_u32 s26, s26, 4096
    s_mov_b64 exec, s[22:23]
    buffer_load_dwordx4 v1, s[8:11], s26 offen sc1 lds
    s_mov_b64 exec, -1
    ds_read_b128 v[100:103], v4 offset:18432
    s_waitcnt lgkmcnt(4)
    v_mfma_f32_16x16x32_bf16 v[36:39], v[112:115], v[108:111], 0
    v_mfma_f32_16x16x32_bf16 v[72:75], v[116:119], v[108:111], 0
    ds_read_b128 v[104:107], v4 offset:19456
    s_waitcnt lgkmcnt(4)
    v_mfma_f32_16x16x32_bf16 v[40:43], v[112:115], v[88:91], 0
    v_mfma_f32_16x16x32_bf16 v[76:79], v[116:119], v[88:91], 0
    s_add_u32 s38, s38, 4096
    buffer_load_dwordx4 v[144:147], v1, s[12:15], s38 offen offset:0 sc1
    ds_read_b128 v[108:111], v4 offset:20480
    s_waitcnt lgkmcnt(4)
    v_mfma_f32_16x16x32_bf16 v[44:47], v[112:115], v[92:95], 0
    v_mfma_f32_16x16x32_bf16 v[80:83], v[116:119], v[92:95], 0
    ds_read_b128 v[88:91], v4 offset:21504
    s_waitcnt lgkmcnt(4)
    v_mfma_f32_16x16x32_bf16 v[48:51], v[112:115], v[96:99], 0
    v_mfma_f32_16x16x32_bf16 v[84:87], v[116:119], v[96:99], 0
    s_add_u32 s39, s39, 4096
    buffer_load_dwordx4 v[148:151], v1, s[12:15], s39 offen offset:0 sc1
    ds_read_b128 v[92:95], v4 offset:22528
    s_waitcnt vmcnt(11) lgkmcnt(4)
    v_mfma_f32_16x16x32_bf16 v[16:19], v[120:123], v[100:103], v[16:19]
    v_mfma_f32_16x16x32_bf16 v[52:55], v[124:127], v[100:103], v[52:55]
    ds_read_b128 v[96:99], v4 offset:23552
    s_waitcnt lgkmcnt(4)
    v_mfma_f32_16x16x32_bf16 v[20:23], v[120:123], v[104:107], v[20:23]
    v_mfma_f32_16x16x32_bf16 v[56:59], v[124:127], v[104:107], v[56:59]
    buffer_load_dwordx4 v[152:155], v1, s[12:15], s38 offen offset:1024 sc1
    ds_read_b128 v[100:103], v4 offset:24576
    s_waitcnt lgkmcnt(4)
    v_mfma_f32_16x16x32_bf16 v[24:27], v[120:123], v[108:111], v[24:27]
    v_mfma_f32_16x16x32_bf16 v[60:63], v[124:127], v[108:111], v[60:63]
    ds_read_b128 v[104:107], v4 offset:25600
    s_waitcnt lgkmcnt(4)
    v_mfma_f32_16x16x32_bf16 v[28:31], v[120:123], v[88:91], v[28:31]
    v_mfma_f32_16x16x32_bf16 v[64:67], v[124:127], v[88:91], v[64:67]
    buffer_load_dwordx4 v[156:159], v1, s[12:15], s39 offen offset:1024 sc1
    ds_read_b128 v[108:111], v4 offset:26624
    s_waitcnt lgkmcnt(4)
    v_mfma_f32_16x16x32_bf16 v[32:35], v[120:123], v[92:95], v[32:35]
    v_mfma_f32_16x16x32_bf16 v[68:71], v[124:127], v[92:95], v[68:71]
    s_barrier
    ds_read_b128 v[88:91], v5 offset:0
    s_waitcnt lgkmcnt(4)
    v_mfma_f32_16x16x32_bf16 v[36:39], v[120:123], v[96:99], v[36:39]
    v_mfma_f32_16x16x32_bf16 v[72:75], v[124:127], v[96:99], v[72:75]
    s_add_u32 m0, s20, 110592
    s_add_u32 s26, s33, s20
    s_add_u32 s26, s26, 110592
    buffer_load_dwordx4 v1, s[8:11], s26 offen offset:0 sc1 lds
    ds_read_b128 v[92:95], v5 offset:1024
    s_waitcnt lgkmcnt(4)
    v_mfma_f32_16x16x32_bf16 v[40:43], v[120:123], v[100:103], v[40:43]
    v_mfma_f32_16x16x32_bf16 v[76:79], v[124:127], v[100:103], v[76:79]
    ds_read_b128 v[96:99], v5 offset:2048
    s_waitcnt lgkmcnt(4)
    v_mfma_f32_16x16x32_bf16 v[44:47], v[120:123], v[104:107], v[44:47]
    v_mfma_f32_16x16x32_bf16 v[80:83], v[124:127], v[104:107], v[80:83]
    buffer_load_dwordx4 v1, s[8:11], s26 offen offset:1024 sc1 lds
    ds_read_b128 v[100:103], v5 offset:3072
    s_waitcnt lgkmcnt(4)
    v_mfma_f32_16x16x32_bf16 v[48:51], v[120:123], v[108:111], v[48:51]
    v_mfma_f32_16x16x32_bf16 v[84:87], v[124:127], v[108:111], v[84:87]
    ds_read_b128 v[104:107], v5 offset:4096
    s_waitcnt vmcnt(13) lgkmcnt(4)
    v_mfma_f32_16x16x32_bf16 v[16:19], v[128:131], v[88:91], v[16:19]
    v_mfma_f32_16x16x32_bf16 v[52:55], v[132:135], v[88:91], v[52:55]
    buffer_load_dwordx4 v1, s[8:11], s26 offen offset:2048 sc1 lds
    ds_read_b128 v[108:111], v5 offset:5120
    s_waitcnt lgkmcnt(4)
    v_mfma_f32_16x16x32_bf16 v[20:23], v[128:131], v[92:95], v[20:23]
    v_mfma_f32_16x16x32_bf16 v[56:59], v[132:135], v[92:95], v[56:59]
    ds_read_b128 v[88:91], v5 offset:6144
    s_waitcnt lgkmcnt(4)
    v_mfma_f32_16x16x32_bf16 v[24:27], v[128:131], v[96:99], v[24:27]
    v_mfma_f32_16x16x32_bf16 v[60:63], v[132:135], v[96:99], v[60:63]
    buffer_load_dwordx4 v1, s[8:11], s26 offen offset:3072 sc1 lds
    ds_read_b128 v[92:95], v5 offset:7168
    s_waitcnt lgkmcnt(4)
    v_mfma_f32_16x16x32_bf16 v[28:31], v[128:131], v[100:103], v[28:31]
    v_mfma_f32_16x16x32_bf16 v[64:67], v[132:135], v[100:103], v[64:67]
    ds_read_b128 v[96:99], v5 offset:8192
    s_waitcnt lgkmcnt(4)
    v_mfma_f32_16x16x32_bf16 v[32:35], v[128:131], v[104:107], v[32:35]
    v_mfma_f32_16x16x32_bf16 v[68:71], v[132:135], v[104:107], v[68:71]
    s_add_u32 m0, m0, 4096
    s_add_u32 s26, s26, 4096
    s_mov_b64 exec, s[22:23]
    buffer_load_dwordx4 v1, s[8:11], s26 offen sc1 lds
    s_mov_b64 exec, -1
    ds_read_b128 v[100:103], v5 offset:18432
    s_waitcnt lgkmcnt(4)
    v_mfma_f32_16x16x32_bf16 v[36:39], v[128:131], v[108:111], v[36:39]
    v_mfma_f32_16x16x32_bf16 v[72:75], v[132:135], v[108:111], v[72:75]
    ds_read_b128 v[104:107], v5 offset:19456
    s_waitcnt lgkmcnt(4)
    v_mfma_f32_16x16x32_bf16 v[40:43], v[128:131], v[88:91], v[40:43]
    v_mfma_f32_16x16x32_bf16 v[76:79], v[132:135], v[88:91], v[76:79]
    buffer_load_dwordx4 v[160:163], v1, s[12:15], s38 offen offset:2048 sc1
    ds_read_b128 v[108:111], v5 offset:20480
    s_waitcnt lgkmcnt(4)
    v_mfma_f32_16x16x32_bf16 v[44:47], v[128:131], v[92:95], v[44:47]
    v_mfma_f32_16x16x32_bf16 v[80:83], v[132:135], v[92:95], v[80:83]
    ds_read_b128 v[88:91], v5 offset:21504
    s_waitcnt lgkmcnt(4)
    v_mfma_f32_16x16x32_bf16 v[48:51], v[128:131], v[96:99], v[48:51]
    v_mfma_f32_16x16x32_bf16 v[84:87], v[132:135], v[96:99], v[84:87]
    buffer_load_dwordx4 v[164:167], v1, s[12:15], s39 offen offset:2048 sc1
    ds_read_b128 v[92:95], v5 offset:22528
    s_waitcnt vmcnt(16) lgkmcnt(4)
    v_mfma_f32_16x16x32_bf16 v[16:19], v[136:139], v[100:103], v[16:19]
    v_mfma_f32_16x16x32_bf16 v[52:55], v[140:143], v[100:103], v[52:55]
    ds_read_b128 v[96:99], v5 offset:23552
    s_waitcnt lgkmcnt(4)
    v_mfma_f32_16x16x32_bf16 v[20:23], v[136:139], v[104:107], v[20:23]
    v_mfma_f32_16x16x32_bf16 v[56:59], v[140:143], v[104:107], v[56:59]
    buffer_load_dwordx4 v[168:171], v1, s[12:15], s38 offen offset:3072 sc1
    ds_read_b128 v[100:103], v5 offset:24576
    s_waitcnt lgkmcnt(4)
    v_mfma_f32_16x16x32_bf16 v[24:27], v[136:139], v[108:111], v[24:27]
    v_mfma_f32_16x16x32_bf16 v[60:63], v[140:143], v[108:111], v[60:63]
    ds_read_b128 v[104:107], v5 offset:25600
    s_waitcnt lgkmcnt(4)
    v_mfma_f32_16x16x32_bf16 v[28:31], v[136:139], v[88:91], v[28:31]
    v_mfma_f32_16x16x32_bf16 v[64:67], v[140:143], v[88:91], v[64:67]
    buffer_load_dwordx4 v[172:175], v1, s[12:15], s39 offen offset:3072 sc1
    ds_read_b128 v[108:111], v5 offset:26624
    s_waitcnt lgkmcnt(4)
    v_mfma_f32_16x16x32_bf16 v[32:35], v[136:139], v[92:95], v[32:35]
    v_mfma_f32_16x16x32_bf16 v[68:71], v[140:143], v[92:95], v[68:71]
    s_waitcnt vmcnt(13)
    s_barrier
    ds_read_b128 v[88:91], v6 offset:0
    s_waitcnt lgkmcnt(4)
    v_mfma_f32_16x16x32_bf16 v[36:39], v[136:139], v[96:99], v[36:39]
    v_mfma_f32_16x16x32_bf16 v[72:75], v[140:143], v[96:99], v[72:75]
    s_add_u32 m0, s21, 0
    s_add_u32 s26, s33, s21
    s_add_u32 s26, s26, 147456
    buffer_load_dwordx4 v1, s[8:11], s26 offen offset:0 sc1 lds
    ds_read_b128 v[92:95], v6 offset:1024
    s_waitcnt lgkmcnt(4)
    v_mfma_f32_16x16x32_bf16 v[40:43], v[136:139], v[100:103], v[40:43]
    v_mfma_f32_16x16x32_bf16 v[76:79], v[140:143], v[100:103], v[76:79]
    buffer_load_dwordx4 v1, s[8:11], s26 offen offset:1024 sc1 lds
    ds_read_b128 v[96:99], v6 offset:2048
    s_waitcnt lgkmcnt(4)
    v_mfma_f32_16x16x32_bf16 v[44:47], v[136:139], v[104:107], v[44:47]
    v_mfma_f32_16x16x32_bf16 v[80:83], v[140:143], v[104:107], v[80:83]
    s_add_u32 m0, m0, 2048
    s_add_u32 s26, s26, 2048
    s_mov_b64 exec, s[24:25]
    buffer_load_dwordx4 v1, s[8:11], s26 offen sc1 lds
    s_mov_b64 exec, -1
    ds_read_b128 v[100:103], v6 offset:3072
    s_waitcnt lgkmcnt(4)
    v_mfma_f32_16x16x32_bf16 v[48:51], v[136:139], v[108:111], v[48:51]
    v_mfma_f32_16x16x32_bf16 v[84:87], v[140:143], v[108:111], v[84:87]
    ds_read_b128 v[104:107], v6 offset:4096
    s_waitcnt vmcnt(14) lgkmcnt(4)
    v_mfma_f32_16x16x32_bf16 v[16:19], v[144:147], v[88:91], v[16:19]
    v_mfma_f32_16x16x32_bf16 v[52:55], v[148:151], v[88:91], v[52:55]
    s_add_u32 s38, s38, 4096
    buffer_load_dwordx4 v[112:115], v1, s[12:15], s38 offen offset:0 sc1
    ds_read_b128 v[108:111], v6 offset:5120
    s_waitcnt lgkmcnt(4)
    v_mfma_f32_16x16x32_bf16 v[20:23], v[144:147], v[92:95], v[20:23]
    v_mfma_f32_16x16x32_bf16 v[56:59], v[148:151], v[92:95], v[56:59]
    ds_read_b128 v[88:91], v6 offset:6144
    s_waitcnt lgkmcnt(4)
    v_mfma_f32_16x16x32_bf16 v[24:27], v[144:147], v[96:99], v[24:27]
    v_mfma_f32_16x16x32_bf16 v[60:63], v[148:151], v[96:99], v[60:63]
    s_add_u32 s39, s39, 4096
    buffer_load_dwordx4 v[116:119], v1, s[12:15], s39 offen offset:0 sc1
    ds_read_b128 v[92:95], v6 offset:7168
    s_waitcnt lgkmcnt(4)
    v_mfma_f32_16x16x32_bf16 v[28:31], v[144:147], v[100:103], v[28:31]
    v_mfma_f32_16x16x32_bf16 v[64:67], v[148:151], v[100:103], v[64:67]
    ds_read_b128 v[96:99], v6 offset:8192
    s_waitcnt lgkmcnt(4)
    v_mfma_f32_16x16x32_bf16 v[32:35], v[144:147], v[104:107], v[32:35]
    v_mfma_f32_16x16x32_bf16 v[68:71], v[148:151], v[104:107], v[68:71]
    s_cmp_lg_u32 s79, 0
    s_cbranch_scc1 Lm30_qc0
    s_cmp_ge_u32 s16, 3
    s_cbranch_scc1 Lm30_qc0
    buffer_load_dword v176, v11, s[8:11], s42 offen sc1
    s_add_u32 s42, s42, 6912
    buffer_load_dword v177, v11, s[8:11], s42 offen sc1
    s_add_u32 s42, s42, 6912
    buffer_load_dword v178, v11, s[8:11], s42 offen sc1
    s_add_u32 s42, s42, 6912
    buffer_load_dword v179, v11, s[8:11], s42 offen sc1
    s_add_u32 s42, s42, 6912
    buffer_load_dword v180, v11, s[8:11], s42 offen sc1
    s_add_u32 s42, s42, 6912
    buffer_load_dword v181, v11, s[8:11], s42 offen sc1
    s_add_u32 s42, s42, 6912
    buffer_load_dword v182, v11, s[8:11], s42 offen sc1
    s_add_u32 s42, s42, 6912
    buffer_load_dword v183, v11, s[8:11], s42 offen sc1
    s_add_u32 s42, s42, 6912
    buffer_load_dword v184, v11, s[8:11], s42 offen sc1
    s_add_u32 s42, s42, 6912
    buffer_load_dword v185, v11, s[8:11], s42 offen sc1
    s_add_u32 s42, s42, 6912
    buffer_load_dword v186, v11, s[8:11], s42 offen sc1
    s_add_u32 s42, s42, 6912
    buffer_load_dword v187, v11, s[8:11], s42 offen sc1
    s_add_u32 s42, s42, 6912
    buffer_load_dword v188, v11, s[8:11], s42 offen sc1
    s_add_u32 s42, s42, 6912
    buffer_load_dword v189, v11, s[8:11], s42 offen sc1
    s_add_u32 s42, s42, 6912
    buffer_load_dword v190, v11, s[8:11], s42 offen sc1
    s_add_u32 s42, s42, 6912
    buffer_load_dword v191, v11, s[8:11], s42 offen sc1
    s_add_u32 s42, s42, 6912
    buffer_load_dword v192, v11, s[8:11], s42 offen sc1
    s_add_u32 s42, s42, 6912
    buffer_load_dword v193, v11, s[8:11], s42 offen sc1
    s_add_u32 s42, s42, 6912
Lm30_qc0:
    ds_read_b128 v[100:103], v6 offset:18432
    s_waitcnt lgkmcnt(4)
    v_mfma_f32_16x16x32_bf16 v[36:39], v[144:147], v[108:111], v[36:39]
    v_mfma_f32_16x16x32_bf16 v[72:75], v[148:151], v[108:111], v[72:75]
    ds_read_b128 v[104:107], v6 offset:19456
    s_waitcnt lgkmcnt(4)
    v_mfma_f32_16x16x32_bf16 v[40:43], v[144:147], v[88:91], v[40:43]
    v_mfma_f32_16x16x32_bf16 v[76:79], v[148:151], v[88:91], v[76:79]
    buffer_load_dwordx2 v[196:197], v12, s[12:15], s41 offen offset:0 sc1
    ds_read_b128 v[108:111], v6 offset:20480
    s_waitcnt lgkmcnt(4)
    v_mfma_f32_16x16x32_bf16 v[44:47], v[144:147], v[92:95], v[44:47]
    v_mfma_f32_16x16x32_bf16 v[80:83], v[148:151], v[92:95], v[80:83]
    ds_read_b128 v[88:91], v6 offset:21504
    s_waitcnt lgkmcnt(4)
    v_mfma_f32_16x16x32_bf16 v[48:51], v[144:147], v[96:99], v[48:51]
    v_mfma_f32_16x16x32_bf16 v[84:87], v[148:151], v[96:99], v[84:87]
    buffer_load_dwordx2 v[198:199], v12, s[12:15], s41 offen offset:512 sc1
    ds_read_b128 v[92:95], v6 offset:22528
    s_waitcnt vmcnt(16) lgkmcnt(4)
    v_mfma_f32_16x16x32_bf16 v[16:19], v[152:155], v[100:103], v[16:19]
    v_mfma_f32_16x16x32_bf16 v[52:55], v[156:159], v[100:103], v[52:55]
    ds_read_b128 v[96:99], v6 offset:23552
    s_waitcnt lgkmcnt(4)
    v_mfma_f32_16x16x32_bf16 v[20:23], v[152:155], v[104:107], v[20:23]
    v_mfma_f32_16x16x32_bf16 v[56:59], v[156:159], v[104:107], v[56:59]
    buffer_load_dwordx2 v[200:201], v12, s[12:15], s41 offen offset:1024 sc1
    ds_read_b128 v[100:103], v6 offset:24576
    s_waitcnt lgkmcnt(4)
    v_mfma_f32_16x16x32_bf16 v[24:27], v[152:155], v[108:111], v[24:27]
    v_mfma_f32_16x16x32_bf16 v[60:63], v[156:159], v[108:111], v[60:63]
    ds_read_b128 v[104:107], v6 offset:25600
    s_waitcnt lgkmcnt(4)
    v_mfma_f32_16x16x32_bf16 v[28:31], v[152:155], v[88:91], v[28:31]
    v_mfma_f32_16x16x32_bf16 v[64:67], v[156:159], v[88:91], v[64:67]
    buffer_load_dwordx2 v[202:203], v12, s[12:15], s41 offen offset:1536 sc1
    ds_read_b128 v[108:111], v6 offset:26624
    s_waitcnt lgkmcnt(4)
    v_mfma_f32_16x16x32_bf16 v[32:35], v[152:155], v[92:95], v[32:35]
    v_mfma_f32_16x16x32_bf16 v[68:71], v[156:159], v[92:95], v[68:71]
    s_waitcnt vmcnt(13)
    s_barrier
    ds_read_b128 v[88:91], v7 offset:0
    s_waitcnt lgkmcnt(4)
    v_mfma_f32_16x16x32_bf16 v[36:39], v[152:155], v[96:99], v[36:39]
    v_mfma_f32_16x16x32_bf16 v[72:75], v[156:159], v[96:99], v[72:75]
    ds_read_b128 v[92:95], v7 offset:1024
    s_waitcnt lgkmcnt(4)
    v_mfma_f32_16x16x32_bf16 v[40:43], v[152:155], v[100:103], v[40:43]
    v_mfma_f32_16x16x32_bf16 v[76:79], v[156:159], v[100:103], v[76:79]
    ds_read_b128 v[96:99], v7 offset:2048
    s_waitcnt lgkmcnt(4)
    v_mfma_f32_16x16x32_bf16 v[44:47], v[152:155], v[104:107], v[44:47]
    v_mfma_f32_16x16x32_bf16 v[80:83], v[156:159], v[104:107], v[80:83]
    ds_read_b128 v[100:103], v7 offset:3072
    s_waitcnt lgkmcnt(4)
    v_mfma_f32_16x16x32_bf16 v[48:51], v[152:155], v[108:111], v[48:51]
    v_mfma_f32_16x16x32_bf16 v[84:87], v[156:159], v[108:111], v[84:87]
    ds_read_b128 v[104:107], v7 offset:4096
    s_waitcnt vmcnt(11) lgkmcnt(4)
    v_mfma_f32_16x16x32_bf16 v[16:19], v[160:163], v[88:91], v[16:19]
    v_mfma_f32_16x16x32_bf16 v[52:55], v[164:167], v[88:91], v[52:55]
    ds_read_b128 v[108:111], v7 offset:5120
    s_waitcnt lgkmcnt(4)
    v_mfma_f32_16x16x32_bf16 v[20:23], v[160:163], v[92:95], v[20:23]
    v_mfma_f32_16x16x32_bf16 v[56:59], v[164:167], v[92:95], v[56:59]
    ds_read_b128 v[88:91], v7 offset:6144
    s_waitcnt lgkmcnt(4)
    v_mfma_f32_16x16x32_bf16 v[24:27], v[160:163], v[96:99], v[24:27]
    v_mfma_f32_16x16x32_bf16 v[60:63], v[164:167], v[96:99], v[60:63]
    ds_read_b128 v[92:95], v7 offset:7168
    s_waitcnt lgkmcnt(4)
    v_mfma_f32_16x16x32_bf16 v[28:31], v[160:163], v[100:103], v[28:31]
    v_mfma_f32_16x16x32_bf16 v[64:67], v[164:167], v[100:103], v[64:67]
    ds_read_b128 v[96:99], v7 offset:8192
    s_waitcnt lgkmcnt(4)
    v_mfma_f32_16x16x32_bf16 v[32:35], v[160:163], v[104:107], v[32:35]
    v_mfma_f32_16x16x32_bf16 v[68:71], v[164:167], v[104:107], v[68:71]
    ds_read_b128 v[100:103], v7 offset:18432
    s_waitcnt lgkmcnt(4)
    v_mfma_f32_16x16x32_bf16 v[36:39], v[160:163], v[108:111], v[36:39]
    v_mfma_f32_16x16x32_bf16 v[72:75], v[164:167], v[108:111], v[72:75]
    ds_read_b128 v[104:107], v7 offset:19456
    s_waitcnt lgkmcnt(4)
    v_mfma_f32_16x16x32_bf16 v[40:43], v[160:163], v[88:91], v[40:43]
    v_mfma_f32_16x16x32_bf16 v[76:79], v[164:167], v[88:91], v[76:79]
    ds_read_b128 v[108:111], v7 offset:20480
    s_waitcnt lgkmcnt(4)
    v_mfma_f32_16x16x32_bf16 v[44:47], v[160:163], v[92:95], v[44:47]
    v_mfma_f32_16x16x32_bf16 v[80:83], v[164:167], v[92:95], v[80:83]
    ds_read_b128 v[88:91], v7 offset:21504
    s_waitcnt lgkmcnt(4)
    v_mfma_f32_16x16x32_bf16 v[48:51], v[160:163], v[96:99], v[48:51]
    v_mfma_f32_16x16x32_bf16 v[84:87], v[164:167], v[96:99], v[84:87]
    ds_read_b128 v[92:95], v7 offset:22528
    s_waitcnt vmcnt(9) lgkmcnt(4)
    v_mfma_f32_16x16x32_bf16 v[16:19], v[168:171], v[100:103], v[16:19]
    v_mfma_f32_16x16x32_bf16 v[52:55], v[172:175], v[100:103], v[52:55]
    ds_read_b128 v[96:99], v7 offset:23552
    s_waitcnt lgkmcnt(4)
    v_mfma_f32_16x16x32_bf16 v[20:23], v[168:171], v[104:107], v[20:23]
    v_mfma_f32_16x16x32_bf16 v[56:59], v[172:175], v[104:107], v[56:59]
    ds_read_b128 v[100:103], v7 offset:24576
    s_waitcnt lgkmcnt(4)
    v_mfma_f32_16x16x32_bf16 v[24:27], v[168:171], v[108:111], v[24:27]
    v_mfma_f32_16x16x32_bf16 v[60:63], v[172:175], v[108:111], v[60:63]
    ds_read_b128 v[104:107], v7 offset:25600
    s_waitcnt lgkmcnt(4)
    v_mfma_f32_16x16x32_bf16 v[28:31], v[168:171], v[88:91], v[28:31]
    v_mfma_f32_16x16x32_bf16 v[64:67], v[172:175], v[88:91], v[64:67]
    ds_read_b128 v[108:111], v7 offset:26624
    s_waitcnt lgkmcnt(4)
    v_mfma_f32_16x16x32_bf16 v[32:35], v[168:171], v[92:95], v[32:35]
    v_mfma_f32_16x16x32_bf16 v[68:71], v[172:175], v[92:95], v[68:71]
    s_waitcnt vmcnt(6)
    s_waitcnt vmcnt(0)
    v_add_f32 v176, v176, v177
    v_add_f32 v176, v176, v178
    v_add_f32 v176, v176, v179
    v_add_f32 v176, v176, v180
    v_add_f32 v176, v176, v181
    v_add_f32 v176, v176, v182
    v_add_f32 v176, v176, v183
    v_add_f32 v176, v176, v184
    v_add_f32 v176, v176, v185
    v_add_f32 v176, v176, v186
    v_add_f32 v176, v176, v187
    v_add_f32 v176, v176, v188
    v_add_f32 v176, v176, v189
    v_add_f32 v176, v176, v190
    v_add_f32 v176, v176, v191
    v_add_f32 v176, v176, v192
    v_add_f32 v176, v176, v193
    ds_write_b32 v10, v176
    v_add_f32 v196, v196, v198
    v_add_f32 v197, v197, v199
    v_add_f32 v196, v196, v200
    v_add_f32 v197, v197, v201
    v_add_f32 v196, v196, v202
    v_add_f32 v197, v197, v203
    v_mov_b32 v198, v196
    v_mov_b32 v199, v197
    s_nop 0
    v_permlane32_swap_b32 v196, v198
    v_permlane32_swap_b32 v197, v199
    v_add_f32 v196, v196, v198
    v_add_f32 v197, v197, v199
    v_mov_b32 v198, v196
    v_mov_b32 v199, v197
    s_nop 0
    v_permlane16_swap_b32 v196, v198
    v_permlane16_swap_b32 v197, v199
    v_add_f32 v196, v196, v198
    v_add_f32 v197, v197, v199
    v_mul_f32 v12, 0x3ae38e39, v196
    v_mul_f32 v14, 0x3ae38e39, v197
    v_fma_f32 v14, -v12, v12, v14
    v_max_f32 v14, 0, v14
    v_add_f32 v14, 0x3727c5ac, v14
    v_rsq_f32 v13, v14
    s_waitcnt lgkmcnt(0)
    s_barrier
    ds_read_b128 v[88:91], v4 offset:0
    v_mfma_f32_16x16x32_bf16 v[36:39], v[168:171], v[96:99], v[36:39]
    v_mfma_f32_16x16x32_bf16 v[72:75], v[172:175], v[96:99], v[72:75]
    ds_read_b128 v[92:95], v4 offset:1024
    v_mfma_f32_16x16x32_bf16 v[40:43], v[168:171], v[100:103], v[40:43]
    v_mfma_f32_16x16x32_bf16 v[76:79], v[172:175], v[100:103], v[76:79]
    ds_read_b128 v[96:99], v4 offset:2048
    v_mfma_f32_16x16x32_bf16 v[44:47], v[168:171], v[104:107], v[44:47]
    v_mfma_f32_16x16x32_bf16 v[80:83], v[172:175], v[104:107], v[80:83]
    ds_read_b128 v[100:103], v4 offset:3072
    v_mfma_f32_16x16x32_bf16 v[48:51], v[168:171], v[108:111], v[48:51]
    v_mfma_f32_16x16x32_bf16 v[84:87], v[172:175], v[108:111], v[84:87]
    ds_read_b128 v[104:107], v4 offset:4096
    s_waitcnt lgkmcnt(4)
    v_mfma_f32_16x16x32_bf16 v[16:19], v[112:115], v[88:91], v[16:19]
    v_mfma_f32_16x16x32_bf16 v[52:55], v[116:119], v[88:91], v[52:55]
    ds_read_b128 v[108:111], v4 offset:5120
    s_waitcnt lgkmcnt(4)
    v_mfma_f32_16x16x32_bf16 v[20:23], v[112:115], v[92:95], v[20:23]
    v_mfma_f32_16x16x32_bf16 v[56:59], v[116:119], v[92:95], v[56:59]
    ds_read_b128 v[88:91], v4 offset:6144
    s_waitcnt lgkmcnt(4)
    v_mfma_f32_16x16x32_bf16 v[24:27], v[112:115], v[96:99], v[24:27]
    v_mfma_f32_16x16x32_bf16 v[60:63], v[116:119], v[96:99], v[60:63]
    ds_read_b128 v[92:95], v4 offset:7168
    s_waitcnt lgkmcnt(4)
    v_mfma_f32_16x16x32_bf16 v[28:31], v[112:115], v[100:103], v[28:31]
    v_mfma_f32_16x16x32_bf16 v[64:67], v[116:119], v[100:103], v[64:67]
    ds_read_b128 v[96:99], v4 offset:8192
    s_waitcnt lgkmcnt(4)
    v_mfma_f32_16x16x32_bf16 v[32:35], v[112:115], v[104:107], v[32:35]
    v_mfma_f32_16x16x32_bf16 v[68:71], v[116:119], v[104:107], v[68:71]
    s_waitcnt lgkmcnt(3)
    v_mfma_f32_16x16x32_bf16 v[36:39], v[112:115], v[108:111], v[36:39]
    v_mfma_f32_16x16x32_bf16 v[72:75], v[116:119], v[108:111], v[72:75]
    s_waitcnt lgkmcnt(2)
    v_mfma_f32_16x16x32_bf16 v[40:43], v[112:115], v[88:91], v[40:43]
    v_mfma_f32_16x16x32_bf16 v[76:79], v[116:119], v[88:91], v[76:79]
    s_waitcnt lgkmcnt(1)
    v_mfma_f32_16x16x32_bf16 v[44:47], v[112:115], v[92:95], v[44:47]
    v_mfma_f32_16x16x32_bf16 v[80:83], v[116:119], v[92:95], v[80:83]
    s_waitcnt lgkmcnt(0)
    v_mfma_f32_16x16x32_bf16 v[48:51], v[112:115], v[96:99], v[48:51]
    v_mfma_f32_16x16x32_bf16 v[84:87], v[116:119], v[96:99], v[84:87]
    v_lshlrev_b32 v8, 2, v2
    v_add_u32 v8, 147456, v8
    v_lshlrev_b32 v11, 4, v3
    ds_read_b32 v204, v8 offset:0
    ds_read_b32 v205, v8 offset:64
    ds_read_b32 v206, v8 offset:128
    ds_read_b32 v207, v8 offset:192
    ds_read_b32 v208, v8 offset:256
    ds_read_b32 v209, v8 offset:320
    ds_read_b32 v210, v8 offset:384
    ds_read_b32 v211, v8 offset:448
    ds_read_b32 v212, v8 offset:512
    ds_bpermute_b32 v176, v11, v12 offset:0
    ds_bpermute_b32 v180, v11, v13 offset:0
    ds_bpermute_b32 v177, v11, v12 offset:4
    ds_bpermute_b32 v181, v11, v13 offset:4
    ds_bpermute_b32 v178, v11, v12 offset:8
    ds_bpermute_b32 v182, v11, v13 offset:8
    ds_bpermute_b32 v179, v11, v12 offset:12
    ds_bpermute_b32 v183, v11, v13 offset:12
    s_mul_i32 s26, s16, 9216
    s_add_u32 s26, s26, 36864
    v_add_u32 v8, s26, v1
    s_xor_b32 s26, s16, 4
    s_mul_i32 s26, s26, 9216
    s_add_u32 s26, s26, 36864
    v_add_u32 v9, s26, v1
    ds_write_b128 v8, v[52:55] offset:0
    ds_write_b128 v8, v[56:59] offset:1024
    ds_write_b128 v8, v[60:63] offset:2048
    ds_write_b128 v8, v[64:67] offset:3072
    ds_write_b128 v8, v[68:71] offset:4096
    ds_write_b128 v8, v[72:75] offset:5120
    ds_write_b128 v8, v[76:79] offset:6144
    ds_write_b128 v8, v[80:83] offset:7168
    ds_write_b128 v8, v[84:87] offset:8192
    s_sub_u32 s45, s32, 8
    s_lshl_b32 s43, s45, 19
    s_lshl_b32 s46, s36, 9
    s_add_u32 s43, s43, s46
    s_add_u32 s43, s43, 10223616
    s_lshl_b32 s44, s45, 16
    s_add_u32 s44, s44, s46
    s_add_u32 s44, s44, 12320768
    v_and_b32 v10, 31, v0
    v_lshlrev_b32 v10, 4, v10
    v_lshrrev_b32 v11, 1, v3
    v_lshl_add_u32 v11, v11, 16, v10
    s_waitcnt lgkmcnt(9)
    v_fma_f32 v16, -v176, v204, v16
    v_mul_f32 v16, v180, v16
    v_fma_f32 v17, -v177, v204, v17
    v_mul_f32 v17, v181, v17
    v_fma_f32 v18, -v178, v204, v18
    v_mul_f32 v18, v182, v18
    v_fma_f32 v19, -v179, v204, v19
    v_mul_f32 v19, v183, v19
    v_fma_f32 v20, -v176, v205, v20
    v_mul_f32 v20, v180, v20
    v_fma_f32 v21, -v177, v205, v21
    v_mul_f32 v21, v181, v21
    v_fma_f32 v22, -v178, v205, v22
    v_mul_f32 v22, v182, v22
    v_fma_f32 v23, -v179, v205, v23
    v_mul_f32 v23, v183, v23
    v_fma_f32 v24, -v176, v206, v24
    v_mul_f32 v24, v180, v24
    v_fma_f32 v25, -v177, v206, v25
    v_mul_f32 v25, v181, v25
    v_fma_f32 v26, -v178, v206, v26
    v_mul_f32 v26, v182, v26
    v_fma_f32 v27, -v179, v206, v27
    v_mul_f32 v27, v183, v27
    v_fma_f32 v28, -v176, v207, v28
    v_mul_f32 v28, v180, v28
    v_fma_f32 v29, -v177, v207, v29
    v_mul_f32 v29, v181, v29
    v_fma_f32 v30, -v178, v207, v30
    v_mul_f32 v30, v182, v30
    v_fma_f32 v31, -v179, v207, v31
    v_mul_f32 v31, v183, v31
    v_fma_f32 v32, -v176, v208, v32
    v_mul_f32 v32, v180, v32
    v_fma_f32 v33, -v177, v208, v33
    v_mul_f32 v33, v181, v33
    v_fma_f32 v34, -v178, v208, v34
    v_mul_f32 v34, v182, v34
    v_fma_f32 v35, -v179, v208, v35
    v_mul_f32 v35, v183, v35
    v_fma_f32 v36, -v176, v209, v36
    v_mul_f32 v36, v180, v36
    v_fma_f32 v37, -v177, v209, v37
    v_mul_f32 v37, v181, v37
    v_fma_f32 v38, -v178, v209, v38
    v_mul_f32 v38, v182, v38
    v_fma_f32 v39, -v179, v209, v39
    v_mul_f32 v39, v183, v39
    v_fma_f32 v40, -v176, v210, v40
    v_mul_f32 v40, v180, v40
    v_fma_f32 v41, -v177, v210, v41
    v_mul_f32 v41, v181, v41
    v_fma_f32 v42, -v178, v210, v42
    v_mul_f32 v42, v182, v42
    v_fma_f32 v43, -v179, v210, v43
    v_mul_f32 v43, v183, v43
    v_fma_f32 v44, -v176, v211, v44
    v_mul_f32 v44, v180, v44
    v_fma_f32 v45, -v177, v211, v45
    v_mul_f32 v45, v181, v45
    v_fma_f32 v46, -v178, v211, v46
    v_mul_f32 v46, v182, v46
    v_fma_f32 v47, -v179, v211, v47
    v_mul_f32 v47, v183, v47
    v_fma_f32 v48, -v176, v212, v48
    v_mul_f32 v48, v180, v48
    v_fma_f32 v49, -v177, v212, v49
    v_mul_f32 v49, v181, v49
    v_fma_f32 v50, -v178, v212, v50
    v_mul_f32 v50, v182, v50
    v_fma_f32 v51, -v179, v212, v51
    v_mul_f32 v51, v183, v51
    s_waitcnt lgkmcnt(0)
    s_barrier
    ds_read_b128 v[52:55], v9 offset:0
    ds_read_b128 v[56:59], v9 offset:1024
    ds_read_b128 v[60:63], v9 offset:2048
    ds_read_b128 v[64:67], v9 offset:3072
    ds_read_b128 v[68:71], v9 offset:4096
    ds_read_b128 v[72:75], v9 offset:5120
    ds_read_b128 v[76:79], v9 offset:6144
    ds_read_b128 v[80:83], v9 offset:7168
    ds_read_b128 v[84:87], v9 offset:8192
    s_waitcnt lgkmcnt(8)
    v_fmac_f32 v16, v180, v52
    v_fmac_f32 v17, v181, v53
    v_fmac_f32 v18, v182, v54
    v_fmac_f32 v19, v183, v55
    v_cvt_pk_bf16_f32 v88, v16, v17
    v_cvt_pk_bf16_f32 v89, v18, v19
    s_waitcnt lgkmcnt(7)
    v_fmac_f32 v20, v180, v56
    v_fmac_f32 v21, v181, v57
    v_fmac_f32 v22, v182, v58
    v_fmac_f32 v23, v183, v59
    v_cvt_pk_bf16_f32 v90, v20, v21
    v_cvt_pk_bf16_f32 v91, v22, v23
    s_nop 0
    v_permlane32_swap_b32 v88, v90
    v_permlane32_swap_b32 v89, v91
    buffer_store_dwordx4 v[88:91], v11, s[12:15], s43 offen sc1
    s_add_u32 s43, s43, 131072
    s_waitcnt lgkmcnt(6)
    v_fmac_f32 v24, v180, v60
    v_fmac_f32 v25, v181, v61
    v_fmac_f32 v26, v182, v62
    v_fmac_f32 v27, v183, v63
    v_cvt_pk_bf16_f32 v92, v24, v25
    v_cvt_pk_bf16_f32 v93, v26, v27
    s_waitcnt lgkmcnt(5)
    v_fmac_f32 v28, v180, v64
    v_fmac_f32 v29, v181, v65
    v_fmac_f32 v30, v182, v66
    v_fmac_f32 v31, v183, v67
    v_cvt_pk_bf16_f32 v94, v28, v29
    v_cvt_pk_bf16_f32 v95, v30, v31
    s_nop 0
    v_permlane32_swap_b32 v92, v94
    v_permlane32_swap_b32 v93, v95
    buffer_store_dwordx4 v[92:95], v11, s[12:15], s43 offen sc1
    s_add_u32 s43, s43, 131072
    s_waitcnt lgkmcnt(4)
    v_fmac_f32 v32, v180, v68
    v_fmac_f32 v33, v181, v69
    v_fmac_f32 v34, v182, v70
    v_fmac_f32 v35, v183, v71
    v_cvt_pk_bf16_f32 v96, v32, v33
    v_cvt_pk_bf16_f32 v97, v34, v35
    s_waitcnt lgkmcnt(3)
    v_fmac_f32 v36, v180, v72
    v_fmac_f32 v37, v181, v73
    v_fmac_f32 v38, v182, v74
    v_fmac_f32 v39, v183, v75
    v_cvt_pk_bf16_f32 v98, v36, v37
    v_cvt_pk_bf16_f32 v99, v38, v39
    s_nop 0
    v_permlane32_swap_b32 v96, v98
    v_permlane32_swap_b32 v97, v99
    buffer_store_dwordx4 v[96:99], v11, s[12:15], s43 offen sc1
    s_add_u32 s43, s43, 131072
    s_waitcnt lgkmcnt(2)
    v_fmac_f32 v40, v180, v76
    v_fmac_f32 v41, v181, v77
    v_fmac_f32 v42, v182, v78
    v_fmac_f32 v43, v183, v79
    v_cvt_pk_bf16_f32 v100, v40, v41
    v_cvt_pk_bf16_f32 v101, v42, v43
    s_waitcnt lgkmcnt(1)
    v_fmac_f32 v44, v180, v80
    v_fmac_f32 v45, v181, v81
    v_fmac_f32 v46, v182, v82
    v_fmac_f32 v47, v183, v83
    v_cvt_pk_bf16_f32 v102, v44, v45
    v_cvt_pk_bf16_f32 v103, v46, v47
    s_nop 0
    v_permlane32_swap_b32 v100, v102
    v_permlane32_swap_b32 v101, v103
    buffer_store_dwordx4 v[100:103], v11, s[12:15], s43 offen sc1
    s_add_u32 s43, s43, 131072
    s_waitcnt lgkmcnt(0)
    v_fmac_f32 v48, v180, v84
    v_fmac_f32 v49, v181, v85
    v_fmac_f32 v50, v182, v86
    v_fmac_f32 v51, v183, v87
    v_cvt_pk_bf16_f32 v104, v48, v49
    v_cvt_pk_bf16_f32 v105, v50, v51
    v_mov_b32 v106, v104
    v_mov_b32 v107, v105
    s_nop 0
    v_permlane32_swap_b32 v104, v106
    v_permlane32_swap_b32 v105, v107
    s_mov_b64 exec, s[22:23]
    buffer_store_dwordx4 v[104:107], v10, s[12:15], s44 offen sc1
    s_mov_b64 exec, -1
Lm22_qpub:
    s_waitcnt vmcnt(0) lgkmcnt(0)
    s_barrier
    s_cmp_lg_u32 s16, 0
    s_cbranch_scc1 Lm31_pub
    v_mov_b32 v13, s79
    v_mov_b32 v14, s80
    s_mov_b64 exec, 1
    buffer_store_dword v14, v13, s[12:15], s47 offen sc1
    s_mov_b64 exec, -1
Lm31_pub:
Lm20_qend:
    v_mbcnt_lo_u32_b32 v0, -1, 0
    v_mbcnt_hi_u32_b32 v0, -1, v0
    v_lshlrev_b32 v1, 4, v0
    v_and_b32 v2, 31, v0
    v_lshrrev_b32 v3, 5, v0
    s_and_b32 s17, s16, 3
    s_lshr_b32 s18, s16, 2
    s_and_b32 s19, s2, 7
    s_lshl_b32 s19, s19, 2
    s_bfe_u32 s20, s2, 0x20003
    s_add_u32 s19, s19, s20
    s_lshr_b32 s20, s2, 5
    s_lshl_b32 s21, s20, 3
    s_lshl_b32 s22, s17, 1
    s_add_u32 s21, s21, s22
    s_add_u32 s22, s21, s18
    s_xor_b32 s23, s18, 1
    s_add_u32 s23, s21, s23
    s_lshl_b32 s24, s19, 16
    s_lshr_b32 s25, s19, 1
    s_lshl_b32 s25, s25, 14
    s_and_b32 s26, s19, 1
    s_lshl_b32 s26, s26, 2
    s_add_u32 s25, s25, s26
    v_lshlrev_b32 v4, 3, v2
    s_mov_b32 s28, -1
    s_mov_b32 s29, 0
    s_mov_b32 s30, 0x3ffff
    s_mov_b32 s31, 0x3ffff
    s_mov_b32 s44, 0
    v_cmp_eq_u32 vcc, 18, v2
    v_cmp_eq_u32 s[32:33], 20, v2
    v_mov_b32 v6, 0x3f803f80
    s_or_b64 vcc, vcc, s[32:33]
    s_lshl_b32 s32, s22, 10
    s_add_u32 s32, s32, s24
    s_add_u32 s32, s32, 5505024
    s_lshl_b32 s33, s23, 10
    s_add_u32 s33, s33, s24
    s_add_u32 s33, s33, 5505024
    s_lshl_b32 s35, s22, 8
    s_add_u32 s35, s35, s25
    s_add_u32 s35, s35, 9699328
    s_lshl_b32 s36, s23, 8
    s_add_u32 s36, s36, s25
    s_add_u32 s36, s36, 9699328
    v_cndmask_b32 v6, 0, v6, vcc
    v_mov_b32 v77, 0
    s_lshr_b32 s27, s19, 3
    s_lshl_b32 s27, s27, 13
    s_add_u32 s27, s27, 44564480
    s_lshl_b32 s26, s20, 5
    s_add_u32 s26, s26, s19
    s_lshl_b32 s26, s26, 7
    s_add_u32 s26, s26, 44597248
    v_mov_b32 v24, 0
    v_mov_b32 v25, 0
    v_mov_b32 v26, 0
    v_mov_b32 v27, 0
    v_mov_b32 v40, 0
    v_mov_b32 v41, 0x3f803f80
    v_mov_b32 v42, 0
    v_mov_b32 v43, 0x3f803f80
    v_mov_b32 v48, v6
    v_mov_b32 v49, v6
    v_mov_b32 v50, v6
    v_mov_b32 v51, v6
    v_mov_b32 v52, v6
    v_mov_b32 v53, v6
    v_mov_b32 v54, v6
    v_mov_b32 v55, v6
    v_mov_b32 v56, v6
    v_mov_b32 v57, v6
    v_mov_b32 v58, v6
    v_mov_b32 v59, v6
    v_mov_b32 v60, v6
    v_mov_b32 v61, v6
    v_mov_b32 v62, v6
    v_mov_b32 v63, v6
    s_lshl_b32 s45, s16, 10
    s_add_u32 s34, s24, s45
    s_add_u32 s34, s34, 7602176
    s_lshl_b32 s46, s17, 8
    s_lshl_b32 s47, s18, 12
    s_add_u32 s46, s46, s47
    s_lshl_b32 s37, s46, 1
    s_add_u32 s37, s37, s25
    s_add_u32 s37, s37, 9961472
    s_add_u32 s46, s46, 139264
    s_add_u32 s38, s24, 10223616
    s_lshr_b32 s39, s19, 3
    s_lshl_b32 s39, s39, 16
    s_and_b32 s42, s19, 7
    s_lshl_b32 s42, s42, 5
    s_add_u32 s39, s39, s42
    s_sub_u32 s39, s39, s24
    s_add_u32 s39, s39, 2096896
    s_lshl_b32 s41, s16, 6
    v_lshlrev_b32 v7, 3, v0
    v_add_u32 v10, s41, v0
    v_mul_u32_u24 v11, 3641, v10
    v_lshrrev_b32 v11, 16, v11
    v_mul_u32_u24 v12, 18, v11
    v_sub_u32 v12, v10, v12
    v_cmp_gt_u32 vcc, 16, v12
    v_lshlrev_b32 v8, 8, v11
    v_lshl_add_u32 v8, v12, 4, v8
    v_mov_b32 v10, s39
    v_cndmask_b32 v10, v10, 0, vcc
    v_add_u32 v8, v8, v10
    v_add_u32 v10, 512, v0
    v_mul_u32_u24 v11, 3641, v10
    v_lshrrev_b32 v11, 16, v11
    v_mul_u32_u24 v12, 18, v11
    v_sub_u32 v12, v10, v12
    v_cmp_gt_u32 vcc, 16, v12
    v_lshlrev_b32 v9, 8, v11
    v_lshl_add_u32 v9, v12, 4, v9
    v_mov_b32 v10, s39
    v_cndmask_b32 v10, v10, 0, vcc
    v_add_u32 v9, v9, v10
    s_mul_i32 s41, s18, 36864
    s_add_u32 s41, s41, 65536
    v_mul_u32_u24 v5, 288, v3
    v_lshl_add_u32 v5, v2, 4, v5
    v_add_u32 v5, s41, v5
    s_lshl_b32 s41, s18, 15
    v_add_u32 v10, s41, v1
    s_lshl_b32 s41, s18, 12
    v_lshlrev_b32 v12, 2, v2
    v_add_u32 v12, 139264, v12
    v_add_u32 v11, s41, v12
    s_cmp_lg_u32 s79, 0
    s_cbranch_scc1 Lm32_anp
    s_lshl_b32 s76, s2, 3
    s_add_u32 s76, s76, s16
    s_mov_b32 s77, 0x05040100
    s_mov_b32 s78, 0x07060302
    v_and_b32 v188, 15, v0
    v_lshrrev_b32 v189, 4, v0
    s_mov_b32 s50, 5308416
    s_mov_b32 s51, 0x20000
    s_cmp_lt_u32 s76, 1296
    s_cbranch_scc1 Lm33_t_w13
    s_sub_u32 s64, s76, 1296
    s_min_u32 s64, s64, 575
    s_mov_b32 s48, s74
    s_mov_b32 s49, s75
    s_lshr_b32 s65, s64, 2
    s_and_b32 s66, s64, 3
    s_mul_hi_u32 s67, s65, 238609295
    s_mul_i32 s69, s67, 18
    s_sub_u32 s68, s65, s69
    s_mul_i32 s69, s68, 22
    s_lshr_b32 s69, s69, 6
    s_mul_i32 s69, s69, 3
    s_lshl_b32 s64, s68, 1
    s_add_u32 s69, s69, s64
    s_mul_i32 s64, s68, 9
    s_sub_u32 s64, s64, 102
    s_cmp_ge_u32 s68, 12
    s_cselect_b32 s69, s64, s69
    s_mul_i32 s64, s68, 18
    s_sub_u32 s64, s64, 280
    s_cmp_ge_u32 s68, 16
    s_cselect_b32 s69, s64, s69
    s_cselect_b32 s64, 9, 1
    s_cselect_b32 s68, 8, 0
    s_mul_i32 s67, s67, 36
    s_add_u32 s69, s69, s67
    s_add_u32 s64, s64, s69
    s_lshr_b32 s67, s69, 3
    s_lshl_b32 s67, s67, 7
    s_and_b32 s53, s69, 7
    s_add_u32 s67, s67, s53
    s_mul_i32 s52, s67, 1152
    s_lshr_b32 s67, s64, 3
    s_lshl_b32 s67, s67, 7
    s_and_b32 s53, s64, 7
    s_add_u32 s67, s67, s53
    s_mul_i32 s56, s67, 1152
    s_sub_u32 s69, s56, s52
    s_add_u32 s67, s52, 36864
    s_cmp_eq_u32 s68, 8
    s_cselect_b32 s69, s69, 73728
    s_cselect_b32 s56, s67, s56
    s_cselect_b32 s64, 2, 1
    s_mul_i32 s64, s64, 36864
    v_lshrrev_b32 v190, 1, v189
    v_mul_lo_u32 v184, v190, s69
    v_and_b32 v190, 1, v189
    v_mul_lo_u32 v190, v190, s64
    v_add_u32 v184, v184, v190
    s_add_u32 s53, s52, 9216
    s_add_u32 s54, s52, 18432
    s_add_u32 s55, s52, 27648
    s_add_u32 s57, s56, 9216
    s_add_u32 s58, s56, 18432
    s_add_u32 s59, s56, 27648
    s_mul_hi_u32 s67, s65, 119304648
    s_mul_i32 s69, s67, 36
    s_sub_u32 s68, s65, s69
    s_mul_i32 s67, s67, 36
    s_cmp_ge_u32 s68, 18
    s_cselect_b32 s69, 35, 0
    s_lshl_b32 s68, s68, 1
    s_sub_u32 s68, s68, s69
    s_add_u32 s67, s67, s68
    s_mul_i32 s67, s67, 9216
    s_add_u32 s67, s67, 14680064
    v_mov_b32 v187, 2147483392
    s_mul_i32 s68, s66, 288
    v_lshl_add_u32 v184, v188, 4, v184
    v_add_u32 v184, s68, v184
    s_mul_i32 s68, s66, 1327104
    s_add_u32 s67, s67, s68
    s_cmp_lt_u32 s76, 1872
    s_cselect_b32 s67, s67, 2147475200
    v_and_b32 v190, 3, v188
    v_lshrrev_b32 v191, 2, v188
    v_lshl_add_u32 v190, v190, 2, v191
    v_lshl_add_u32 v190, v189, 4, v190
    v_lshl_add_u32 v185, v190, 4, s67
    v_add_u32 v186, 4096, v185
    s_mov_b32 s60, 0
    s_mov_b32 s61, 1024
    s_mov_b32 s62, 2048
    s_mov_b32 s63, 3072
    s_branch Lm33_t_done
Lm33_t_w13:
    s_cmp_lt_u32 s76, 648
    s_cselect_b32 s48, s70, s72
    s_cselect_b32 s49, s71, s73
    s_cselect_b32 s69, 0, 1
    s_cselect_b32 s64, 0, 648
    s_sub_u32 s64, s76, s64
    s_mul_hi_u32 s65, s64, 119304648
    s_mul_i32 s67, s65, 36
    s_sub_u32 s66, s64, s67
    s_mov_b32 s52, 0
    s_mov_b32 s53, 9216
    s_mov_b32 s54, 18432
    s_mov_b32 s55, 27648
    s_mov_b32 s56, 36864
    s_mov_b32 s57, 46080
    s_mov_b32 s58, 55296
    s_mov_b32 s59, 64512
    s_mov_b32 s60, 0
    s_mov_b32 s61, 36864
    s_mov_b32 s62, 73728
    s_mov_b32 s63, 110592
    s_lshl_b32 s67, s65, 5
    v_lshl_add_u32 v184, v189, 3, s67
    v_mul_u32_u24 v184, 9216, v184
    s_lshl_b32 s67, s66, 8
    v_lshl_add_u32 v190, v188, 4, s67
    v_add_u32 v184, v184, v190
    s_mul_i32 s67, s66, 144
    s_add_u32 s67, s67, s65
    s_lshl_b32 s67, s67, 1
    s_add_u32 s67, s67, s69
    s_lshl_b32 s67, s67, 10
    s_add_u32 s67, s67, 3145728
    v_lshl_add_u32 v185, v0, 4, s67
    v_add_u32 v186, 147456, v185
    s_mul_i32 s67, s65, 288
    s_lshl_b32 s68, s66, 3
    s_add_u32 s67, s67, s68
    s_lshl_b32 s67, s67, 1
    s_add_u32 s67, s67, s69
    s_lshl_b32 s67, s67, 6
    s_add_u32 s67, s67, 20316160
    v_lshl_add_u32 v187, v188, 2, s67
    v_mov_b32 v190, 2147483392
    v_cmp_gt_u32 vcc, 16, v0
    s_nop 1
    v_cndmask_b32 v187, v190, v187, vcc
Lm33_t_done:
    v_mov_b32 v232, 0x3f803f80
    v_mov_b32 v233, 0x3f803f80
    v_mov_b32 v234, 0x3f803f80
    v_mov_b32 v235, 0x3f803f80
Lm32_anp:
    s_and_b32 s41, s2, 1
    s_lshl_b32 s41, s41, 1
    s_lshr_b32 s42, s2, 7
    s_add_u32 s41, s41, s42
    s_mul_i32 s41, s41, 9
    s_add_u32 s41, s41, s16
    s_mul_i32 s17, s41, 18432
    s_add_u32 s17, s17, 2097152
    s_cmp_eq_u32 s16, 7
    s_cbranch_scc1 Lm34_p
    s_barrier
    s_branch Lm35_j
Lm34_p:
    v_lshl_add_u32 v13, v0, 7, s79
    s_mov_b32 s3, 0x40000
    s_mov_b32 exec_lo, 4294967295
    s_mov_b32 exec_hi, 65535
    s_cmp_lg_u32 s79, 0
    s_cbranch_scc1 Lm36_l
    s_mov_b64 exec, -1
    s_mov_b32 exec_hi, 0xfffffff
Lm36_l:
    buffer_load_dword v14, v13, s[12:15], s27 offen sc1
    s_waitcnt vmcnt(0)
    v_cmp_ne_u32 vcc, s80, v14
    s_sub_u32 s3, s3, 1
    s_cbranch_scc1 Lm37_d
    s_nop 2
    s_cbranch_vccz Lm37_d
    s_sleep 4
    s_branch Lm36_l
Lm37_d:
    s_mov_b64 exec, -1
    s_barrier
Lm35_j:
    buffer_load_dwordx4 v[16:19], v1, s[12:15], s32 offen sc1
    buffer_load_dwordx4 v[20:23], v1, s[12:15], s33 offen sc1
    s_mov_b64 exec, s[28:29]
    buffer_load_dword v24, v4, s[12:15], s35 offen sc1
    buffer_load_dword v26, v4, s[12:15], s36 offen sc1
    s_mov_b64 exec, -1
    s_add_u32 m0, s45, 0
    s_add_u32 s41, s34, 0
    buffer_load_dwordx4 v1, s[12:15], s41 offen sc1 lds
    s_add_u32 m0, s46, 0
    s_add_u32 s41, s37, 0
    buffer_load_dword v7, s[12:15], s41 offen sc1 lds
    s_add_u32 m0, s45, 65536
    s_add_u32 s41, s38, 0
    buffer_load_dwordx4 v8, s[12:15], s41 offen sc1 lds
    s_add_u32 m0, s45, 32768
    s_add_u32 s41, s34, 32768
    buffer_load_dwordx4 v1, s[12:15], s41 offen sc1 lds
    s_add_u32 m0, s45, 102400
    s_add_u32 s41, s38, 32768
    buffer_load_dwordx4 v8, s[12:15], s41 offen sc1 lds
    s_mul_i32 s41, s16, 9216
    s_add_u32 m0, s41, 73728
    s_lshl_b32 s41, s16, 13
    s_add_u32 s41, s41, s38
    buffer_load_dwordx4 v9, s[12:15], s41 offen sc1 lds
    s_waitcnt vmcnt(0)
    s_barrier
    ds_read_b128 v[72:75], v1
    ds_read_b32 v76, v12
    s_waitcnt lgkmcnt(0)
    v_mfma_f32_32x32x16_bf16 v[120:135], v[72:75], v[16:19], 0
    v_mfma_f32_32x32x8_bf16 v[120:135], v[76:77], v[24:25], v[120:135]
    v_mfma_f32_32x32x16_bf16 v[136:151], v[72:75], v[20:23], 0
    v_mfma_f32_32x32x8_bf16 v[136:151], v[76:77], v[26:27], v[136:151]
    s_nop 9
    v_max3_f32 v14, v120, v121, v122
    v_max3_f32 v14, v14, v123, v124
    v_max3_f32 v14, v14, v125, v126
    v_max3_f32 v14, v14, v127, v128
    v_max3_f32 v14, v14, v129, v130
    v_max3_f32 v14, v14, v131, v132
    v_max3_f32 v14, v14, v133, v134
    v_max_f32 v14, v14, v135
    v_max3_f32 v15, v136, v137, v138
    v_max3_f32 v15, v15, v139, v140
    v_max3_f32 v15, v15, v141, v142
    v_max3_f32 v15, v15, v143, v144
    v_max3_f32 v15, v15, v145, v146
    v_max3_f32 v15, v15, v147, v148
    v_max3_f32 v15, v15, v149, v150
    v_max_f32 v15, v15, v151
Lm38_setmax:
    ds_read_b128 v[28:31], v10 offset:0
    ds_read_b32 v40, v11 offset:0
    ds_read_b128 v[32:35], v10 offset:1024
    ds_read_b32 v42, v11 offset:128
    s_mov_b64 exec, s[30:31]
    ds_read_b128 v[48:51], v5 offset:0
    ds_read_b128 v[52:55], v5 offset:576
    s_mov_b64 exec, -1
    v_mov_b32 v88, v14
    v_mov_b32 v89, v15
    v_cmp_eq_u32 vcc, 0, v3
    s_nop 0
    v_permlane32_swap_b32 v14, v88
    v_permlane32_swap_b32 v15, v89
    v_max_f32 v14, v14, v88
    v_max_f32 v15, v15, v89
    v_and_b32 v88, 0xffff0000, v14
    v_and_b32 v89, 0xffff0000, v15
    v_sub_f32 v14, v88, v14
    v_sub_f32 v15, v89, v15
    v_and_b32 v90, 0xffff0000, v14
    v_and_b32 v91, 0xffff0000, v15
    v_sub_f32 v14, v14, v90
    v_sub_f32 v15, v15, v91
    v_cvt_pk_bf16_f32 v88, -v88, v90
    v_cvt_pk_bf16_f32 v89, -v89, v91
    v_cvt_pk_bf16_f32 v14, v14, 0
    v_cvt_pk_bf16_f32 v15, v15, 0
    v_cndmask_b32 v25, v14, v88, vcc
    v_cndmask_b32 v27, v15, v89, vcc
    s_waitcnt lgkmcnt(4)
    v_mfma_f32_32x32x16_bf16 v[120:135], v[28:31], v[16:19], 0
    v_mfma_f32_32x32x8_bf16 v[120:135], v[40:41], v[24:25], v[120:135]
    s_add_u32 m0, s45, 8192
    s_add_u32 s41, s34, 8192
    buffer_load_dwordx4 v1, s[12:15], s41 offen sc1 lds
    s_add_u32 m0, s46, 1024
    s_add_u32 s41, s37, 2048
    buffer_load_dword v7, s[12:15], s41 offen sc1 lds
    s_add_u32 m0, s45, 74752
    s_add_u32 s41, s38, 8192
    buffer_load_dwordx4 v8, s[12:15], s41 offen sc1 lds
    v_mfma_f32_32x32x16_bf16 v[136:151], v[28:31], v[20:23], 0
    s_nop 1
    v_exp_f32 v120, v120
    v_exp_f32 v121, v121
    v_exp_f32 v122, v122
    v_exp_f32 v123, v123
    v_cvt_pk_bf16_f32 v72, v120, v121
    v_mfma_f32_32x32x8_bf16 v[136:151], v[40:41], v[26:27], v[136:151]
    v_exp_f32 v124, v124
    v_exp_f32 v125, v125
    v_cvt_pk_bf16_f32 v73, v122, v123
    v_exp_f32 v126, v126
    v_exp_f32 v127, v127
    v_cvt_pk_bf16_f32 v74, v124, v125
    v_exp_f32 v128, v128
    v_exp_f32 v129, v129
    v_cvt_pk_bf16_f32 v75, v126, v127
    v_exp_f32 v130, v130
    v_exp_f32 v131, v131
    v_cvt_pk_bf16_f32 v76, v128, v129
    v_exp_f32 v132, v132
    v_exp_f32 v133, v133
    v_cvt_pk_bf16_f32 v77, v130, v131
    v_exp_f32 v134, v134
    v_exp_f32 v135, v135
    v_cvt_pk_bf16_f32 v78, v132, v133
    v_cvt_pk_bf16_f32 v79, v134, v135
    s_add_u32 m0, s45, 40960
    s_add_u32 s41, s34, 40960
    buffer_load_dwordx4 v1, s[12:15], s41 offen sc1 lds
    s_add_u32 m0, s45, 111616
    s_add_u32 s41, s38, 40960
    buffer_load_dwordx4 v8, s[12:15], s41 offen sc1 lds
    s_add_u32 m0, s45, 16384
    s_add_u32 s41, s34, 16384
    buffer_load_dwordx4 v1, s[12:15], s41 offen sc1 lds
    ds_read_b128 v[28:31], v10 offset:2048
    ds_read_b32 v40, v11 offset:256
    s_mov_b64 exec, s[30:31]
    ds_read_b128 v[56:59], v5 offset:1152
    ds_read_b128 v[60:63], v5 offset:1728
    s_mov_b64 exec, -1
    s_waitcnt lgkmcnt(6)
    v_mfma_f32_32x32x16_bf16 v[120:135], v[32:35], v[16:19], 0
    v_exp_f32 v136, v136
    v_exp_f32 v137, v137
    v_exp_f32 v138, v138
    v_exp_f32 v139, v139
    v_cvt_pk_bf16_f32 v80, v136, v137
    v_mfma_f32_32x32x8_bf16 v[120:135], v[42:43], v[24:25], v[120:135]
    v_exp_f32 v140, v140
    v_exp_f32 v141, v141
    v_cvt_pk_bf16_f32 v81, v138, v139
    v_exp_f32 v142, v142
    v_exp_f32 v143, v143
    v_cvt_pk_bf16_f32 v82, v140, v141
    s_waitcnt lgkmcnt(4)
    v_mfma_f32_32x32x16_bf16 v[152:167], v[48:51], v[72:75], 0
    v_exp_f32 v144, v144
    v_exp_f32 v145, v145
    v_cvt_pk_bf16_f32 v83, v142, v143
    v_exp_f32 v146, v146
    v_exp_f32 v147, v147
    v_cvt_pk_bf16_f32 v84, v144, v145
    v_mfma_f32_32x32x16_bf16 v[152:167], v[52:55], v[76:79], v[152:167]
    v_exp_f32 v148, v148
    v_exp_f32 v149, v149
    v_cvt_pk_bf16_f32 v85, v146, v147
    v_exp_f32 v150, v150
    v_exp_f32 v151, v151
    v_cvt_pk_bf16_f32 v86, v148, v149
    v_cvt_pk_bf16_f32 v87, v150, v151
    s_add_u32 m0, s46, 2048
    s_add_u32 s41, s37, 4096
    buffer_load_dword v7, s[12:15], s41 offen sc1 lds
    s_add_u32 m0, s45, 83968
    s_add_u32 s41, s38, 16384
    buffer_load_dwordx4 v8, s[12:15], s41 offen sc1 lds
    s_add_u32 m0, s45, 49152
    s_add_u32 s41, s34, 49152
    buffer_load_dwordx4 v1, s[12:15], s41 offen sc1 lds
    v_mfma_f32_32x32x16_bf16 v[136:151], v[32:35], v[20:23], 0
    v_exp_f32 v120, v120
    v_exp_f32 v121, v121
    v_exp_f32 v122, v122
    v_exp_f32 v123, v123
    v_cvt_pk_bf16_f32 v72, v120, v121
    v_mfma_f32_32x32x8_bf16 v[136:151], v[42:43], v[26:27], v[136:151]
    v_exp_f32 v124, v124
    v_exp_f32 v125, v125
    v_cvt_pk_bf16_f32 v73, v122, v123
    v_exp_f32 v126, v126
    v_exp_f32 v127, v127
    v_cvt_pk_bf16_f32 v74, v124, v125
    v_mfma_f32_32x32x16_bf16 v[168:183], v[48:51], v[80:83], 0
    v_exp_f32 v128, v128
    v_exp_f32 v129, v129
    v_cvt_pk_bf16_f32 v75, v126, v127
    v_exp_f32 v130, v130
    v_exp_f32 v131, v131
    v_cvt_pk_bf16_f32 v76, v128, v129
    v_mfma_f32_32x32x16_bf16 v[168:183], v[52:55], v[84:87], v[168:183]
    v_exp_f32 v132, v132
    v_exp_f32 v133, v133
    v_cvt_pk_bf16_f32 v77, v130, v131
    v_exp_f32 v134, v134
    v_exp_f32 v135, v135
    v_cvt_pk_bf16_f32 v78, v132, v133
    v_cvt_pk_bf16_f32 v79, v134, v135
    s_add_u32 m0, s45, 120832
    s_add_u32 s41, s38, 49152
    buffer_load_dwordx4 v8, s[12:15], s41 offen sc1 lds
    s_add_u32 m0, s45, 24576
    s_add_u32 s41, s34, 24576
    buffer_load_dwordx4 v1, s[12:15], s41 offen sc1 lds
    s_add_u32 m0, s46, 3072
    s_add_u32 s41, s37, 6144
    buffer_load_dword v7, s[12:15], s41 offen sc1 lds
    ds_read_b128 v[32:35], v10 offset:3072
    ds_read_b32 v42, v11 offset:384
    s_mov_b64 exec, s[30:31]
    ds_read_b128 v[48:51], v5 offset:2304
    ds_read_b128 v[52:55], v5 offset:2880
    s_mov_b64 exec, -1
    s_waitcnt lgkmcnt(6)
    v_mfma_f32_32x32x16_bf16 v[120:135], v[28:31], v[16:19], 0
    v_exp_f32 v136, v136
    v_exp_f32 v137, v137
    v_exp_f32 v138, v138
    v_exp_f32 v139, v139
    v_cvt_pk_bf16_f32 v80, v136, v137
    v_mfma_f32_32x32x8_bf16 v[120:135], v[40:41], v[24:25], v[120:135]
    v_exp_f32 v140, v140
    v_exp_f32 v141, v141
    v_cvt_pk_bf16_f32 v81, v138, v139
    v_exp_f32 v142, v142
    v_exp_f32 v143, v143
    v_cvt_pk_bf16_f32 v82, v140, v141
    s_waitcnt lgkmcnt(4)
    v_mfma_f32_32x32x16_bf16 v[152:167], v[56:59], v[72:75], v[152:167]
    v_exp_f32 v144, v144
    v_exp_f32 v145, v145
    v_cvt_pk_bf16_f32 v83, v142, v143
    v_exp_f32 v146, v146
    v_exp_f32 v147, v147
    v_cvt_pk_bf16_f32 v84, v144, v145
    v_mfma_f32_32x32x16_bf16 v[152:167], v[60:63], v[76:79], v[152:167]
    v_exp_f32 v148, v148
    v_exp_f32 v149, v149
    v_cvt_pk_bf16_f32 v85, v146, v147
    v_exp_f32 v150, v150
    v_exp_f32 v151, v151
    v_cvt_pk_bf16_f32 v86, v148, v149
    v_cvt_pk_bf16_f32 v87, v150, v151
    s_add_u32 m0, s45, 93184
    s_add_u32 s41, s38, 24576
    buffer_load_dwordx4 v8, s[12:15], s41 offen sc1 lds
    s_add_u32 m0, s45, 57344
    s_add_u32 s41, s34, 57344
    buffer_load_dwordx4 v1, s[12:15], s41 offen sc1 lds
    s_add_u32 m0, s45, 130048
    s_add_u32 s41, s38, 57344
    buffer_load_dwordx4 v8, s[12:15], s41 offen sc1 lds
    v_mfma_f32_32x32x16_bf16 v[136:151], v[28:31], v[20:23], 0
    v_exp_f32 v120, v120
    v_exp_f32 v121, v121
    v_exp_f32 v122, v122
    v_exp_f32 v123, v123
    v_cvt_pk_bf16_f32 v72, v120, v121
    v_mfma_f32_32x32x8_bf16 v[136:151], v[40:41], v[26:27], v[136:151]
    v_exp_f32 v124, v124
    v_exp_f32 v125, v125
    v_cvt_pk_bf16_f32 v73, v122, v123
    v_exp_f32 v126, v126
    v_exp_f32 v127, v127
    v_cvt_pk_bf16_f32 v74, v124, v125
    v_mfma_f32_32x32x16_bf16 v[168:183], v[56:59], v[80:83], v[168:183]
    v_exp_f32 v128, v128
    v_exp_f32 v129, v129
    v_cvt_pk_bf16_f32 v75, v126, v127
    v_exp_f32 v130, v130
    v_exp_f32 v131, v131
    v_cvt_pk_bf16_f32 v76, v128, v129
    v_mfma_f32_32x32x16_bf16 v[168:183], v[60:63], v[84:87], v[168:183]
    v_exp_f32 v132, v132
    v_exp_f32 v133, v133
    v_cvt_pk_bf16_f32 v77, v130, v131
    v_exp_f32 v134, v134
    v_exp_f32 v135, v135
    v_cvt_pk_bf16_f32 v78, v132, v133
    v_cvt_pk_bf16_f32 v79, v134, v135
    ds_read_b128 v[28:31], v10 offset:4096
    ds_read_b32 v40, v11 offset:512
    s_mov_b64 exec, s[30:31]
    ds_read_b128 v[56:59], v5 offset:3456
    ds_read_b128 v[60:63], v5 offset:4032
    s_mov_b64 exec, -1
    s_waitcnt lgkmcnt(6)
    v_mfma_f32_32x32x16_bf16 v[120:135], v[32:35], v[16:19], 0
    v_exp_f32 v136, v136
    v_exp_f32 v137, v137
    v_exp_f32 v138, v138
    v_exp_f32 v139, v139
    v_cvt_pk_bf16_f32 v80, v136, v137
    v_mfma_f32_32x32x8_bf16 v[120:135], v[42:43], v[24:25], v[120:135]
    v_exp_f32 v140, v140
    v_exp_f32 v141, v141
    v_cvt_pk_bf16_f32 v81, v138, v139
    v_exp_f32 v142, v142
    v_exp_f32 v143, v143
    v_cvt_pk_bf16_f32 v82, v140, v141
    s_waitcnt lgkmcnt(4)
    v_mfma_f32_32x32x16_bf16 v[152:167], v[48:51], v[72:75], v[152:167]
    v_exp_f32 v144, v144
    v_exp_f32 v145, v145
    v_cvt_pk_bf16_f32 v83, v142, v143
    v_exp_f32 v146, v146
    v_exp_f32 v147, v147
    v_cvt_pk_bf16_f32 v84, v144, v145
    v_mfma_f32_32x32x16_bf16 v[152:167], v[52:55], v[76:79], v[152:167]
    v_exp_f32 v148, v148
    v_exp_f32 v149, v149
    v_cvt_pk_bf16_f32 v85, v146, v147
    v_exp_f32 v150, v150
    v_exp_f32 v151, v151
    v_cvt_pk_bf16_f32 v86, v148, v149
    v_cvt_pk_bf16_f32 v87, v150, v151
    v_mfma_f32_32x32x16_bf16 v[136:151], v[32:35], v[20:23], 0
    v_exp_f32 v120, v120
    v_exp_f32 v121, v121
    v_exp_f32 v122, v122
    v_exp_f32 v123, v123
    v_cvt_pk_bf16_f32 v72, v120, v121
    v_mfma_f32_32x32x8_bf16 v[136:151], v[42:43], v[26:27], v[136:151]
    v_exp_f32 v124, v124
    v_exp_f32 v125, v125
    v_cvt_pk_bf16_f32 v73, v122, v123
    v_exp_f32 v126, v126
    v_exp_f32 v127, v127
    v_cvt_pk_bf16_f32 v74, v124, v125
    v_mfma_f32_32x32x16_bf16 v[168:183], v[48:51], v[80:83], v[168:183]
    v_exp_f32 v128, v128
    v_exp_f32 v129, v129
    v_cvt_pk_bf16_f32 v75, v126, v127
    v_exp_f32 v130, v130
    v_exp_f32 v131, v131
    v_cvt_pk_bf16_f32 v76, v128, v129
    v_mfma_f32_32x32x16_bf16 v[168:183], v[52:55], v[84:87], v[168:183]
    v_exp_f32 v132, v132
    v_exp_f32 v133, v133
    v_cvt_pk_bf16_f32 v77, v130, v131
    v_exp_f32 v134, v134
    v_exp_f32 v135, v135
    v_cvt_pk_bf16_f32 v78, v132, v133
    v_cvt_pk_bf16_f32 v79, v134, v135
    ds_read_b128 v[32:35], v10 offset:5120
    ds_read_b32 v42, v11 offset:640
    s_mov_b64 exec, s[30:31]
    ds_read_b128 v[48:51], v5 offset:4608
    ds_read_b128 v[52:55], v5 offset:5184
    s_mov_b64 exec, -1
    s_waitcnt lgkmcnt(6)
    v_mfma_f32_32x32x16_bf16 v[120:135], v[28:31], v[16:19], 0
    v_exp_f32 v136, v136
    v_exp_f32 v137, v137
    v_exp_f32 v138, v138
    v_exp_f32 v139, v139
    v_cvt_pk_bf16_f32 v80, v136, v137
    v_mfma_f32_32x32x8_bf16 v[120:135], v[40:41], v[24:25], v[120:135]
    v_exp_f32 v140, v140
    v_exp_f32 v141, v141
    v_cvt_pk_bf16_f32 v81, v138, v139
    v_exp_f32 v142, v142
    v_exp_f32 v143, v143
    v_cvt_pk_bf16_f32 v82, v140, v141
    s_waitcnt lgkmcnt(4)
    v_mfma_f32_32x32x16_bf16 v[152:167], v[56:59], v[72:75], v[152:167]
    v_exp_f32 v144, v144
    v_exp_f32 v145, v145
    v_cvt_pk_bf16_f32 v83, v142, v143
    v_exp_f32 v146, v146
    v_exp_f32 v147, v147
    v_cvt_pk_bf16_f32 v84, v144, v145
    v_mfma_f32_32x32x16_bf16 v[152:167], v[60:63], v[76:79], v[152:167]
    v_exp_f32 v148, v148
    v_exp_f32 v149, v149
    v_cvt_pk_bf16_f32 v85, v146, v147
    v_exp_f32 v150, v150
    v_exp_f32 v151, v151
    v_cvt_pk_bf16_f32 v86, v148, v149
    v_cvt_pk_bf16_f32 v87, v150, v151
    v_mfma_f32_32x32x16_bf16 v[136:151], v[28:31], v[20:23], 0
    v_exp_f32 v120, v120
    v_exp_f32 v121, v121
    v_exp_f32 v122, v122
    v_exp_f32 v123, v123
    v_cvt_pk_bf16_f32 v72, v120, v121
    v_mfma_f32_32x32x8_bf16 v[136:151], v[40:41], v[26:27], v[136:151]
    v_exp_f32 v124, v124
    v_exp_f32 v125, v125
    v_cvt_pk_bf16_f32 v73, v122, v123
    v_exp_f32 v126, v126
    v_exp_f32 v127, v127
    v_cvt_pk_bf16_f32 v74, v124, v125
    v_mfma_f32_32x32x16_bf16 v[168:183], v[56:59], v[80:83], v[168:183]
    v_exp_f32 v128, v128
    v_exp_f32 v129, v129
    v_cvt_pk_bf16_f32 v75, v126, v127
    v_exp_f32 v130, v130
    v_exp_f32 v131, v131
    v_cvt_pk_bf16_f32 v76, v128, v129
    v_mfma_f32_32x32x16_bf16 v[168:183], v[60:63], v[84:87], v[168:183]
    v_exp_f32 v132, v132
    v_exp_f32 v133, v133
    v_cvt_pk_bf16_f32 v77, v130, v131
    v_exp_f32 v134, v134
    v_exp_f32 v135, v135
    v_cvt_pk_bf16_f32 v78, v132, v133
    v_cvt_pk_bf16_f32 v79, v134, v135
    ds_read_b128 v[28:31], v10 offset:6144
    ds_read_b32 v40, v11 offset:768
    s_mov_b64 exec, s[30:31]
    ds_read_b128 v[56:59], v5 offset:5760
    ds_read_b128 v[60:63], v5 offset:6336
    s_mov_b64 exec, -1
    s_waitcnt lgkmcnt(6)
    v_mfma_f32_32x32x16_bf16 v[120:135], v[32:35], v[16:19], 0
    v_exp_f32 v136, v136
    v_exp_f32 v137, v137
    v_exp_f32 v138, v138
    v_exp_f32 v139, v139
    v_cvt_pk_bf16_f32 v80, v136, v137
    v_mfma_f32_32x32x8_bf16 v[120:135], v[42:43], v[24:25], v[120:135]
    v_exp_f32 v140, v140
    v_exp_f32 v141, v141
    v_cvt_pk_bf16_f32 v81, v138, v139
    v_exp_f32 v142, v142
    v_exp_f32 v143, v143
    v_cvt_pk_bf16_f32 v82, v140, v141
    s_waitcnt lgkmcnt(4)
    v_mfma_f32_32x32x16_bf16 v[152:167], v[48:51], v[72:75], v[152:167]
    v_exp_f32 v144, v144
    v_exp_f32 v145, v145
    v_cvt_pk_bf16_f32 v83, v142, v143
    v_exp_f32 v146, v146
    v_exp_f32 v147, v147
    v_cvt_pk_bf16_f32 v84, v144, v145
    v_mfma_f32_32x32x16_bf16 v[152:167], v[52:55], v[76:79], v[152:167]
    v_exp_f32 v148, v148
    v_exp_f32 v149, v149
    v_cvt_pk_bf16_f32 v85, v146, v147
    v_exp_f32 v150, v150
    v_exp_f32 v151, v151
    v_cvt_pk_bf16_f32 v86, v148, v149
    v_cvt_pk_bf16_f32 v87, v150, v151
    v_mfma_f32_32x32x16_bf16 v[136:151], v[32:35], v[20:23], 0
    v_exp_f32 v120, v120
    v_exp_f32 v121, v121
    v_exp_f32 v122, v122
    v_exp_f32 v123, v123
    v_cvt_pk_bf16_f32 v72, v120, v121
    v_mfma_f32_32x32x8_bf16 v[136:151], v[42:43], v[26:27], v[136:151]
    v_exp_f32 v124, v124
    v_exp_f32 v125, v125
    v_cvt_pk_bf16_f32 v73, v122, v123
    v_exp_f32 v126, v126
    v_exp_f32 v127, v127
    v_cvt_pk_bf16_f32 v74, v124, v125
    v_mfma_f32_32x32x16_bf16 v[168:183], v[48:51], v[80:83], v[168:183]
    v_exp_f32 v128, v128
    v_exp_f32 v129, v129
    v_cvt_pk_bf16_f32 v75, v126, v127
    v_exp_f32 v130, v130
    v_exp_f32 v131, v131
    v_cvt_pk_bf16_f32 v76, v128, v129
    v_mfma_f32_32x32x16_bf16 v[168:183], v[52:55], v[84:87], v[168:183]
    v_exp_f32 v132, v132
    v_exp_f32 v133, v133
    v_cvt_pk_bf16_f32 v77, v130, v131
    v_exp_f32 v134, v134
    v_exp_f32 v135, v135
    v_cvt_pk_bf16_f32 v78, v132, v133
    v_cvt_pk_bf16_f32 v79, v134, v135
    s_waitcnt vmcnt(0)
    s_barrier
    s_cmp_lt_u32 s16, 4
    s_cbranch_scc1 Lm45_npr
    s_setprio 1
Lm45_npr:
    ds_read_b128 v[32:35], v10 offset:7168
    ds_read_b32 v42, v11 offset:896
    s_mov_b64 exec, s[30:31]
    ds_read_b128 v[48:51], v5 offset:6912
    ds_read_b128 v[52:55], v5 offset:7488
    s_mov_b64 exec, -1
    s_waitcnt lgkmcnt(6)
    v_mfma_f32_32x32x16_bf16 v[120:135], v[28:31], v[16:19], 0
    v_exp_f32 v136, v136
    v_exp_f32 v137, v137
    v_exp_f32 v138, v138
    v_exp_f32 v139, v139
    v_cvt_pk_bf16_f32 v80, v136, v137
    v_mfma_f32_32x32x8_bf16 v[120:135], v[40:41], v[24:25], v[120:135]
    v_exp_f32 v140, v140
    v_exp_f32 v141, v141
    v_cvt_pk_bf16_f32 v81, v138, v139
    v_exp_f32 v142, v142
    v_exp_f32 v143, v143
    v_cvt_pk_bf16_f32 v82, v140, v141
    s_waitcnt lgkmcnt(4)
    v_mfma_f32_32x32x16_bf16 v[152:167], v[56:59], v[72:75], v[152:167]
    v_exp_f32 v144, v144
    v_exp_f32 v145, v145
    v_cvt_pk_bf16_f32 v83, v142, v143
    v_exp_f32 v146, v146
    v_exp_f32 v147, v147
    v_cvt_pk_bf16_f32 v84, v144, v145
    v_mfma_f32_32x32x16_bf16 v[152:167], v[60:63], v[76:79], v[152:167]
    v_exp_f32 v148, v148
    v_exp_f32 v149, v149
    v_cvt_pk_bf16_f32 v85, v146, v147
    v_exp_f32 v150, v150
    v_exp_f32 v151, v151
    v_cvt_pk_bf16_f32 v86, v148, v149
    v_cvt_pk_bf16_f32 v87, v150, v151
    s_cmp_lg_u32 s79, 0
    s_cbranch_scc1 Lm46_np
    buffer_load_dwordx4 v[192:195], v184, s[48:51], s52 offen
Lm46_np:
    v_mfma_f32_32x32x16_bf16 v[136:151], v[28:31], v[20:23], 0
    v_exp_f32 v120, v120
    v_exp_f32 v121, v121
    v_exp_f32 v122, v122
    v_exp_f32 v123, v123
    v_cvt_pk_bf16_f32 v72, v120, v121
    v_mfma_f32_32x32x8_bf16 v[136:151], v[40:41], v[26:27], v[136:151]
    v_exp_f32 v124, v124
    v_exp_f32 v125, v125
    v_cvt_pk_bf16_f32 v73, v122, v123
    v_exp_f32 v126, v126
    v_exp_f32 v127, v127
    v_cvt_pk_bf16_f32 v74, v124, v125
    v_mfma_f32_32x32x16_bf16 v[168:183], v[56:59], v[80:83], v[168:183]
    v_exp_f32 v128, v128
    v_exp_f32 v129, v129
    v_cvt_pk_bf16_f32 v75, v126, v127
    v_exp_f32 v130, v130
    v_exp_f32 v131, v131
    v_cvt_pk_bf16_f32 v76, v128, v129
    v_mfma_f32_32x32x16_bf16 v[168:183], v[60:63], v[84:87], v[168:183]
    v_exp_f32 v132, v132
    v_exp_f32 v133, v133
    v_cvt_pk_bf16_f32 v77, v130, v131
    v_exp_f32 v134, v134
    v_exp_f32 v135, v135
    v_cvt_pk_bf16_f32 v78, v132, v133
    v_cvt_pk_bf16_f32 v79, v134, v135
    ds_read_b128 v[28:31], v10 offset:8192
    ds_read_b32 v40, v11 offset:1024
    s_mov_b64 exec, s[30:31]
    ds_read_b128 v[56:59], v5 offset:8064
    ds_read_b128 v[60:63], v5 offset:8640
    s_mov_b64 exec, -1
    s_waitcnt lgkmcnt(6)
    v_mfma_f32_32x32x16_bf16 v[120:135], v[32:35], v[16:19], 0
    v_exp_f32 v136, v136
    v_exp_f32 v137, v137
    v_exp_f32 v138, v138
    v_exp_f32 v139, v139
    v_cvt_pk_bf16_f32 v80, v136, v137
    v_mfma_f32_32x32x8_bf16 v[120:135], v[42:43], v[24:25], v[120:135]
    v_exp_f32 v140, v140
    v_exp_f32 v141, v141
    v_cvt_pk_bf16_f32 v81, v138, v139
    v_exp_f32 v142, v142
    v_exp_f32 v143, v143
    v_cvt_pk_bf16_f32 v82, v140, v141
    s_waitcnt lgkmcnt(4)
    v_mfma_f32_32x32x16_bf16 v[152:167], v[48:51], v[72:75], v[152:167]
    v_exp_f32 v144, v144
    v_exp_f32 v145, v145
    v_cvt_pk_bf16_f32 v83, v142, v143
    v_exp_f32 v146, v146
    v_exp_f32 v147, v147
    v_cvt_pk_bf16_f32 v84, v144, v145
    v_mfma_f32_32x32x16_bf16 v[152:167], v[52:55], v[76:79], v[152:167]
    v_exp_f32 v148, v148
    v_exp_f32 v149, v149
    v_cvt_pk_bf16_f32 v85, v146, v147
    v_exp_f32 v150, v150
    v_exp_f32 v151, v151
    v_cvt_pk_bf16_f32 v86, v148, v149
    v_cvt_pk_bf16_f32 v87, v150, v151
    s_cmp_lg_u32 s79, 0
    s_cbranch_scc1 Lm47_np
    buffer_load_dwordx4 v[196:199], v184, s[48:51], s53 offen
Lm47_np:
    v_mfma_f32_32x32x16_bf16 v[136:151], v[32:35], v[20:23], 0
    v_exp_f32 v120, v120
    v_exp_f32 v121, v121
    v_exp_f32 v122, v122
    v_exp_f32 v123, v123
    v_cvt_pk_bf16_f32 v72, v120, v121
    v_mfma_f32_32x32x8_bf16 v[136:151], v[42:43], v[26:27], v[136:151]
    v_exp_f32 v124, v124
    v_exp_f32 v125, v125
    v_cvt_pk_bf16_f32 v73, v122, v123
    v_exp_f32 v126, v126
    v_exp_f32 v127, v127
    v_cvt_pk_bf16_f32 v74, v124, v125
    v_mfma_f32_32x32x16_bf16 v[168:183], v[48:51], v[80:83], v[168:183]
    v_exp_f32 v128, v128
    v_exp_f32 v129, v129
    v_cvt_pk_bf16_f32 v75, v126, v127
    v_exp_f32 v130, v130
    v_exp_f32 v131, v131
    v_cvt_pk_bf16_f32 v76, v128, v129
    v_mfma_f32_32x32x16_bf16 v[168:183], v[52:55], v[84:87], v[168:183]
    v_exp_f32 v132, v132
    v_exp_f32 v133, v133
    v_cvt_pk_bf16_f32 v77, v130, v131
    v_exp_f32 v134, v134
    v_exp_f32 v135, v135
    v_cvt_pk_bf16_f32 v78, v132, v133
    v_cvt_pk_bf16_f32 v79, v134, v135
    ds_read_b128 v[32:35], v10 offset:9216
    ds_read_b32 v42, v11 offset:1152
    s_mov_b64 exec, s[30:31]
    ds_read_b128 v[48:51], v5 offset:9216
    ds_read_b128 v[52:55], v5 offset:9792
    s_mov_b64 exec, -1
    s_waitcnt lgkmcnt(6)
    v_mfma_f32_32x32x16_bf16 v[120:135], v[28:31], v[16:19], 0
    v_exp_f32 v136, v136
    v_exp_f32 v137, v137
    v_exp_f32 v138, v138
    v_exp_f32 v139, v139
    v_cvt_pk_bf16_f32 v80, v136, v137
    v_mfma_f32_32x32x8_bf16 v[120:135], v[40:41], v[24:25], v[120:135]
    v_exp_f32 v140, v140
    v_exp_f32 v141, v141
    v_cvt_pk_bf16_f32 v81, v138, v139
    v_exp_f32 v142, v142
    v_exp_f32 v143, v143
    v_cvt_pk_bf16_f32 v82, v140, v141
    s_waitcnt lgkmcnt(4)
    v_mfma_f32_32x32x16_bf16 v[152:167], v[56:59], v[72:75], v[152:167]
    v_exp_f32 v144, v144
    v_exp_f32 v145, v145
    v_cvt_pk_bf16_f32 v83, v142, v143
    v_exp_f32 v146, v146
    v_exp_f32 v147, v147
    v_cvt_pk_bf16_f32 v84, v144, v145
    v_mfma_f32_32x32x16_bf16 v[152:167], v[60:63], v[76:79], v[152:167]
    v_exp_f32 v148, v148
    v_exp_f32 v149, v149
    v_cvt_pk_bf16_f32 v85, v146, v147
    v_exp_f32 v150, v150
    v_exp_f32 v151, v151
    v_cvt_pk_bf16_f32 v86, v148, v149
    v_cvt_pk_bf16_f32 v87, v150, v151
    s_cmp_lg_u32 s79, 0
    s_cbranch_scc1 Lm48_np
    buffer_load_dwordx4 v[200:203], v184, s[48:51], s54 offen
Lm48_np:
    v_mfma_f32_32x32x16_bf16 v[136:151], v[28:31], v[20:23], 0
    v_exp_f32 v120, v120
    v_exp_f32 v121, v121
    v_exp_f32 v122, v122
    v_exp_f32 v123, v123
    v_cvt_pk_bf16_f32 v72, v120, v121
    v_mfma_f32_32x32x8_bf16 v[136:151], v[40:41], v[26:27], v[136:151]
    v_exp_f32 v124, v124
    v_exp_f32 v125, v125
    v_cvt_pk_bf16_f32 v73, v122, v123
    v_exp_f32 v126, v126
    v_exp_f32 v127, v127
    v_cvt_pk_bf16_f32 v74, v124, v125
    v_mfma_f32_32x32x16_bf16 v[168:183], v[56:59], v[80:83], v[168:183]
    v_exp_f32 v128, v128
    v_exp_f32 v129, v129
    v_cvt_pk_bf16_f32 v75, v126, v127
    v_exp_f32 v130, v130
    v_exp_f32 v131, v131
    v_cvt_pk_bf16_f32 v76, v128, v129
    v_mfma_f32_32x32x16_bf16 v[168:183], v[60:63], v[84:87], v[168:183]
    v_exp_f32 v132, v132
    v_exp_f32 v133, v133
    v_cvt_pk_bf16_f32 v77, v130, v131
    v_exp_f32 v134, v134
    v_exp_f32 v135, v135
    v_cvt_pk_bf16_f32 v78, v132, v133
    v_cvt_pk_bf16_f32 v79, v134, v135
    ds_read_b128 v[28:31], v10 offset:10240
    ds_read_b32 v40, v11 offset:1280
    s_mov_b64 exec, s[30:31]
    ds_read_b128 v[56:59], v5 offset:10368
    ds_read_b128 v[60:63], v5 offset:10944
    s_mov_b64 exec, -1
    s_waitcnt lgkmcnt(6)
    v_mfma_f32_32x32x16_bf16 v[120:135], v[32:35], v[16:19], 0
    v_exp_f32 v136, v136
    v_exp_f32 v137, v137
    v_exp_f32 v138, v138
    v_exp_f32 v139, v139
    v_cvt_pk_bf16_f32 v80, v136, v137
    v_mfma_f32_32x32x8_bf16 v[120:135], v[42:43], v[24:25], v[120:135]
    v_exp_f32 v140, v140
    v_exp_f32 v141, v141
    v_cvt_pk_bf16_f32 v81, v138, v139
    v_exp_f32 v142, v142
    v_exp_f32 v143, v143
    v_cvt_pk_bf16_f32 v82, v140, v141
    s_waitcnt lgkmcnt(4)
    v_mfma_f32_32x32x16_bf16 v[152:167], v[48:51], v[72:75], v[152:167]
    v_exp_f32 v144, v144
    v_exp_f32 v145, v145
    v_cvt_pk_bf16_f32 v83, v142, v143
    v_exp_f32 v146, v146
    v_exp_f32 v147, v147
    v_cvt_pk_bf16_f32 v84, v144, v145
    v_mfma_f32_32x32x16_bf16 v[152:167], v[52:55], v[76:79], v[152:167]
    v_exp_f32 v148, v148
    v_exp_f32 v149, v149
    v_cvt_pk_bf16_f32 v85, v146, v147
    v_exp_f32 v150, v150
    v_exp_f32 v151, v151
    v_cvt_pk_bf16_f32 v86, v148, v149
    v_cvt_pk_bf16_f32 v87, v150, v151
    s_cmp_lg_u32 s79, 0
    s_cbranch_scc1 Lm49_np
    buffer_load_dwordx4 v[204:207], v184, s[48:51], s55 offen
Lm49_np:
    v_mfma_f32_32x32x16_bf16 v[136:151], v[32:35], v[20:23], 0
    v_exp_f32 v120, v120
    v_exp_f32 v121, v121
    v_exp_f32 v122, v122
    v_exp_f32 v123, v123
    v_cvt_pk_bf16_f32 v72, v120, v121
    v_mfma_f32_32x32x8_bf16 v[136:151], v[42:43], v[26:27], v[136:151]
    v_exp_f32 v124, v124
    v_exp_f32 v125, v125
    v_cvt_pk_bf16_f32 v73, v122, v123
    v_exp_f32 v126, v126
    v_exp_f32 v127, v127
    v_cvt_pk_bf16_f32 v74, v124, v125
    v_mfma_f32_32x32x16_bf16 v[168:183], v[48:51], v[80:83], v[168:183]
    v_exp_f32 v128, v128
    v_exp_f32 v129, v129
    v_cvt_pk_bf16_f32 v75, v126, v127
    v_exp_f32 v130, v130
    v_exp_f32 v131, v131
    v_cvt_pk_bf16_f32 v76, v128, v129
    v_mfma_f32_32x32x16_bf16 v[168:183], v[52:55], v[84:87], v[168:183]
    v_exp_f32 v132, v132
    v_exp_f32 v133, v133
    v_cvt_pk_bf16_f32 v77, v130, v131
    v_exp_f32 v134, v134
    v_exp_f32 v135, v135
    v_cvt_pk_bf16_f32 v78, v132, v133
    v_cvt_pk_bf16_f32 v79, v134, v135
    ds_read_b128 v[32:35], v10 offset:11264
    ds_read_b32 v42, v11 offset:1408
    s_mov_b64 exec, s[30:31]
    ds_read_b128 v[48:51], v5 offset:11520
    ds_read_b128 v[52:55], v5 offset:12096
    s_mov_b64 exec, -1
    s_waitcnt lgkmcnt(6)
    v_mfma_f32_32x32x16_bf16 v[120:135], v[28:31], v[16:19], 0
    v_exp_f32 v136, v136
    v_exp_f32 v137, v137
    v_exp_f32 v138, v138
    v_exp_f32 v139, v139
    v_cvt_pk_bf16_f32 v80, v136, v137
    v_mfma_f32_32x32x8_bf16 v[120:135], v[40:41], v[24:25], v[120:135]
    v_exp_f32 v140, v140
    v_exp_f32 v141, v141
    v_cvt_pk_bf16_f32 v81, v138, v139
    v_exp_f32 v142, v142
    v_exp_f32 v143, v143
    v_cvt_pk_bf16_f32 v82, v140, v141
    s_waitcnt lgkmcnt(4)
    v_mfma_f32_32x32x16_bf16 v[152:167], v[56:59], v[72:75], v[152:167]
    v_exp_f32 v144, v144
    v_exp_f32 v145, v145
    v_cvt_pk_bf16_f32 v83, v142, v143
    v_exp_f32 v146, v146
    v_exp_f32 v147, v147
    v_cvt_pk_bf16_f32 v84, v144, v145
    v_mfma_f32_32x32x16_bf16 v[152:167], v[60:63], v[76:79], v[152:167]
    v_exp_f32 v148, v148
    v_exp_f32 v149, v149
    v_cvt_pk_bf16_f32 v85, v146, v147
    v_exp_f32 v150, v150
    v_exp_f32 v151, v151
    v_cvt_pk_bf16_f32 v86, v148, v149
    v_cvt_pk_bf16_f32 v87, v150, v151
    s_cmp_lg_u32 s79, 0
    s_cbranch_scc1 Lm50_np
    buffer_load_dwordx4 v[208:211], v184, s[48:51], s56 offen
Lm50_np:
    v_mfma_f32_32x32x16_bf16 v[136:151], v[28:31], v[20:23], 0
    v_exp_f32 v120, v120
    v_exp_f32 v121, v121
    v_exp_f32 v122, v122
    v_exp_f32 v123, v123
    v_cvt_pk_bf16_f32 v72, v120, v121
    v_mfma_f32_32x32x8_bf16 v[136:151], v[40:41], v[26:27], v[136:151]
    v_exp_f32 v124, v124
    v_exp_f32 v125, v125
    v_cvt_pk_bf16_f32 v73, v122, v123
    v_exp_f32 v126, v126
    v_exp_f32 v127, v127
    v_cvt_pk_bf16_f32 v74, v124, v125
    v_mfma_f32_32x32x16_bf16 v[168:183], v[56:59], v[80:83], v[168:183]
    v_exp_f32 v128, v128
    v_exp_f32 v129, v129
    v_cvt_pk_bf16_f32 v75, v126, v127
    v_exp_f32 v130, v130
    v_exp_f32 v131, v131
    v_cvt_pk_bf16_f32 v76, v128, v129
    v_mfma_f32_32x32x16_bf16 v[168:183], v[60:63], v[84:87], v[168:183]
    v_exp_f32 v132, v132
    v_exp_f32 v133, v133
    v_cvt_pk_bf16_f32 v77, v130, v131
    v_exp_f32 v134, v134
    v_exp_f32 v135, v135
    v_cvt_pk_bf16_f32 v78, v132, v133
    v_cvt_pk_bf16_f32 v79, v134, v135
    ds_read_b128 v[28:31], v10 offset:12288
    ds_read_b32 v40, v11 offset:1536
    s_mov_b64 exec, s[30:31]
    ds_read_b128 v[56:59], v5 offset:12672
    ds_read_b128 v[60:63], v5 offset:13248
    s_mov_b64 exec, -1
    s_waitcnt lgkmcnt(6)
    v_mfma_f32_32x32x16_bf16 v[120:135], v[32:35], v[16:19], 0
    v_exp_f32 v136, v136
    v_exp_f32 v137, v137
    v_exp_f32 v138, v138
    v_exp_f32 v139, v139
    v_cvt_pk_bf16_f32 v80, v136, v137
    v_mfma_f32_32x32x8_bf16 v[120:135], v[42:43], v[24:25], v[120:135]
    v_exp_f32 v140, v140
    v_exp_f32 v141, v141
    v_cvt_pk_bf16_f32 v81, v138, v139
    v_exp_f32 v142, v142
    v_exp_f32 v143, v143
    v_cvt_pk_bf16_f32 v82, v140, v141
    s_waitcnt lgkmcnt(4)
    v_mfma_f32_32x32x16_bf16 v[152:167], v[48:51], v[72:75], v[152:167]
    v_exp_f32 v144, v144
    v_exp_f32 v145, v145
    v_cvt_pk_bf16_f32 v83, v142, v143
    v_exp_f32 v146, v146
    v_exp_f32 v147, v147
    v_cvt_pk_bf16_f32 v84, v144, v145
    v_mfma_f32_32x32x16_bf16 v[152:167], v[52:55], v[76:79], v[152:167]
    v_exp_f32 v148, v148
    v_exp_f32 v149, v149
    v_cvt_pk_bf16_f32 v85, v146, v147
    v_exp_f32 v150, v150
    v_exp_f32 v151, v151
    v_cvt_pk_bf16_f32 v86, v148, v149
    v_cvt_pk_bf16_f32 v87, v150, v151
    s_cmp_lg_u32 s79, 0
    s_cbranch_scc1 Lm51_np
    buffer_load_dwordx4 v[212:215], v184, s[48:51], s57 offen
Lm51_np:
    v_mfma_f32_32x32x16_bf16 v[136:151], v[32:35], v[20:23], 0
    v_exp_f32 v120, v120
    v_exp_f32 v121, v121
    v_exp_f32 v122, v122
    v_exp_f32 v123, v123
    v_cvt_pk_bf16_f32 v72, v120, v121
    v_mfma_f32_32x32x8_bf16 v[136:151], v[42:43], v[26:27], v[136:151]
    v_exp_f32 v124, v124
    v_exp_f32 v125, v125
    v_cvt_pk_bf16_f32 v73, v122, v123
    v_exp_f32 v126, v126
    v_exp_f32 v127, v127
    v_cvt_pk_bf16_f32 v74, v124, v125
    v_mfma_f32_32x32x16_bf16 v[168:183], v[48:51], v[80:83], v[168:183]
    v_exp_f32 v128, v128
    v_exp_f32 v129, v129
    v_cvt_pk_bf16_f32 v75, v126, v127
    v_exp_f32 v130, v130
    v_exp_f32 v131, v131
    v_cvt_pk_bf16_f32 v76, v128, v129
    v_mfma_f32_32x32x16_bf16 v[168:183], v[52:55], v[84:87], v[168:183]
    v_exp_f32 v132, v132
    v_exp_f32 v133, v133
    v_cvt_pk_bf16_f32 v77, v130, v131
    v_exp_f32 v134, v134
    v_exp_f32 v135, v135
    v_cvt_pk_bf16_f32 v78, v132, v133
    v_cvt_pk_bf16_f32 v79, v134, v135
    ds_read_b128 v[32:35], v10 offset:13312
    ds_read_b32 v42, v11 offset:1664
    s_mov_b64 exec, s[30:31]
    ds_read_b128 v[48:51], v5 offset:13824
    ds_read_b128 v[52:55], v5 offset:14400
    s_mov_b64 exec, -1
    s_waitcnt lgkmcnt(6)
    v_mfma_f32_32x32x16_bf16 v[120:135], v[28:31], v[16:19], 0
    v_exp_f32 v136, v136
    v_exp_f32 v137, v137
    v_exp_f32 v138, v138
    v_exp_f32 v139, v139
    v_cvt_pk_bf16_f32 v80, v136, v137
    v_mfma_f32_32x32x8_bf16 v[120:135], v[40:41], v[24:25], v[120:135]
    v_exp_f32 v140, v140
    v_exp_f32 v141, v141
    v_cvt_pk_bf16_f32 v81, v138, v139
    v_exp_f32 v142, v142
    v_exp_f32 v143, v143
    v_cvt_pk_bf16_f32 v82, v140, v141
    s_waitcnt lgkmcnt(4)
    v_mfma_f32_32x32x16_bf16 v[152:167], v[56:59], v[72:75], v[152:167]
    v_exp_f32 v144, v144
    v_exp_f32 v145, v145
    v_cvt_pk_bf16_f32 v83, v142, v143
    v_exp_f32 v146, v146
    v_exp_f32 v147, v147
    v_cvt_pk_bf16_f32 v84, v144, v145
    v_mfma_f32_32x32x16_bf16 v[152:167], v[60:63], v[76:79], v[152:167]
    v_exp_f32 v148, v148
    v_exp_f32 v149, v149
    v_cvt_pk_bf16_f32 v85, v146, v147
    v_exp_f32 v150, v150
    v_exp_f32 v151, v151
    v_cvt_pk_bf16_f32 v86, v148, v149
    v_cvt_pk_bf16_f32 v87, v150, v151
    s_cmp_lg_u32 s79, 0
    s_cbranch_scc1 Lm52_np
    buffer_load_dwordx4 v[216:219], v184, s[48:51], s58 offen
Lm52_np:
    v_mfma_f32_32x32x16_bf16 v[136:151], v[28:31], v[20:23], 0
    v_exp_f32 v120, v120
    v_exp_f32 v121, v121
    v_exp_f32 v122, v122
    v_exp_f32 v123, v123
    v_cvt_pk_bf16_f32 v72, v120, v121
    v_mfma_f32_32x32x8_bf16 v[136:151], v[40:41], v[26:27], v[136:151]
    v_exp_f32 v124, v124
    v_exp_f32 v125, v125
    v_cvt_pk_bf16_f32 v73, v122, v123
    v_exp_f32 v126, v126
    v_exp_f32 v127, v127
    v_cvt_pk_bf16_f32 v74, v124, v125
    v_mfma_f32_32x32x16_bf16 v[168:183], v[56:59], v[80:83], v[168:183]
    v_exp_f32 v128, v128
    v_exp_f32 v129, v129
    v_cvt_pk_bf16_f32 v75, v126, v127
    v_exp_f32 v130, v130
    v_exp_f32 v131, v131
    v_cvt_pk_bf16_f32 v76, v128, v129
    v_mfma_f32_32x32x16_bf16 v[168:183], v[60:63], v[84:87], v[168:183]
    v_exp_f32 v132, v132
    v_exp_f32 v133, v133
    v_cvt_pk_bf16_f32 v77, v130, v131
    v_exp_f32 v134, v134
    v_exp_f32 v135, v135
    v_cvt_pk_bf16_f32 v78, v132, v133
    v_cvt_pk_bf16_f32 v79, v134, v135
    ds_read_b128 v[28:31], v10 offset:14336
    ds_read_b32 v40, v11 offset:1792
    s_mov_b64 exec, s[30:31]
    ds_read_b128 v[56:59], v5 offset:14976
    ds_read_b128 v[60:63], v5 offset:15552
    s_mov_b64 exec, -1
    s_waitcnt lgkmcnt(6)
    v_mfma_f32_32x32x16_bf16 v[120:135], v[32:35], v[16:19], 0
    v_exp_f32 v136, v136
    v_exp_f32 v137, v137
    v_exp_f32 v138, v138
    v_exp_f32 v139, v139
    v_cvt_pk_bf16_f32 v80, v136, v137
    v_mfma_f32_32x32x8_bf16 v[120:135], v[42:43], v[24:25], v[120:135]
    v_exp_f32 v140, v140
    v_exp_f32 v141, v141
    v_cvt_pk_bf16_f32 v81, v138, v139
    v_exp_f32 v142, v142
    v_exp_f32 v143, v143
    v_cvt_pk_bf16_f32 v82, v140, v141
    s_waitcnt lgkmcnt(4)
    v_mfma_f32_32x32x16_bf16 v[152:167], v[48:51], v[72:75], v[152:167]
    v_exp_f32 v144, v144
    v_exp_f32 v145, v145
    v_cvt_pk_bf16_f32 v83, v142, v143
    v_exp_f32 v146, v146
    v_exp_f32 v147, v147
    v_cvt_pk_bf16_f32 v84, v144, v145
    v_mfma_f32_32x32x16_bf16 v[152:167], v[52:55], v[76:79], v[152:167]
    v_exp_f32 v148, v148
    v_exp_f32 v149, v149
    v_cvt_pk_bf16_f32 v85, v146, v147
    v_exp_f32 v150, v150
    v_exp_f32 v151, v151
    v_cvt_pk_bf16_f32 v86, v148, v149
    v_cvt_pk_bf16_f32 v87, v150, v151
    s_cmp_lg_u32 s79, 0
    s_cbranch_scc1 Lm53_np
    buffer_load_dwordx4 v[220:223], v184, s[48:51], s59 offen
Lm53_np:
    v_mfma_f32_32x32x16_bf16 v[136:151], v[32:35], v[20:23], 0
    v_exp_f32 v120, v120
    v_exp_f32 v121, v121
    v_exp_f32 v122, v122
    v_exp_f32 v123, v123
    v_cvt_pk_bf16_f32 v72, v120, v121
    v_mfma_f32_32x32x8_bf16 v[136:151], v[42:43], v[26:27], v[136:151]
    v_exp_f32 v124, v124
    v_exp_f32 v125, v125
    v_cvt_pk_bf16_f32 v73, v122, v123
    v_exp_f32 v126, v126
    v_exp_f32 v127, v127
    v_cvt_pk_bf16_f32 v74, v124, v125
    v_mfma_f32_32x32x16_bf16 v[168:183], v[48:51], v[80:83], v[168:183]
    v_exp_f32 v128, v128
    v_exp_f32 v129, v129
    v_cvt_pk_bf16_f32 v75, v126, v127
    v_exp_f32 v130, v130
    v_exp_f32 v131, v131
    v_cvt_pk_bf16_f32 v76, v128, v129
    v_mfma_f32_32x32x16_bf16 v[168:183], v[52:55], v[84:87], v[168:183]
    v_exp_f32 v132, v132
    v_exp_f32 v133, v133
    v_cvt_pk_bf16_f32 v77, v130, v131
    v_exp_f32 v134, v134
    v_exp_f32 v135, v135
    v_cvt_pk_bf16_f32 v78, v132, v133
    v_cvt_pk_bf16_f32 v79, v134, v135
    ds_read_b128 v[32:35], v10 offset:15360
    ds_read_b32 v42, v11 offset:1920
    s_mov_b64 exec, s[30:31]
    ds_read_b128 v[48:51], v5 offset:16128
    ds_read_b128 v[52:55], v5 offset:16704
    s_mov_b64 exec, -1
    s_waitcnt lgkmcnt(6)
    v_mfma_f32_32x32x16_bf16 v[120:135], v[28:31], v[16:19], 0
    v_exp_f32 v136, v136
    v_exp_f32 v137, v137
    v_exp_f32 v138, v138
    v_exp_f32 v139, v139
    v_cvt_pk_bf16_f32 v80, v136, v137
    v_mfma_f32_32x32x8_bf16 v[120:135], v[40:41], v[24:25], v[120:135]
    v_exp_f32 v140, v140
    v_exp_f32 v141, v141
    v_cvt_pk_bf16_f32 v81, v138, v139
    v_exp_f32 v142, v142
    v_exp_f32 v143, v143
    v_cvt_pk_bf16_f32 v82, v140, v141
    s_waitcnt lgkmcnt(4)
    v_mfma_f32_32x32x16_bf16 v[152:167], v[56:59], v[72:75], v[152:167]
    v_exp_f32 v144, v144
    v_exp_f32 v145, v145
    v_cvt_pk_bf16_f32 v83, v142, v143
    v_exp_f32 v146, v146
    v_exp_f32 v147, v147
    v_cvt_pk_bf16_f32 v84, v144, v145
    v_mfma_f32_32x32x16_bf16 v[152:167], v[60:63], v[76:79], v[152:167]
    v_exp_f32 v148, v148
    v_exp_f32 v149, v149
    v_cvt_pk_bf16_f32 v85, v146, v147
    v_exp_f32 v150, v150
    v_exp_f32 v151, v151
    v_cvt_pk_bf16_f32 v86, v148, v149
    v_cvt_pk_bf16_f32 v87, v150, v151
    v_mfma_f32_32x32x16_bf16 v[136:151], v[28:31], v[20:23], 0
    v_exp_f32 v120, v120
    v_exp_f32 v121, v121
    v_exp_f32 v122, v122
    v_exp_f32 v123, v123
    v_cvt_pk_bf16_f32 v72, v120, v121
    v_mfma_f32_32x32x8_bf16 v[136:151], v[40:41], v[26:27], v[136:151]
    v_exp_f32 v124, v124
    v_exp_f32 v125, v125
    v_cvt_pk_bf16_f32 v73, v122, v123
    v_exp_f32 v126, v126
    v_exp_f32 v127, v127
    v_cvt_pk_bf16_f32 v74, v124, v125
    v_mfma_f32_32x32x16_bf16 v[168:183], v[56:59], v[80:83], v[168:183]
    v_exp_f32 v128, v128
    v_exp_f32 v129, v129
    v_cvt_pk_bf16_f32 v75, v126, v127
    v_exp_f32 v130, v130
    v_exp_f32 v131, v131
    v_cvt_pk_bf16_f32 v76, v128, v129
    v_mfma_f32_32x32x16_bf16 v[168:183], v[60:63], v[84:87], v[168:183]
    v_exp_f32 v132, v132
    v_exp_f32 v133, v133
    v_cvt_pk_bf16_f32 v77, v130, v131
    v_exp_f32 v134, v134
    v_exp_f32 v135, v135
    v_cvt_pk_bf16_f32 v78, v132, v133
    v_cvt_pk_bf16_f32 v79, v134, v135
    ds_read_b128 v[28:31], v10 offset:16384
    ds_read_b32 v40, v11 offset:2048
    s_mov_b64 exec, s[30:31]
    ds_read_b128 v[56:59], v5 offset:17280
    ds_read_b128 v[60:63], v5 offset:17856
    s_mov_b64 exec, -1
    s_waitcnt lgkmcnt(6)
    v_mfma_f32_32x32x16_bf16 v[120:135], v[32:35], v[16:19], 0
    v_exp_f32 v136, v136
    v_exp_f32 v137, v137
    v_exp_f32 v138, v138
    v_exp_f32 v139, v139
    v_cvt_pk_bf16_f32 v80, v136, v137
    v_mfma_f32_32x32x8_bf16 v[120:135], v[42:43], v[24:25], v[120:135]
    v_exp_f32 v140, v140
    v_exp_f32 v141, v141
    v_cvt_pk_bf16_f32 v81, v138, v139
    v_exp_f32 v142, v142
    v_exp_f32 v143, v143
    v_cvt_pk_bf16_f32 v82, v140, v141
    s_waitcnt lgkmcnt(4)
    v_mfma_f32_32x32x16_bf16 v[152:167], v[48:51], v[72:75], v[152:167]
    v_exp_f32 v144, v144
    v_exp_f32 v145, v145
    v_cvt_pk_bf16_f32 v83, v142, v143
    v_exp_f32 v146, v146
    v_exp_f32 v147, v147
    v_cvt_pk_bf16_f32 v84, v144, v145
    v_mfma_f32_32x32x16_bf16 v[152:167], v[52:55], v[76:79], v[152:167]
    v_exp_f32 v148, v148
    v_exp_f32 v149, v149
    v_cvt_pk_bf16_f32 v85, v146, v147
    v_exp_f32 v150, v150
    v_exp_f32 v151, v151
    v_cvt_pk_bf16_f32 v86, v148, v149
    v_cvt_pk_bf16_f32 v87, v150, v151
    v_mfma_f32_32x32x16_bf16 v[136:151], v[32:35], v[20:23], 0
    v_exp_f32 v120, v120
    v_exp_f32 v121, v121
    v_exp_f32 v122, v122
    v_exp_f32 v123, v123
    v_cvt_pk_bf16_f32 v72, v120, v121
    v_mfma_f32_32x32x8_bf16 v[136:151], v[42:43], v[26:27], v[136:151]
    v_exp_f32 v124, v124
    v_exp_f32 v125, v125
    v_cvt_pk_bf16_f32 v73, v122, v123
    v_exp_f32 v126, v126
    v_exp_f32 v127, v127
    v_cvt_pk_bf16_f32 v74, v124, v125
    v_mfma_f32_32x32x16_bf16 v[168:183], v[48:51], v[80:83], v[168:183]
    v_exp_f32 v128, v128
    v_exp_f32 v129, v129
    v_cvt_pk_bf16_f32 v75, v126, v127
    v_exp_f32 v130, v130
    v_exp_f32 v131, v131
    v_cvt_pk_bf16_f32 v76, v128, v129
    v_mfma_f32_32x32x16_bf16 v[168:183], v[52:55], v[84:87], v[168:183]
    v_exp_f32 v132, v132
    v_exp_f32 v133, v133
    v_cvt_pk_bf16_f32 v77, v130, v131
    v_exp_f32 v134, v134
    v_exp_f32 v135, v135
    v_cvt_pk_bf16_f32 v78, v132, v133
    v_cvt_pk_bf16_f32 v79, v134, v135
    ds_read_b128 v[32:35], v10 offset:17408
    ds_read_b32 v42, v11 offset:2176
    s_mov_b64 exec, s[30:31]
    ds_read_b128 v[48:51], v5 offset:18432
    ds_read_b128 v[52:55], v5 offset:19008
    s_mov_b64 exec, -1
    s_waitcnt lgkmcnt(6)
    v_mfma_f32_32x32x16_bf16 v[120:135], v[28:31], v[16:19], 0
    v_exp_f32 v136, v136
    v_exp_f32 v137, v137
    v_exp_f32 v138, v138
    v_exp_f32 v139, v139
    v_cvt_pk_bf16_f32 v80, v136, v137
    v_mfma_f32_32x32x8_bf16 v[120:135], v[40:41], v[24:25], v[120:135]
    v_exp_f32 v140, v140
    v_exp_f32 v141, v141
    v_cvt_pk_bf16_f32 v81, v138, v139
    v_exp_f32 v142, v142
    v_exp_f32 v143, v143
    v_cvt_pk_bf16_f32 v82, v140, v141
    s_waitcnt lgkmcnt(4)
    v_mfma_f32_32x32x16_bf16 v[152:167], v[56:59], v[72:75], v[152:167]
    v_exp_f32 v144, v144
    v_exp_f32 v145, v145
    v_cvt_pk_bf16_f32 v83, v142, v143
    v_exp_f32 v146, v146
    v_exp_f32 v147, v147
    v_cvt_pk_bf16_f32 v84, v144, v145
    v_mfma_f32_32x32x16_bf16 v[152:167], v[60:63], v[76:79], v[152:167]
    v_exp_f32 v148, v148
    v_exp_f32 v149, v149
    v_cvt_pk_bf16_f32 v85, v146, v147
    v_exp_f32 v150, v150
    v_exp_f32 v151, v151
    v_cvt_pk_bf16_f32 v86, v148, v149
    v_cvt_pk_bf16_f32 v87, v150, v151
    v_mfma_f32_32x32x16_bf16 v[136:151], v[28:31], v[20:23], 0
    v_exp_f32 v120, v120
    v_exp_f32 v121, v121
    v_exp_f32 v122, v122
    v_exp_f32 v123, v123
    v_cvt_pk_bf16_f32 v72, v120, v121
    v_mfma_f32_32x32x8_bf16 v[136:151], v[40:41], v[26:27], v[136:151]
    v_exp_f32 v124, v124
    v_exp_f32 v125, v125
    v_cvt_pk_bf16_f32 v73, v122, v123
    v_exp_f32 v126, v126
    v_exp_f32 v127, v127
    v_cvt_pk_bf16_f32 v74, v124, v125
    v_mfma_f32_32x32x16_bf16 v[168:183], v[56:59], v[80:83], v[168:183]
    v_exp_f32 v128, v128
    v_exp_f32 v129, v129
    v_cvt_pk_bf16_f32 v75, v126, v127
    v_exp_f32 v130, v130
    v_exp_f32 v131, v131
    v_cvt_pk_bf16_f32 v76, v128, v129
    v_mfma_f32_32x32x16_bf16 v[168:183], v[60:63], v[84:87], v[168:183]
    v_exp_f32 v132, v132
    v_exp_f32 v133, v133
    v_cvt_pk_bf16_f32 v77, v130, v131
    v_exp_f32 v134, v134
    v_exp_f32 v135, v135
    v_cvt_pk_bf16_f32 v78, v132, v133
    v_cvt_pk_bf16_f32 v79, v134, v135
    ds_read_b128 v[28:31], v10 offset:18432
    ds_read_b32 v40, v11 offset:2304
    s_mov_b64 exec, s[30:31]
    ds_read_b128 v[56:59], v5 offset:19584
    ds_read_b128 v[60:63], v5 offset:20160
    s_mov_b64 exec, -1
    s_waitcnt lgkmcnt(6)
    v_mfma_f32_32x32x16_bf16 v[120:135], v[32:35], v[16:19], 0
    v_exp_f32 v136, v136
    v_exp_f32 v137, v137
    v_exp_f32 v138, v138
    v_exp_f32 v139, v139
    v_cvt_pk_bf16_f32 v80, v136, v137
    v_mfma_f32_32x32x8_bf16 v[120:135], v[42:43], v[24:25], v[120:135]
    v_exp_f32 v140, v140
    v_exp_f32 v141, v141
    v_cvt_pk_bf16_f32 v81, v138, v139
    v_exp_f32 v142, v142
    v_exp_f32 v143, v143
    v_cvt_pk_bf16_f32 v82, v140, v141
    s_waitcnt lgkmcnt(4)
    v_mfma_f32_32x32x16_bf16 v[152:167], v[48:51], v[72:75], v[152:167]
    v_exp_f32 v144, v144
    v_exp_f32 v145, v145
    v_cvt_pk_bf16_f32 v83, v142, v143
    v_exp_f32 v146, v146
    v_exp_f32 v147, v147
    v_cvt_pk_bf16_f32 v84, v144, v145
    v_mfma_f32_32x32x16_bf16 v[152:167], v[52:55], v[76:79], v[152:167]
    v_exp_f32 v148, v148
    v_exp_f32 v149, v149
    v_cvt_pk_bf16_f32 v85, v146, v147
    v_exp_f32 v150, v150
    v_exp_f32 v151, v151
    v_cvt_pk_bf16_f32 v86, v148, v149
    v_cvt_pk_bf16_f32 v87, v150, v151
    v_mfma_f32_32x32x16_bf16 v[136:151], v[32:35], v[20:23], 0
    v_exp_f32 v120, v120
    v_exp_f32 v121, v121
    v_exp_f32 v122, v122
    v_exp_f32 v123, v123
    v_cvt_pk_bf16_f32 v72, v120, v121
    v_mfma_f32_32x32x8_bf16 v[136:151], v[42:43], v[26:27], v[136:151]
    v_exp_f32 v124, v124
    v_exp_f32 v125, v125
    v_cvt_pk_bf16_f32 v73, v122, v123
    v_exp_f32 v126, v126
    v_exp_f32 v127, v127
    v_cvt_pk_bf16_f32 v74, v124, v125
    v_mfma_f32_32x32x16_bf16 v[168:183], v[48:51], v[80:83], v[168:183]
    v_exp_f32 v128, v128
    v_exp_f32 v129, v129
    v_cvt_pk_bf16_f32 v75, v126, v127
    v_exp_f32 v130, v130
    v_exp_f32 v131, v131
    v_cvt_pk_bf16_f32 v76, v128, v129
    v_mfma_f32_32x32x16_bf16 v[168:183], v[52:55], v[84:87], v[168:183]
    v_exp_f32 v132, v132
    v_exp_f32 v133, v133
    v_cvt_pk_bf16_f32 v77, v130, v131
    v_exp_f32 v134, v134
    v_exp_f32 v135, v135
    v_cvt_pk_bf16_f32 v78, v132, v133
    v_cvt_pk_bf16_f32 v79, v134, v135
    ds_read_b128 v[32:35], v10 offset:19456
    ds_read_b32 v42, v11 offset:2432
    s_mov_b64 exec, s[30:31]
    ds_read_b128 v[48:51], v5 offset:20736
    ds_read_b128 v[52:55], v5 offset:21312
    s_mov_b64 exec, -1
    s_waitcnt lgkmcnt(6)
    v_mfma_f32_32x32x16_bf16 v[120:135], v[28:31], v[16:19], 0
    v_exp_f32 v136, v136
    v_exp_f32 v137, v137
    v_exp_f32 v138, v138
    v_exp_f32 v139, v139
    v_cvt_pk_bf16_f32 v80, v136, v137
    v_mfma_f32_32x32x8_bf16 v[120:135], v[40:41], v[24:25], v[120:135]
    v_exp_f32 v140, v140
    v_exp_f32 v141, v141
    v_cvt_pk_bf16_f32 v81, v138, v139
    v_exp_f32 v142, v142
    v_exp_f32 v143, v143
    v_cvt_pk_bf16_f32 v82, v140, v141
    s_waitcnt lgkmcnt(4)
    v_mfma_f32_32x32x16_bf16 v[152:167], v[56:59], v[72:75], v[152:167]
    v_exp_f32 v144, v144
    v_exp_f32 v145, v145
    v_cvt_pk_bf16_f32 v83, v142, v143
    v_exp_f32 v146, v146
    v_exp_f32 v147, v147
    v_cvt_pk_bf16_f32 v84, v144, v145
    v_mfma_f32_32x32x16_bf16 v[152:167], v[60:63], v[76:79], v[152:167]
    v_exp_f32 v148, v148
    v_exp_f32 v149, v149
    v_cvt_pk_bf16_f32 v85, v146, v147
    v_exp_f32 v150, v150
    v_exp_f32 v151, v151
    v_cvt_pk_bf16_f32 v86, v148, v149
    v_cvt_pk_bf16_f32 v87, v150, v151
    v_mfma_f32_32x32x16_bf16 v[136:151], v[28:31], v[20:23], 0
    v_exp_f32 v120, v120
    v_exp_f32 v121, v121
    v_exp_f32 v122, v122
    v_exp_f32 v123, v123
    v_cvt_pk_bf16_f32 v72, v120, v121
    v_mfma_f32_32x32x8_bf16 v[136:151], v[40:41], v[26:27], v[136:151]
    v_exp_f32 v124, v124
    v_exp_f32 v125, v125
    v_cvt_pk_bf16_f32 v73, v122, v123
    v_exp_f32 v126, v126
    v_exp_f32 v127, v127
    v_cvt_pk_bf16_f32 v74, v124, v125
    v_mfma_f32_32x32x16_bf16 v[168:183], v[56:59], v[80:83], v[168:183]
    v_exp_f32 v128, v128
    v_exp_f32 v129, v129
    v_cvt_pk_bf16_f32 v75, v126, v127
    v_exp_f32 v130, v130
    v_exp_f32 v131, v131
    v_cvt_pk_bf16_f32 v76, v128, v129
    v_mfma_f32_32x32x16_bf16 v[168:183], v[60:63], v[84:87], v[168:183]
    v_exp_f32 v132, v132
    v_exp_f32 v133, v133
    v_cvt_pk_bf16_f32 v77, v130, v131
    v_exp_f32 v134, v134
    v_exp_f32 v135, v135
    v_cvt_pk_bf16_f32 v78, v132, v133
    v_cvt_pk_bf16_f32 v79, v134, v135
    ds_read_b128 v[28:31], v10 offset:20480
    ds_read_b32 v40, v11 offset:2560
    s_mov_b64 exec, s[30:31]
    ds_read_b128 v[56:59], v5 offset:21888
    ds_read_b128 v[60:63], v5 offset:22464
    s_mov_b64 exec, -1
    s_waitcnt lgkmcnt(6)
    v_mfma_f32_32x32x16_bf16 v[120:135], v[32:35], v[16:19], 0
    v_exp_f32 v136, v136
    v_exp_f32 v137, v137
    v_exp_f32 v138, v138
    v_exp_f32 v139, v139
    v_cvt_pk_bf16_f32 v80, v136, v137
    v_mfma_f32_32x32x8_bf16 v[120:135], v[42:43], v[24:25], v[120:135]
    v_exp_f32 v140, v140
    v_exp_f32 v141, v141
    v_cvt_pk_bf16_f32 v81, v138, v139
    v_exp_f32 v142, v142
    v_exp_f32 v143, v143
    v_cvt_pk_bf16_f32 v82, v140, v141
    s_waitcnt lgkmcnt(4)
    v_mfma_f32_32x32x16_bf16 v[152:167], v[48:51], v[72:75], v[152:167]
    v_exp_f32 v144, v144
    v_exp_f32 v145, v145
    v_cvt_pk_bf16_f32 v83, v142, v143
    v_exp_f32 v146, v146
    v_exp_f32 v147, v147
    v_cvt_pk_bf16_f32 v84, v144, v145
    v_mfma_f32_32x32x16_bf16 v[152:167], v[52:55], v[76:79], v[152:167]
    v_exp_f32 v148, v148
    v_exp_f32 v149, v149
    v_cvt_pk_bf16_f32 v85, v146, v147
    v_exp_f32 v150, v150
    v_exp_f32 v151, v151
    v_cvt_pk_bf16_f32 v86, v148, v149
    v_cvt_pk_bf16_f32 v87, v150, v151
    v_mfma_f32_32x32x16_bf16 v[136:151], v[32:35], v[20:23], 0
    v_exp_f32 v120, v120
    v_exp_f32 v121, v121
    v_exp_f32 v122, v122
    v_exp_f32 v123, v123
    v_cvt_pk_bf16_f32 v72, v120, v121
    v_mfma_f32_32x32x8_bf16 v[136:151], v[42:43], v[26:27], v[136:151]
    v_exp_f32 v124, v124
    v_exp_f32 v125, v125
    v_cvt_pk_bf16_f32 v73, v122, v123
    v_exp_f32 v126, v126
    v_exp_f32 v127, v127
    v_cvt_pk_bf16_f32 v74, v124, v125
    v_mfma_f32_32x32x16_bf16 v[168:183], v[48:51], v[80:83], v[168:183]
    v_exp_f32 v128, v128
    v_exp_f32 v129, v129
    v_cvt_pk_bf16_f32 v75, v126, v127
    v_exp_f32 v130, v130
    v_exp_f32 v131, v131
    v_cvt_pk_bf16_f32 v76, v128, v129
    v_mfma_f32_32x32x16_bf16 v[168:183], v[52:55], v[84:87], v[168:183]
    v_exp_f32 v132, v132
    v_exp_f32 v133, v133
    v_cvt_pk_bf16_f32 v77, v130, v131
    v_exp_f32 v134, v134
    v_exp_f32 v135, v135
    v_cvt_pk_bf16_f32 v78, v132, v133
    v_cvt_pk_bf16_f32 v79, v134, v135
    ds_read_b128 v[32:35], v10 offset:21504
    ds_read_b32 v42, v11 offset:2688
    s_mov_b64 exec, s[30:31]
    ds_read_b128 v[48:51], v5 offset:23040
    ds_read_b128 v[52:55], v5 offset:23616
    s_mov_b64 exec, -1
    s_waitcnt lgkmcnt(6)
    v_mfma_f32_32x32x16_bf16 v[120:135], v[28:31], v[16:19], 0
    v_exp_f32 v136, v136
    v_exp_f32 v137, v137
    v_exp_f32 v138, v138
    v_exp_f32 v139, v139
    v_cvt_pk_bf16_f32 v80, v136, v137
    v_mfma_f32_32x32x8_bf16 v[120:135], v[40:41], v[24:25], v[120:135]
    v_exp_f32 v140, v140
    v_exp_f32 v141, v141
    v_cvt_pk_bf16_f32 v81, v138, v139
    v_exp_f32 v142, v142
    v_exp_f32 v143, v143
    v_cvt_pk_bf16_f32 v82, v140, v141
    s_waitcnt lgkmcnt(4)
    v_mfma_f32_32x32x16_bf16 v[152:167], v[56:59], v[72:75], v[152:167]
    v_exp_f32 v144, v144
    v_exp_f32 v145, v145
    v_cvt_pk_bf16_f32 v83, v142, v143
    v_exp_f32 v146, v146
    v_exp_f32 v147, v147
    v_cvt_pk_bf16_f32 v84, v144, v145
    v_mfma_f32_32x32x16_bf16 v[152:167], v[60:63], v[76:79], v[152:167]
    v_exp_f32 v148, v148
    v_exp_f32 v149, v149
    v_cvt_pk_bf16_f32 v85, v146, v147
    v_exp_f32 v150, v150
    v_exp_f32 v151, v151
    v_cvt_pk_bf16_f32 v86, v148, v149
    v_cvt_pk_bf16_f32 v87, v150, v151
    s_cmp_lg_u32 s79, 0
    s_cbranch_scc1 Lm54_np
    s_waitcnt vmcnt(0)
    v_perm_b32 v224, v196, v192, s77
    v_perm_b32 v225, v204, v200, s77
    v_perm_b32 v226, v212, v208, s77
    v_perm_b32 v227, v220, v216, s77
    buffer_store_dwordx4 v[224:227], v185, s[8:11], s60 offen sc1
    s_nop 0
    v_mfma_f32_16x16x32_bf16 v[236:239], v[232:235], v[224:227], 0
Lm54_np:
    v_mfma_f32_32x32x16_bf16 v[136:151], v[28:31], v[20:23], 0
    v_exp_f32 v120, v120
    v_exp_f32 v121, v121
    v_exp_f32 v122, v122
    v_exp_f32 v123, v123
    v_cvt_pk_bf16_f32 v72, v120, v121
    v_mfma_f32_32x32x8_bf16 v[136:151], v[40:41], v[26:27], v[136:151]
    v_exp_f32 v124, v124
    v_exp_f32 v125, v125
    v_cvt_pk_bf16_f32 v73, v122, v123
    v_exp_f32 v126, v126
    v_exp_f32 v127, v127
    v_cvt_pk_bf16_f32 v74, v124, v125
    v_mfma_f32_32x32x16_bf16 v[168:183], v[56:59], v[80:83], v[168:183]
    v_exp_f32 v128, v128
    v_exp_f32 v129, v129
    v_cvt_pk_bf16_f32 v75, v126, v127
    v_exp_f32 v130, v130
    v_exp_f32 v131, v131
    v_cvt_pk_bf16_f32 v76, v128, v129
    v_mfma_f32_32x32x16_bf16 v[168:183], v[60:63], v[84:87], v[168:183]
    v_exp_f32 v132, v132
    v_exp_f32 v133, v133
    v_cvt_pk_bf16_f32 v77, v130, v131
    v_exp_f32 v134, v134
    v_exp_f32 v135, v135
    v_cvt_pk_bf16_f32 v78, v132, v133
    v_cvt_pk_bf16_f32 v79, v134, v135
    ds_read_b128 v[28:31], v10 offset:22528
    ds_read_b32 v40, v11 offset:2816
    s_mov_b64 exec, s[30:31]
    ds_read_b128 v[56:59], v5 offset:24192
    ds_read_b128 v[60:63], v5 offset:24768
    s_mov_b64 exec, -1
    s_cmp_lg_u32 s79, 0
    s_cbranch_scc1 Lm55_np
    v_perm_b32 v228, v196, v192, s78
    v_perm_b32 v229, v204, v200, s78
    v_perm_b32 v230, v212, v208, s78
    v_perm_b32 v231, v220, v216, s78
    buffer_store_dwordx4 v[228:231], v185, s[8:11], s61 offen sc1
    buffer_store_dword v236, v187, s[8:11], 0 offen offset:0 sc1
    v_mfma_f32_16x16x32_bf16 v[240:243], v[232:235], v[228:231], 0
Lm55_np:
    s_waitcnt lgkmcnt(6)
    v_mfma_f32_32x32x16_bf16 v[120:135], v[32:35], v[16:19], 0
    v_exp_f32 v136, v136
    v_exp_f32 v137, v137
    v_exp_f32 v138, v138
    v_exp_f32 v139, v139
    v_cvt_pk_bf16_f32 v80, v136, v137
    v_mfma_f32_32x32x8_bf16 v[120:135], v[42:43], v[24:25], v[120:135]
    v_exp_f32 v140, v140
    v_exp_f32 v141, v141
    v_cvt_pk_bf16_f32 v81, v138, v139
    v_exp_f32 v142, v142
    v_exp_f32 v143, v143
    v_cvt_pk_bf16_f32 v82, v140, v141
    s_waitcnt lgkmcnt(4)
    v_mfma_f32_32x32x16_bf16 v[152:167], v[48:51], v[72:75], v[152:167]
    v_exp_f32 v144, v144
    v_exp_f32 v145, v145
    v_cvt_pk_bf16_f32 v83, v142, v143
    v_exp_f32 v146, v146
    v_exp_f32 v147, v147
    v_cvt_pk_bf16_f32 v84, v144, v145
    v_mfma_f32_32x32x16_bf16 v[152:167], v[52:55], v[76:79], v[152:167]
    v_exp_f32 v148, v148
    v_exp_f32 v149, v149
    v_cvt_pk_bf16_f32 v85, v146, v147
    v_exp_f32 v150, v150
    v_exp_f32 v151, v151
    v_cvt_pk_bf16_f32 v86, v148, v149
    v_cvt_pk_bf16_f32 v87, v150, v151
    s_cmp_lg_u32 s79, 0
    s_cbranch_scc1 Lm56_np
    v_perm_b32 v224, v197, v193, s77
    v_perm_b32 v225, v205, v201, s77
    v_perm_b32 v226, v213, v209, s77
    v_perm_b32 v227, v221, v217, s77
    buffer_store_dwordx4 v[224:227], v185, s[8:11], s62 offen sc1
    buffer_store_dword v240, v187, s[8:11], 0 offen offset:128 sc1
    v_mfma_f32_16x16x32_bf16 v[236:239], v[232:235], v[224:227], 0
Lm56_np:
    v_mfma_f32_32x32x16_bf16 v[136:151], v[32:35], v[20:23], 0
    v_exp_f32 v120, v120
    v_exp_f32 v121, v121
    v_exp_f32 v122, v122
    v_exp_f32 v123, v123
    v_cvt_pk_bf16_f32 v72, v120, v121
    v_mfma_f32_32x32x8_bf16 v[136:151], v[42:43], v[26:27], v[136:151]
    v_exp_f32 v124, v124
    v_exp_f32 v125, v125
    v_cvt_pk_bf16_f32 v73, v122, v123
    v_exp_f32 v126, v126
    v_exp_f32 v127, v127
    v_cvt_pk_bf16_f32 v74, v124, v125
    v_mfma_f32_32x32x16_bf16 v[168:183], v[48:51], v[80:83], v[168:183]
    v_exp_f32 v128, v128
    v_exp_f32 v129, v129
    v_cvt_pk_bf16_f32 v75, v126, v127
    v_exp_f32 v130, v130
    v_exp_f32 v131, v131
    v_cvt_pk_bf16_f32 v76, v128, v129
    v_mfma_f32_32x32x16_bf16 v[168:183], v[52:55], v[84:87], v[168:183]
    v_exp_f32 v132, v132
    v_exp_f32 v133, v133
    v_cvt_pk_bf16_f32 v77, v130, v131
    v_exp_f32 v134, v134
    v_exp_f32 v135, v135
    v_cvt_pk_bf16_f32 v78, v132, v133
    v_cvt_pk_bf16_f32 v79, v134, v135
    ds_read_b128 v[32:35], v10 offset:23552
    ds_read_b32 v42, v11 offset:2944
    s_mov_b64 exec, s[30:31]
    ds_read_b128 v[48:51], v5 offset:25344
    ds_read_b128 v[52:55], v5 offset:25920
    s_mov_b64 exec, -1
    s_cmp_lg_u32 s79, 0
    s_cbranch_scc1 Lm57_np
    v_perm_b32 v228, v197, v193, s78
    v_perm_b32 v229, v205, v201, s78
    v_perm_b32 v230, v213, v209, s78
    v_perm_b32 v231, v221, v217, s78
    buffer_store_dwordx4 v[228:231], v185, s[8:11], s63 offen sc1
    buffer_store_dword v236, v187, s[8:11], 0 offen offset:256 sc1
    v_mfma_f32_16x16x32_bf16 v[240:243], v[232:235], v[228:231], 0
Lm57_np:
    s_waitcnt lgkmcnt(6)
    v_mfma_f32_32x32x16_bf16 v[120:135], v[28:31], v[16:19], 0
    v_exp_f32 v136, v136
    v_exp_f32 v137, v137
    v_exp_f32 v138, v138
    v_exp_f32 v139, v139
    v_cvt_pk_bf16_f32 v80, v136, v137
    v_mfma_f32_32x32x8_bf16 v[120:135], v[40:41], v[24:25], v[120:135]
    v_exp_f32 v140, v140
    v_exp_f32 v141, v141
    v_cvt_pk_bf16_f32 v81, v138, v139
    v_exp_f32 v142, v142
    v_exp_f32 v143, v143
    v_cvt_pk_bf16_f32 v82, v140, v141
    s_waitcnt lgkmcnt(4)
    v_mfma_f32_32x32x16_bf16 v[152:167], v[56:59], v[72:75], v[152:167]
    v_exp_f32 v144, v144
    v_exp_f32 v145, v145
    v_cvt_pk_bf16_f32 v83, v142, v143
    v_exp_f32 v146, v146
    v_exp_f32 v147, v147
    v_cvt_pk_bf16_f32 v84, v144, v145
    v_mfma_f32_32x32x16_bf16 v[152:167], v[60:63], v[76:79], v[152:167]
    v_exp_f32 v148, v148
    v_exp_f32 v149, v149
    v_cvt_pk_bf16_f32 v85, v146, v147
    v_exp_f32 v150, v150
    v_exp_f32 v151, v151
    v_cvt_pk_bf16_f32 v86, v148, v149
    v_cvt_pk_bf16_f32 v87, v150, v151
    s_cmp_lg_u32 s79, 0
    s_cbranch_scc1 Lm58_np
    v_perm_b32 v224, v198, v194, s77
    v_perm_b32 v225, v206, v202, s77
    v_perm_b32 v226, v214, v210, s77
    v_perm_b32 v227, v222, v218, s77
    buffer_store_dwordx4 v[224:227], v186, s[8:11], s60 offen sc1
    buffer_store_dword v240, v187, s[8:11], 0 offen offset:384 sc1
    v_mfma_f32_16x16x32_bf16 v[236:239], v[232:235], v[224:227], 0
Lm58_np:
    v_mfma_f32_32x32x16_bf16 v[136:151], v[28:31], v[20:23], 0
    v_exp_f32 v120, v120
    v_exp_f32 v121, v121
    v_exp_f32 v122, v122
    v_exp_f32 v123, v123
    v_cvt_pk_bf16_f32 v72, v120, v121
    v_mfma_f32_32x32x8_bf16 v[136:151], v[40:41], v[26:27], v[136:151]
    v_exp_f32 v124, v124
    v_exp_f32 v125, v125
    v_cvt_pk_bf16_f32 v73, v122, v123
    v_exp_f32 v126, v126
    v_exp_f32 v127, v127
    v_cvt_pk_bf16_f32 v74, v124, v125
    v_mfma_f32_32x32x16_bf16 v[168:183], v[56:59], v[80:83], v[168:183]
    v_exp_f32 v128, v128
    v_exp_f32 v129, v129
    v_cvt_pk_bf16_f32 v75, v126, v127
    v_exp_f32 v130, v130
    v_exp_f32 v131, v131
    v_cvt_pk_bf16_f32 v76, v128, v129
    v_mfma_f32_32x32x16_bf16 v[168:183], v[60:63], v[84:87], v[168:183]
    v_exp_f32 v132, v132
    v_exp_f32 v133, v133
    v_cvt_pk_bf16_f32 v77, v130, v131
    v_exp_f32 v134, v134
    v_exp_f32 v135, v135
    v_cvt_pk_bf16_f32 v78, v132, v133
    v_cvt_pk_bf16_f32 v79, v134, v135
    ds_read_b128 v[28:31], v10 offset:24576
    ds_read_b32 v40, v11 offset:3072
    s_mov_b64 exec, s[30:31]
    ds_read_b128 v[56:59], v5 offset:26496
    ds_read_b128 v[60:63], v5 offset:27072
    s_mov_b64 exec, -1
    s_cmp_lg_u32 s79, 0
    s_cbranch_scc1 Lm59_np
    v_perm_b32 v228, v198, v194, s78
    v_perm_b32 v229, v206, v202, s78
    v_perm_b32 v230, v214, v210, s78
    v_perm_b32 v231, v222, v218, s78
    buffer_store_dwordx4 v[228:231], v186, s[8:11], s61 offen sc1
    buffer_store_dword v236, v187, s[8:11], 0 offen offset:512 sc1
    v_mfma_f32_16x16x32_bf16 v[240:243], v[232:235], v[228:231], 0
Lm59_np:
    s_waitcnt lgkmcnt(6)
    v_mfma_f32_32x32x16_bf16 v[120:135], v[32:35], v[16:19], 0
    v_exp_f32 v136, v136
    v_exp_f32 v137, v137
    v_exp_f32 v138, v138
    v_exp_f32 v139, v139
    v_cvt_pk_bf16_f32 v80, v136, v137
    v_mfma_f32_32x32x8_bf16 v[120:135], v[42:43], v[24:25], v[120:135]
    v_exp_f32 v140, v140
    v_exp_f32 v141, v141
    v_cvt_pk_bf16_f32 v81, v138, v139
    v_exp_f32 v142, v142
    v_exp_f32 v143, v143
    v_cvt_pk_bf16_f32 v82, v140, v141
    s_waitcnt lgkmcnt(4)
    v_mfma_f32_32x32x16_bf16 v[152:167], v[48:51], v[72:75], v[152:167]
    v_exp_f32 v144, v144
    v_exp_f32 v145, v145
    v_cvt_pk_bf16_f32 v83, v142, v143
    v_exp_f32 v146, v146
    v_exp_f32 v147, v147
    v_cvt_pk_bf16_f32 v84, v144, v145
    v_mfma_f32_32x32x16_bf16 v[152:167], v[52:55], v[76:79], v[152:167]
    v_exp_f32 v148, v148
    v_exp_f32 v149, v149
    v_cvt_pk_bf16_f32 v85, v146, v147
    v_exp_f32 v150, v150
    v_exp_f32 v151, v151
    v_cvt_pk_bf16_f32 v86, v148, v149
    v_cvt_pk_bf16_f32 v87, v150, v151
    s_cmp_lg_u32 s79, 0
    s_cbranch_scc1 Lm60_np
    v_perm_b32 v224, v199, v195, s77
    v_perm_b32 v225, v207, v203, s77
    v_perm_b32 v226, v215, v211, s77
    v_perm_b32 v227, v223, v219, s77
    buffer_store_dwordx4 v[224:227], v186, s[8:11], s62 offen sc1
    buffer_store_dword v240, v187, s[8:11], 0 offen offset:640 sc1
    v_mfma_f32_16x16x32_bf16 v[236:239], v[232:235], v[224:227], 0
Lm60_np:
    v_mfma_f32_32x32x16_bf16 v[136:151], v[32:35], v[20:23], 0
    v_exp_f32 v120, v120
    v_exp_f32 v121, v121
    v_exp_f32 v122, v122
    v_exp_f32 v123, v123
    v_cvt_pk_bf16_f32 v72, v120, v121
    v_mfma_f32_32x32x8_bf16 v[136:151], v[42:43], v[26:27], v[136:151]
    v_exp_f32 v124, v124
    v_exp_f32 v125, v125
    v_cvt_pk_bf16_f32 v73, v122, v123
    v_exp_f32 v126, v126
    v_exp_f32 v127, v127
    v_cvt_pk_bf16_f32 v74, v124, v125
    v_mfma_f32_32x32x16_bf16 v[168:183], v[48:51], v[80:83], v[168:183]
    v_exp_f32 v128, v128
    v_exp_f32 v129, v129
    v_cvt_pk_bf16_f32 v75, v126, v127
    v_exp_f32 v130, v130
    v_exp_f32 v131, v131
    v_cvt_pk_bf16_f32 v76, v128, v129
    v_mfma_f32_32x32x16_bf16 v[168:183], v[52:55], v[84:87], v[168:183]
    v_exp_f32 v132, v132
    v_exp_f32 v133, v133
    v_cvt_pk_bf16_f32 v77, v130, v131
    v_exp_f32 v134, v134
    v_exp_f32 v135, v135
    v_cvt_pk_bf16_f32 v78, v132, v133
    v_cvt_pk_bf16_f32 v79, v134, v135
    ds_read_b128 v[32:35], v10 offset:25600
    ds_read_b32 v42, v11 offset:3200
    s_mov_b64 exec, s[30:31]
    ds_read_b128 v[48:51], v5 offset:27648
    ds_read_b128 v[52:55], v5 offset:28224
    s_mov_b64 exec, -1
    s_cmp_lg_u32 s79, 0
    s_cbranch_scc1 Lm61_np
    v_perm_b32 v228, v199, v195, s78
    v_perm_b32 v229, v207, v203, s78
    v_perm_b32 v230, v215, v211, s78
    v_perm_b32 v231, v223, v219, s78
    buffer_store_dwordx4 v[228:231], v186, s[8:11], s63 offen sc1
    buffer_store_dword v236, v187, s[8:11], 0 offen offset:768 sc1
    v_mfma_f32_16x16x32_bf16 v[240:243], v[232:235], v[228:231], 0
Lm61_np:
    s_waitcnt lgkmcnt(6)
    v_mfma_f32_32x32x16_bf16 v[120:135], v[28:31], v[16:19], 0
    v_exp_f32 v136, v136
    v_exp_f32 v137, v137
    v_exp_f32 v138, v138
    v_exp_f32 v139, v139
    v_cvt_pk_bf16_f32 v80, v136, v137
    v_mfma_f32_32x32x8_bf16 v[120:135], v[40:41], v[24:25], v[120:135]
    v_exp_f32 v140, v140
    v_exp_f32 v141, v141
    v_cvt_pk_bf16_f32 v81, v138, v139
    v_exp_f32 v142, v142
    v_exp_f32 v143, v143
    v_cvt_pk_bf16_f32 v82, v140, v141
    s_waitcnt lgkmcnt(4)
    v_mfma_f32_32x32x16_bf16 v[152:167], v[56:59], v[72:75], v[152:167]
    v_exp_f32 v144, v144
    v_exp_f32 v145, v145
    v_cvt_pk_bf16_f32 v83, v142, v143
    v_exp_f32 v146, v146
    v_exp_f32 v147, v147
    v_cvt_pk_bf16_f32 v84, v144, v145
    v_mfma_f32_32x32x16_bf16 v[152:167], v[60:63], v[76:79], v[152:167]
    v_exp_f32 v148, v148
    v_exp_f32 v149, v149
    v_cvt_pk_bf16_f32 v85, v146, v147
    v_exp_f32 v150, v150
    v_exp_f32 v151, v151
    v_cvt_pk_bf16_f32 v86, v148, v149
    v_cvt_pk_bf16_f32 v87, v150, v151
    s_cmp_lg_u32 s79, 0
    s_cbranch_scc1 Lm62_np
    buffer_store_dword v240, v187, s[8:11], 0 offen offset:896 sc1
Lm62_np:
    v_mfma_f32_32x32x16_bf16 v[136:151], v[28:31], v[20:23], 0
    v_exp_f32 v120, v120
    v_exp_f32 v121, v121
    v_exp_f32 v122, v122
    v_exp_f32 v123, v123
    v_cvt_pk_bf16_f32 v72, v120, v121
    v_mfma_f32_32x32x8_bf16 v[136:151], v[40:41], v[26:27], v[136:151]
    v_exp_f32 v124, v124
    v_exp_f32 v125, v125
    v_cvt_pk_bf16_f32 v73, v122, v123
    v_exp_f32 v126, v126
    v_exp_f32 v127, v127
    v_cvt_pk_bf16_f32 v74, v124, v125
    v_mfma_f32_32x32x16_bf16 v[168:183], v[56:59], v[80:83], v[168:183]
    v_exp_f32 v128, v128
    v_exp_f32 v129, v129
    v_cvt_pk_bf16_f32 v75, v126, v127
    v_exp_f32 v130, v130
    v_exp_f32 v131, v131
    v_cvt_pk_bf16_f32 v76, v128, v129
    v_mfma_f32_32x32x16_bf16 v[168:183], v[60:63], v[84:87], v[168:183]
    v_exp_f32 v132, v132
    v_exp_f32 v133, v133
    v_cvt_pk_bf16_f32 v77, v130, v131
    v_exp_f32 v134, v134
    v_exp_f32 v135, v135
    v_cvt_pk_bf16_f32 v78, v132, v133
    v_cvt_pk_bf16_f32 v79, v134, v135
    ds_read_b128 v[28:31], v10 offset:26624
    ds_read_b32 v40, v11 offset:3328
    s_mov_b64 exec, s[30:31]
    ds_read_b128 v[56:59], v5 offset:28800
    ds_read_b128 v[60:63], v5 offset:29376
    s_mov_b64 exec, -1
    s_waitcnt lgkmcnt(6)
    v_mfma_f32_32x32x16_bf16 v[120:135], v[32:35], v[16:19], 0
    v_exp_f32 v136, v136
    v_exp_f32 v137, v137
    v_exp_f32 v138, v138
    v_exp_f32 v139, v139
    v_cvt_pk_bf16_f32 v80, v136, v137
    v_mfma_f32_32x32x8_bf16 v[120:135], v[42:43], v[24:25], v[120:135]
    v_exp_f32 v140, v140
    v_exp_f32 v141, v141
    v_cvt_pk_bf16_f32 v81, v138, v139
    v_exp_f32 v142, v142
    v_exp_f32 v143, v143
    v_cvt_pk_bf16_f32 v82, v140, v141
    s_waitcnt lgkmcnt(4)
    v_mfma_f32_32x32x16_bf16 v[152:167], v[48:51], v[72:75], v[152:167]
    v_exp_f32 v144, v144
    v_exp_f32 v145, v145
    v_cvt_pk_bf16_f32 v83, v142, v143
    v_exp_f32 v146, v146
    v_exp_f32 v147, v147
    v_cvt_pk_bf16_f32 v84, v144, v145
    v_mfma_f32_32x32x16_bf16 v[152:167], v[52:55], v[76:79], v[152:167]
    v_exp_f32 v148, v148
    v_exp_f32 v149, v149
    v_cvt_pk_bf16_f32 v85, v146, v147
    v_exp_f32 v150, v150
    v_exp_f32 v151, v151
    v_cvt_pk_bf16_f32 v86, v148, v149
    v_cvt_pk_bf16_f32 v87, v150, v151
    v_mfma_f32_32x32x16_bf16 v[136:151], v[32:35], v[20:23], 0
    v_exp_f32 v120, v120
    v_exp_f32 v121, v121
    v_exp_f32 v122, v122
    v_exp_f32 v123, v123
    v_cvt_pk_bf16_f32 v72, v120, v121
    v_mfma_f32_32x32x8_bf16 v[136:151], v[42:43], v[26:27], v[136:151]
    v_exp_f32 v124, v124
    v_exp_f32 v125, v125
    v_cvt_pk_bf16_f32 v73, v122, v123
    v_exp_f32 v126, v126
    v_exp_f32 v127, v127
    v_cvt_pk_bf16_f32 v74, v124, v125
    v_mfma_f32_32x32x16_bf16 v[168:183], v[48:51], v[80:83], v[168:183]
    v_exp_f32 v128, v128
    v_exp_f32 v129, v129
    v_cvt_pk_bf16_f32 v75, v126, v127
    v_exp_f32 v130, v130
    v_exp_f32 v131, v131
    v_cvt_pk_bf16_f32 v76, v128, v129
    v_mfma_f32_32x32x16_bf16 v[168:183], v[52:55], v[84:87], v[168:183]
    v_exp_f32 v132, v132
    v_exp_f32 v133, v133
    v_cvt_pk_bf16_f32 v77, v130, v131
    v_exp_f32 v134, v134
    v_exp_f32 v135, v135
    v_cvt_pk_bf16_f32 v78, v132, v133
    v_cvt_pk_bf16_f32 v79, v134, v135
    ds_read_b128 v[32:35], v10 offset:27648
    ds_read_b32 v42, v11 offset:3456
    s_mov_b64 exec, s[30:31]
    ds_read_b128 v[48:51], v5 offset:29952
    ds_read_b128 v[52:55], v5 offset:30528
    s_mov_b64 exec, -1
    s_waitcnt lgkmcnt(6)
    v_mfma_f32_32x32x16_bf16 v[120:135], v[28:31], v[16:19], 0
    v_exp_f32 v136, v136
    v_exp_f32 v137, v137
    v_exp_f32 v138, v138
    v_exp_f32 v139, v139
    v_cvt_pk_bf16_f32 v80, v136, v137
    v_mfma_f32_32x32x8_bf16 v[120:135], v[40:41], v[24:25], v[120:135]
    v_exp_f32 v140, v140
    v_exp_f32 v141, v141
    v_cvt_pk_bf16_f32 v81, v138, v139
    v_exp_f32 v142, v142
    v_exp_f32 v143, v143
    v_cvt_pk_bf16_f32 v82, v140, v141
    s_waitcnt lgkmcnt(4)
    v_mfma_f32_32x32x16_bf16 v[152:167], v[56:59], v[72:75], v[152:167]
    v_exp_f32 v144, v144
    v_exp_f32 v145, v145
    v_cvt_pk_bf16_f32 v83, v142, v143
    v_exp_f32 v146, v146
    v_exp_f32 v147, v147
    v_cvt_pk_bf16_f32 v84, v144, v145
    v_mfma_f32_32x32x16_bf16 v[152:167], v[60:63], v[76:79], v[152:167]
    v_exp_f32 v148, v148
    v_exp_f32 v149, v149
    v_cvt_pk_bf16_f32 v85, v146, v147
    v_exp_f32 v150, v150
    v_exp_f32 v151, v151
    v_cvt_pk_bf16_f32 v86, v148, v149
    v_cvt_pk_bf16_f32 v87, v150, v151
    s_mov_b32 s43, s17
    buffer_load_dwordx4 v[184:187], v1, s[8:11], s43 offen offset:0 sc1
    buffer_load_dwordx4 v[188:191], v1, s[8:11], s43 offen offset:1024 sc1
    v_mfma_f32_32x32x16_bf16 v[136:151], v[28:31], v[20:23], 0
    v_exp_f32 v120, v120
    v_exp_f32 v121, v121
    v_exp_f32 v122, v122
    v_exp_f32 v123, v123
    v_cvt_pk_bf16_f32 v72, v120, v121
    v_mfma_f32_32x32x8_bf16 v[136:151], v[40:41], v[26:27], v[136:151]
    v_exp_f32 v124, v124
    v_exp_f32 v125, v125
    v_cvt_pk_bf16_f32 v73, v122, v123
    v_exp_f32 v126, v126
    v_exp_f32 v127, v127
    v_cvt_pk_bf16_f32 v74, v124, v125
    v_mfma_f32_32x32x16_bf16 v[168:183], v[56:59], v[80:83], v[168:183]
    v_exp_f32 v128, v128
    v_exp_f32 v129, v129
    v_cvt_pk_bf16_f32 v75, v126, v127
    v_exp_f32 v130, v130
    v_exp_f32 v131, v131
    v_cvt_pk_bf16_f32 v76, v128, v129
    v_mfma_f32_32x32x16_bf16 v[168:183], v[60:63], v[84:87], v[168:183]
    v_exp_f32 v132, v132
    v_exp_f32 v133, v133
    v_cvt_pk_bf16_f32 v77, v130, v131
    v_exp_f32 v134, v134
    v_exp_f32 v135, v135
    v_cvt_pk_bf16_f32 v78, v132, v133
    v_cvt_pk_bf16_f32 v79, v134, v135
    buffer_load_dwordx4 v[192:195], v1, s[8:11], s43 offen offset:2048 sc1
    buffer_load_dwordx4 v[196:199], v1, s[8:11], s43 offen offset:3072 sc1
    s_setprio 0
    ds_read_b128 v[28:31], v10 offset:28672
    ds_read_b32 v40, v11 offset:3584
    s_mov_b64 exec, s[30:31]
    ds_read_b128 v[56:59], v5 offset:31104
    ds_read_b128 v[60:63], v5 offset:31680
    s_mov_b64 exec, -1
    s_waitcnt lgkmcnt(6)
    v_mfma_f32_32x32x16_bf16 v[120:135], v[32:35], v[16:19], 0
    v_exp_f32 v136, v136
    v_exp_f32 v137, v137
    v_exp_f32 v138, v138
    v_exp_f32 v139, v139
    v_cvt_pk_bf16_f32 v80, v136, v137
    v_mfma_f32_32x32x8_bf16 v[120:135], v[42:43], v[24:25], v[120:135]
    v_exp_f32 v140, v140
    v_exp_f32 v141, v141
    v_cvt_pk_bf16_f32 v81, v138, v139
    v_exp_f32 v142, v142
    v_exp_f32 v143, v143
    v_cvt_pk_bf16_f32 v82, v140, v141
    s_waitcnt lgkmcnt(4)
    v_mfma_f32_32x32x16_bf16 v[152:167], v[48:51], v[72:75], v[152:167]
    v_exp_f32 v144, v144
    v_exp_f32 v145, v145
    v_cvt_pk_bf16_f32 v83, v142, v143
    v_exp_f32 v146, v146
    v_exp_f32 v147, v147
    v_cvt_pk_bf16_f32 v84, v144, v145
    v_mfma_f32_32x32x16_bf16 v[152:167], v[52:55], v[76:79], v[152:167]
    v_exp_f32 v148, v148
    v_exp_f32 v149, v149
    v_cvt_pk_bf16_f32 v85, v146, v147
    v_exp_f32 v150, v150
    v_exp_f32 v151, v151
    v_cvt_pk_bf16_f32 v86, v148, v149
    v_cvt_pk_bf16_f32 v87, v150, v151
    s_add_u32 s43, s43, 4096
    buffer_load_dwordx4 v[200:203], v1, s[8:11], s43 offen offset:0 sc1
    buffer_load_dwordx4 v[204:207], v1, s[8:11], s43 offen offset:1024 sc1
    v_mfma_f32_32x32x16_bf16 v[136:151], v[32:35], v[20:23], 0
    v_exp_f32 v120, v120
    v_exp_f32 v121, v121
    v_exp_f32 v122, v122
    v_exp_f32 v123, v123
    v_cvt_pk_bf16_f32 v72, v120, v121
    v_mfma_f32_32x32x8_bf16 v[136:151], v[42:43], v[26:27], v[136:151]
    v_exp_f32 v124, v124
    v_exp_f32 v125, v125
    v_cvt_pk_bf16_f32 v73, v122, v123
    v_exp_f32 v126, v126
    v_exp_f32 v127, v127
    v_cvt_pk_bf16_f32 v74, v124, v125
    v_mfma_f32_32x32x16_bf16 v[168:183], v[48:51], v[80:83], v[168:183]
    v_exp_f32 v128, v128
    v_exp_f32 v129, v129
    v_cvt_pk_bf16_f32 v75, v126, v127
    v_exp_f32 v130, v130
    v_exp_f32 v131, v131
    v_cvt_pk_bf16_f32 v76, v128, v129
    v_mfma_f32_32x32x16_bf16 v[168:183], v[52:55], v[84:87], v[168:183]
    v_exp_f32 v132, v132
    v_exp_f32 v133, v133
    v_cvt_pk_bf16_f32 v77, v130, v131
    v_exp_f32 v134, v134
    v_exp_f32 v135, v135
    v_cvt_pk_bf16_f32 v78, v132, v133
    v_cvt_pk_bf16_f32 v79, v134, v135
    buffer_load_dwordx4 v[208:211], v1, s[8:11], s43 offen offset:2048 sc1
    buffer_load_dwordx4 v[212:215], v1, s[8:11], s43 offen offset:3072 sc1
    ds_read_b128 v[32:35], v10 offset:29696
    ds_read_b32 v42, v11 offset:3712
    s_mov_b64 exec, s[30:31]
    ds_read_b128 v[48:51], v5 offset:32256
    ds_read_b128 v[52:55], v5 offset:32832
    s_mov_b64 exec, -1
    s_waitcnt lgkmcnt(6)
    v_mfma_f32_32x32x16_bf16 v[120:135], v[28:31], v[16:19], 0
    v_exp_f32 v136, v136
    v_exp_f32 v137, v137
    v_exp_f32 v138, v138
    v_exp_f32 v139, v139
    v_cvt_pk_bf16_f32 v80, v136, v137
    v_mfma_f32_32x32x8_bf16 v[120:135], v[40:41], v[24:25], v[120:135]
    v_exp_f32 v140, v140
    v_exp_f32 v141, v141
    v_cvt_pk_bf16_f32 v81, v138, v139
    v_exp_f32 v142, v142
    v_exp_f32 v143, v143
    v_cvt_pk_bf16_f32 v82, v140, v141
    s_waitcnt lgkmcnt(4)
    v_mfma_f32_32x32x16_bf16 v[152:167], v[56:59], v[72:75], v[152:167]
    v_exp_f32 v144, v144
    v_exp_f32 v145, v145
    v_cvt_pk_bf16_f32 v83, v142, v143
    v_exp_f32 v146, v146
    v_exp_f32 v147, v147
    v_cvt_pk_bf16_f32 v84, v144, v145
    v_mfma_f32_32x32x16_bf16 v[152:167], v[60:63], v[76:79], v[152:167]
    v_exp_f32 v148, v148
    v_exp_f32 v149, v149
    v_cvt_pk_bf16_f32 v85, v146, v147
    v_exp_f32 v150, v150
    v_exp_f32 v151, v151
    v_cvt_pk_bf16_f32 v86, v148, v149
    v_cvt_pk_bf16_f32 v87, v150, v151
    s_add_u32 s43, s43, 4096
    buffer_load_dwordx4 v[216:219], v1, s[8:11], s43 offen offset:0 sc1
    buffer_load_dwordx4 v[220:223], v1, s[8:11], s43 offen offset:1024 sc1
    v_mfma_f32_32x32x16_bf16 v[136:151], v[28:31], v[20:23], 0
    v_exp_f32 v120, v120
    v_exp_f32 v121, v121
    v_exp_f32 v122, v122
    v_exp_f32 v123, v123
    v_cvt_pk_bf16_f32 v72, v120, v121
    v_mfma_f32_32x32x8_bf16 v[136:151], v[40:41], v[26:27], v[136:151]
    v_exp_f32 v124, v124
    v_exp_f32 v125, v125
    v_cvt_pk_bf16_f32 v73, v122, v123
    v_exp_f32 v126, v126
    v_exp_f32 v127, v127
    v_cvt_pk_bf16_f32 v74, v124, v125
    v_mfma_f32_32x32x16_bf16 v[168:183], v[56:59], v[80:83], v[168:183]
    v_exp_f32 v128, v128
    v_exp_f32 v129, v129
    v_cvt_pk_bf16_f32 v75, v126, v127
    v_exp_f32 v130, v130
    v_exp_f32 v131, v131
    v_cvt_pk_bf16_f32 v76, v128, v129
    v_mfma_f32_32x32x16_bf16 v[168:183], v[60:63], v[84:87], v[168:183]
    v_exp_f32 v132, v132
    v_exp_f32 v133, v133
    v_cvt_pk_bf16_f32 v77, v130, v131
    v_exp_f32 v134, v134
    v_exp_f32 v135, v135
    v_cvt_pk_bf16_f32 v78, v132, v133
    v_cvt_pk_bf16_f32 v79, v134, v135
    buffer_load_dwordx4 v[224:227], v1, s[8:11], s43 offen offset:2048 sc1
    buffer_load_dwordx4 v[228:231], v1, s[8:11], s43 offen offset:3072 sc1
    ds_read_b128 v[28:31], v10 offset:30720
    ds_read_b32 v40, v11 offset:3840
    s_mov_b64 exec, s[30:31]
    ds_read_b128 v[56:59], v5 offset:33408
    ds_read_b128 v[60:63], v5 offset:33984
    s_mov_b64 exec, -1
    s_waitcnt lgkmcnt(6)
    v_mfma_f32_32x32x16_bf16 v[120:135], v[32:35], v[16:19], 0
    v_exp_f32 v136, v136
    v_exp_f32 v137, v137
    v_exp_f32 v138, v138
    v_exp_f32 v139, v139
    v_cvt_pk_bf16_f32 v80, v136, v137
    v_mfma_f32_32x32x8_bf16 v[120:135], v[42:43], v[24:25], v[120:135]
    v_exp_f32 v140, v140
    v_exp_f32 v141, v141
    v_cvt_pk_bf16_f32 v81, v138, v139
    v_exp_f32 v142, v142
    v_exp_f32 v143, v143
    v_cvt_pk_bf16_f32 v82, v140, v141
    s_waitcnt lgkmcnt(4)
    v_mfma_f32_32x32x16_bf16 v[152:167], v[48:51], v[72:75], v[152:167]
    v_exp_f32 v144, v144
    v_exp_f32 v145, v145
    v_cvt_pk_bf16_f32 v83, v142, v143
    v_exp_f32 v146, v146
    v_exp_f32 v147, v147
    v_cvt_pk_bf16_f32 v84, v144, v145
    v_mfma_f32_32x32x16_bf16 v[152:167], v[52:55], v[76:79], v[152:167]
    v_exp_f32 v148, v148
    v_exp_f32 v149, v149
    v_cvt_pk_bf16_f32 v85, v146, v147
    v_exp_f32 v150, v150
    v_exp_f32 v151, v151
    v_cvt_pk_bf16_f32 v86, v148, v149
    v_cvt_pk_bf16_f32 v87, v150, v151
    s_add_u32 s43, s43, 4096
    buffer_load_dwordx4 v[232:235], v1, s[8:11], s43 offen offset:0 sc1
    buffer_load_dwordx4 v[236:239], v1, s[8:11], s43 offen offset:1024 sc1
    v_mfma_f32_32x32x16_bf16 v[136:151], v[32:35], v[20:23], 0
    v_exp_f32 v120, v120
    v_exp_f32 v121, v121
    v_exp_f32 v122, v122
    v_exp_f32 v123, v123
    v_cvt_pk_bf16_f32 v72, v120, v121
    v_mfma_f32_32x32x8_bf16 v[136:151], v[42:43], v[26:27], v[136:151]
    v_exp_f32 v124, v124
    v_exp_f32 v125, v125
    v_cvt_pk_bf16_f32 v73, v122, v123
    v_exp_f32 v126, v126
    v_exp_f32 v127, v127
    v_cvt_pk_bf16_f32 v74, v124, v125
    v_mfma_f32_32x32x16_bf16 v[168:183], v[48:51], v[80:83], v[168:183]
    v_exp_f32 v128, v128
    v_exp_f32 v129, v129
    v_cvt_pk_bf16_f32 v75, v126, v127
    v_exp_f32 v130, v130
    v_exp_f32 v131, v131
    v_cvt_pk_bf16_f32 v76, v128, v129
    v_mfma_f32_32x32x16_bf16 v[168:183], v[52:55], v[84:87], v[168:183]
    v_exp_f32 v132, v132
    v_exp_f32 v133, v133
    v_cvt_pk_bf16_f32 v77, v130, v131
    v_exp_f32 v134, v134
    v_exp_f32 v135, v135
    v_cvt_pk_bf16_f32 v78, v132, v133
    v_cvt_pk_bf16_f32 v79, v134, v135
    buffer_load_dwordx4 v[240:243], v1, s[8:11], s43 offen offset:2048 sc1
    buffer_load_dwordx4 v[244:247], v1, s[8:11], s43 offen offset:3072 sc1
    ds_read_b128 v[32:35], v10 offset:31744
    ds_read_b32 v42, v11 offset:3968
    s_mov_b64 exec, s[30:31]
    ds_read_b128 v[48:51], v5 offset:34560
    ds_read_b128 v[52:55], v5 offset:35136
    s_mov_b64 exec, -1
    s_waitcnt lgkmcnt(6)
    v_mfma_f32_32x32x16_bf16 v[120:135], v[28:31], v[16:19], 0
    v_exp_f32 v136, v136
    v_exp_f32 v137, v137
    v_exp_f32 v138, v138
    v_exp_f32 v139, v139
    v_cvt_pk_bf16_f32 v80, v136, v137
    v_mfma_f32_32x32x8_bf16 v[120:135], v[40:41], v[24:25], v[120:135]
    v_exp_f32 v140, v140
    v_exp_f32 v141, v141
    v_cvt_pk_bf16_f32 v81, v138, v139
    v_exp_f32 v142, v142
    v_exp_f32 v143, v143
    v_cvt_pk_bf16_f32 v82, v140, v141
    s_waitcnt lgkmcnt(4)
    v_mfma_f32_32x32x16_bf16 v[152:167], v[56:59], v[72:75], v[152:167]
    v_exp_f32 v144, v144
    v_exp_f32 v145, v145
    v_cvt_pk_bf16_f32 v83, v142, v143
    v_exp_f32 v146, v146
    v_exp_f32 v147, v147
    v_cvt_pk_bf16_f32 v84, v144, v145
    v_mfma_f32_32x32x16_bf16 v[152:167], v[60:63], v[76:79], v[152:167]
    v_exp_f32 v148, v148
    v_exp_f32 v149, v149
    v_cvt_pk_bf16_f32 v85, v146, v147
    v_exp_f32 v150, v150
    v_exp_f32 v151, v151
    v_cvt_pk_bf16_f32 v86, v148, v149
    v_cvt_pk_bf16_f32 v87, v150, v151
    s_add_u32 s43, s43, 4096
    buffer_load_dwordx4 v[248:251], v1, s[8:11], s43 offen offset:0 sc1
    buffer_load_dwordx4 v[252:255], v1, s[8:11], s43 offen offset:1024 sc1
    v_mfma_f32_32x32x16_bf16 v[136:151], v[28:31], v[20:23], 0
    v_exp_f32 v120, v120
    v_exp_f32 v121, v121
    v_exp_f32 v122, v122
    v_exp_f32 v123, v123
    v_cvt_pk_bf16_f32 v72, v120, v121
    v_mfma_f32_32x32x8_bf16 v[136:151], v[40:41], v[26:27], v[136:151]
    v_exp_f32 v124, v124
    v_exp_f32 v125, v125
    v_cvt_pk_bf16_f32 v73, v122, v123
    v_exp_f32 v126, v126
    v_exp_f32 v127, v127
    v_cvt_pk_bf16_f32 v74, v124, v125
    v_mfma_f32_32x32x16_bf16 v[168:183], v[56:59], v[80:83], v[168:183]
    v_exp_f32 v128, v128
    v_exp_f32 v129, v129
    v_cvt_pk_bf16_f32 v75, v126, v127
    v_exp_f32 v130, v130
    v_exp_f32 v131, v131
    v_cvt_pk_bf16_f32 v76, v128, v129
    v_mfma_f32_32x32x16_bf16 v[168:183], v[60:63], v[84:87], v[168:183]
    v_exp_f32 v132, v132
    v_exp_f32 v133, v133
    v_cvt_pk_bf16_f32 v77, v130, v131
    v_exp_f32 v134, v134
    v_exp_f32 v135, v135
    v_cvt_pk_bf16_f32 v78, v132, v133
    v_cvt_pk_bf16_f32 v79, v134, v135
    s_mov_b64 exec, s[30:31]
    ds_read_b128 v[56:59], v5 offset:35712
    ds_read_b128 v[60:63], v5 offset:36288
    s_mov_b64 exec, -1
    s_waitcnt lgkmcnt(4)
    v_mfma_f32_32x32x16_bf16 v[120:135], v[32:35], v[16:19], 0
    v_exp_f32 v136, v136
    v_exp_f32 v137, v137
    v_exp_f32 v138, v138
    v_exp_f32 v139, v139
    v_cvt_pk_bf16_f32 v80, v136, v137
    v_mfma_f32_32x32x8_bf16 v[120:135], v[42:43], v[24:25], v[120:135]
    v_exp_f32 v140, v140
    v_exp_f32 v141, v141
    v_cvt_pk_bf16_f32 v81, v138, v139
    v_exp_f32 v142, v142
    v_exp_f32 v143, v143
    v_cvt_pk_bf16_f32 v82, v140, v141
    s_waitcnt lgkmcnt(2)
    v_mfma_f32_32x32x16_bf16 v[152:167], v[48:51], v[72:75], v[152:167]
    v_exp_f32 v144, v144
    v_exp_f32 v145, v145
    v_cvt_pk_bf16_f32 v83, v142, v143
    v_exp_f32 v146, v146
    v_exp_f32 v147, v147
    v_cvt_pk_bf16_f32 v84, v144, v145
    v_mfma_f32_32x32x16_bf16 v[152:167], v[52:55], v[76:79], v[152:167]
    v_exp_f32 v148, v148
    v_exp_f32 v149, v149
    v_cvt_pk_bf16_f32 v85, v146, v147
    v_exp_f32 v150, v150
    v_exp_f32 v151, v151
    v_cvt_pk_bf16_f32 v86, v148, v149
    v_cvt_pk_bf16_f32 v87, v150, v151
    v_mfma_f32_32x32x16_bf16 v[136:151], v[32:35], v[20:23], 0
    v_exp_f32 v120, v120
    v_exp_f32 v121, v121
    v_exp_f32 v122, v122
    v_exp_f32 v123, v123
    v_cvt_pk_bf16_f32 v72, v120, v121
    v_mfma_f32_32x32x8_bf16 v[136:151], v[42:43], v[26:27], v[136:151]
    v_exp_f32 v124, v124
    v_exp_f32 v125, v125
    v_cvt_pk_bf16_f32 v73, v122, v123
    v_exp_f32 v126, v126
    v_exp_f32 v127, v127
    v_cvt_pk_bf16_f32 v74, v124, v125
    v_mfma_f32_32x32x16_bf16 v[168:183], v[48:51], v[80:83], v[168:183]
    v_exp_f32 v128, v128
    v_exp_f32 v129, v129
    v_cvt_pk_bf16_f32 v75, v126, v127
    v_exp_f32 v130, v130
    v_exp_f32 v131, v131
    v_cvt_pk_bf16_f32 v76, v128, v129
    v_mfma_f32_32x32x16_bf16 v[168:183], v[52:55], v[84:87], v[168:183]
    v_exp_f32 v132, v132
    v_exp_f32 v133, v133
    v_cvt_pk_bf16_f32 v77, v130, v131
    v_exp_f32 v134, v134
    v_exp_f32 v135, v135
    v_cvt_pk_bf16_f32 v78, v132, v133
    v_cvt_pk_bf16_f32 v79, v134, v135
    s_waitcnt lgkmcnt(0)
    v_mfma_f32_32x32x16_bf16 v[152:167], v[56:59], v[72:75], v[152:167]
    v_exp_f32 v136, v136
    v_exp_f32 v137, v137
    v_exp_f32 v138, v138
    v_exp_f32 v139, v139
    v_cvt_pk_bf16_f32 v80, v136, v137
    v_mfma_f32_32x32x16_bf16 v[152:167], v[60:63], v[76:79], v[152:167]
    v_exp_f32 v140, v140
    v_exp_f32 v141, v141
    v_cvt_pk_bf16_f32 v81, v138, v139
    v_exp_f32 v142, v142
    v_exp_f32 v143, v143
    v_cvt_pk_bf16_f32 v82, v140, v141
    v_exp_f32 v144, v144
    v_exp_f32 v145, v145
    v_cvt_pk_bf16_f32 v83, v142, v143
    v_exp_f32 v146, v146
    v_exp_f32 v147, v147
    v_cvt_pk_bf16_f32 v84, v144, v145
    v_exp_f32 v148, v148
    v_exp_f32 v149, v149
    v_cvt_pk_bf16_f32 v85, v146, v147
    v_exp_f32 v150, v150
    v_exp_f32 v151, v151
    v_cvt_pk_bf16_f32 v86, v148, v149
    v_cvt_pk_bf16_f32 v87, v150, v151
    v_mfma_f32_32x32x16_bf16 v[168:183], v[56:59], v[80:83], v[168:183]
    s_nop 0
    v_mfma_f32_32x32x16_bf16 v[168:183], v[60:63], v[84:87], v[168:183]
Lm40_tail:
    v_cmp_eq_u32 vcc, 0, v3
    s_lshl_b32 s41, s16, 2
    s_add_u32 s41, s41, 147456
    v_mov_b32 v13, s41
    v_mov_b32 v128, 0x5d800000
    s_mul_i32 s41, s16, 3072
    v_add_u32 v130, s41, v1
    s_xor_b32 s41, s16, 4
    s_mul_i32 s41, s41, 3072
    v_add_u32 v131, s41, v1
    v_cndmask_b32 v14, v160, v162, vcc
    s_nop 0
    v_cndmask_b32 v15, v176, v178, vcc
    v_cmp_nlt_f32 s[32:33], v14, v128
    v_cmp_nlt_f32 s[20:21], v15, v128
    s_cmp_eq_u32 s18, 0
    s_cselect_b32 s41, 0x21800000, -1.0
    s_or_b64 s[32:33], s[32:33], s[20:21]
    v_cmp_nlt_f32 s[20:21], s41, v14
    v_cmp_nlt_f32 s[42:43], s41, v15
    s_or_b64 s[32:33], s[32:33], s[20:21]
    s_or_b64 s[32:33], s[32:33], s[42:43]
    s_cmp_lg_u64 s[32:33], 0
    s_cselect_b32 s41, 1, 0
    v_mov_b32 v14, s41
    ds_write_b32 v13, v14
    v_mov_b32 v13, 147456
    s_lshl_b32 s41, s22, 1
    s_mul_i32 s41, s41, 18432
    s_add_u32 s41, s41, 12582912
    s_lshr_b32 s42, s19, 1
    s_lshl_b32 s42, s42, 10
    s_and_b32 s43, s19, 1
    s_lshl_b32 s43, s43, 9
    s_add_u32 s42, s42, s43
    s_add_u32 s42, s42, s41
    v_lshrrev_b32 v14, 4, v2
    v_mul_u32_u24 v14, 18432, v14
    v_and_b32 v15, 15, v2
    v_lshl_add_u32 v14, v15, 4, v14
    v_lshl_add_u32 v15, v3, 8, v14
    v_lshlrev_b32 v14, 2, v2
    s_lshl_b32 s41, s19, 13
    s_lshl_b32 s43, s22, 7
    s_add_u32 s41, s41, s43
    s_add_u32 s41, s41, 44302336
    s_waitcnt lgkmcnt(0)
    s_barrier
    ds_read_b128 v[120:123], v13
    ds_read_b128 v[124:127], v13 offset:16
    s_waitcnt lgkmcnt(0)
    v_or3_b32 v13, v120, v121, v122
    v_or3_b32 v13, v13, v123, v124
    v_or3_b32 v13, v13, v125, v126
    v_or_b32 v13, v13, v127
    s_nop 0
    v_readfirstlane_b32 s43, v13
    s_nop 0
    s_andn2_b32 s43, s43, s44
    s_cmp_lg_u32 s43, 0
    s_cbranch_scc1 Lm41_fb
    ds_write_b128 v130, v[168:171] offset:0
    ds_write_b128 v130, v[172:175] offset:1024
    ds_write_b128 v130, v[176:179] offset:2048
    s_waitcnt lgkmcnt(0)
    s_barrier
    ds_read_b128 v[176:179], v131 offset:2048
    ds_read_b128 v[172:175], v131 offset:1024
    ds_read_b128 v[168:171], v131 offset:0
    s_waitcnt lgkmcnt(2)
    v_add_f32 v160, v160, v176
    v_add_f32 v162, v162, v178
    v_add_f32 v161, v161, v177
    v_cndmask_b32 v13, v160, v162, vcc
    v_rcp_f32 v13, v13
    s_waitcnt lgkmcnt(0)
    v_add_f32 v152, v152, v168
    v_add_f32 v153, v153, v169
    v_add_f32 v154, v154, v170
    v_add_f32 v155, v155, v171
    v_add_f32 v156, v156, v172
    v_add_f32 v157, v157, v173
    v_add_f32 v158, v158, v174
    v_add_f32 v159, v159, v175
    v_mul_f32 v152, v152, v13
    v_mul_f32 v153, v153, v13
    v_mul_f32 v154, v154, v13
    v_mul_f32 v155, v155, v13
    v_mul_f32 v156, v156, v13
    v_mul_f32 v157, v157, v13
    v_mul_f32 v158, v158, v13
    v_mul_f32 v159, v159, v13
    v_mul_f32 v160, v160, v13
    v_mul_f32 v161, v161, v13
    v_cvt_pk_bf16_f32 v72, v152, v153
    v_cvt_pk_bf16_f32 v73, v154, v155
    v_cvt_pk_bf16_f32 v74, v156, v157
    v_cvt_pk_bf16_f32 v75, v158, v159
    v_cvt_pk_bf16_f32 v76, v160, v161
    buffer_store_dwordx4 v[72:75], v15, s[12:15], s42 offen sc1
    s_mov_b64 exec, s[28:29]
    buffer_store_dword v76, v14, s[12:15], s41 offen sc1
    s_mov_b64 exec, -1
    s_branch Lm43_adone
Lm41_fb:
    s_mov_b32 s44, 1
    s_mov_b32 s41, 64
    v_mov_b32 v14, 0xff800000
    v_mov_b32 v15, 0xff800000
    v_mov_b32 v25, 0
    v_mov_b32 v27, 0
    v_mov_b32 v72, v1
    v_mov_b32 v73, v12
Lm42_fbl:
    ds_read_b128 v[28:31], v72
    ds_read_b32 v40, v73
    v_add_u32 v72, 1024, v72
    v_add_u32 v73, 128, v73
    s_waitcnt lgkmcnt(0)
    v_mfma_f32_32x32x16_bf16 v[120:135], v[28:31], v[16:19], 0
    v_mfma_f32_32x32x8_bf16 v[120:135], v[40:41], v[24:25], v[120:135]
    v_mfma_f32_32x32x16_bf16 v[136:151], v[28:31], v[20:23], 0
    v_mfma_f32_32x32x8_bf16 v[136:151], v[40:41], v[26:27], v[136:151]
    s_nop 9
    v_max3_f32 v14, v14, v120, v121
    v_max3_f32 v14, v14, v122, v123
    v_max3_f32 v14, v14, v124, v125
    v_max3_f32 v14, v14, v126, v127
    v_max3_f32 v14, v14, v128, v129
    v_max3_f32 v14, v14, v130, v131
    v_max3_f32 v14, v14, v132, v133
    v_max3_f32 v14, v14, v134, v135
    v_max3_f32 v15, v15, v136, v137
    v_max3_f32 v15, v15, v138, v139
    v_max3_f32 v15, v15, v140, v141
    v_max3_f32 v15, v15, v142, v143
    v_max3_f32 v15, v15, v144, v145
    v_max3_f32 v15, v15, v146, v147
    v_max3_f32 v15, v15, v148, v149
    v_max3_f32 v15, v15, v150, v151
    s_sub_u32 s41, s41, 1
    s_cmp_lg_u32 s41, 0
    s_cbranch_scc1 Lm42_fbl
    v_mov_b32 v88, v14
    v_mov_b32 v89, v15
    s_nop 1
    v_permlane32_swap_b32 v14, v88
    v_permlane32_swap_b32 v15, v89
    v_max_f32 v14, v14, v88
    v_max_f32 v15, v15, v89
    v_mov_b32 v88, v10
    v_mov_b32 v89, v11
    v_mov_b32 v90, v5
    s_mov_b32 s41, 32
    s_barrier
    v_mov_b32 v152, 0
    v_mov_b32 v153, 0
    v_mov_b32 v154, 0
    v_mov_b32 v155, 0
    v_mov_b32 v156, 0
    v_mov_b32 v157, 0
    v_mov_b32 v158, 0
    v_mov_b32 v159, 0
    v_mov_b32 v160, 0
    v_mov_b32 v161, 0
    v_mov_b32 v162, 0
    v_mov_b32 v163, 0
    v_mov_b32 v164, 0
    v_mov_b32 v165, 0
    v_mov_b32 v166, 0
    v_mov_b32 v167, 0
    v_mov_b32 v168, 0
    v_mov_b32 v169, 0
    v_mov_b32 v170, 0
    v_mov_b32 v171, 0
    v_mov_b32 v172, 0
    v_mov_b32 v173, 0
    v_mov_b32 v174, 0
    v_mov_b32 v175, 0
    v_mov_b32 v176, 0
    v_mov_b32 v177, 0
    v_mov_b32 v178, 0
    v_mov_b32 v179, 0
    v_mov_b32 v180, 0
    v_mov_b32 v181, 0
    v_mov_b32 v182, 0
    v_mov_b32 v183, 0
Lm63_fb2:
    ds_read_b128 v[28:31], v88
    ds_read_b32 v40, v89
    s_mov_b64 exec, s[30:31]
    ds_read_b128 v[48:51], v90
    ds_read_b128 v[52:55], v90 offset:576
    s_mov_b64 exec, -1
    v_add_u32 v88, 1024, v88
    v_add_u32 v89, 128, v89
    v_add_u32 v90, 1152, v90
    s_waitcnt lgkmcnt(0)
    v_mfma_f32_32x32x16_bf16 v[120:135], v[28:31], v[16:19], 0
    v_mfma_f32_32x32x8_bf16 v[120:135], v[40:41], v[24:25], v[120:135]
    v_mfma_f32_32x32x16_bf16 v[136:151], v[28:31], v[20:23], 0
    v_mfma_f32_32x32x8_bf16 v[136:151], v[40:41], v[26:27], v[136:151]
    s_nop 9
    v_sub_f32 v120, v120, v14
    v_sub_f32 v121, v121, v14
    v_sub_f32 v122, v122, v14
    v_sub_f32 v123, v123, v14
    v_sub_f32 v124, v124, v14
    v_sub_f32 v125, v125, v14
    v_sub_f32 v126, v126, v14
    v_sub_f32 v127, v127, v14
    v_sub_f32 v128, v128, v14
    v_sub_f32 v129, v129, v14
    v_sub_f32 v130, v130, v14
    v_sub_f32 v131, v131, v14
    v_sub_f32 v132, v132, v14
    v_sub_f32 v133, v133, v14
    v_sub_f32 v134, v134, v14
    v_sub_f32 v135, v135, v14
    v_exp_f32 v120, v120
    v_exp_f32 v121, v121
    v_exp_f32 v122, v122
    v_exp_f32 v123, v123
    v_exp_f32 v124, v124
    v_exp_f32 v125, v125
    v_exp_f32 v126, v126
    v_exp_f32 v127, v127
    v_exp_f32 v128, v128
    v_exp_f32 v129, v129
    v_exp_f32 v130, v130
    v_exp_f32 v131, v131
    v_exp_f32 v132, v132
    v_exp_f32 v133, v133
    v_exp_f32 v134, v134
    v_exp_f32 v135, v135
    v_cvt_pk_bf16_f32 v72, v120, v121
    v_cvt_pk_bf16_f32 v73, v122, v123
    v_cvt_pk_bf16_f32 v74, v124, v125
    v_cvt_pk_bf16_f32 v75, v126, v127
    v_cvt_pk_bf16_f32 v76, v128, v129
    v_cvt_pk_bf16_f32 v77, v130, v131
    v_cvt_pk_bf16_f32 v78, v132, v133
    v_cvt_pk_bf16_f32 v79, v134, v135
    v_mfma_f32_32x32x16_bf16 v[152:167], v[48:51], v[72:75], v[152:167]
    s_nop 0
    v_mfma_f32_32x32x16_bf16 v[152:167], v[52:55], v[76:79], v[152:167]
    v_sub_f32 v136, v136, v15
    v_sub_f32 v137, v137, v15
    v_sub_f32 v138, v138, v15
    v_sub_f32 v139, v139, v15
    v_sub_f32 v140, v140, v15
    v_sub_f32 v141, v141, v15
    v_sub_f32 v142, v142, v15
    v_sub_f32 v143, v143, v15
    v_sub_f32 v144, v144, v15
    v_sub_f32 v145, v145, v15
    v_sub_f32 v146, v146, v15
    v_sub_f32 v147, v147, v15
    v_sub_f32 v148, v148, v15
    v_sub_f32 v149, v149, v15
    v_sub_f32 v150, v150, v15
    v_sub_f32 v151, v151, v15
    v_exp_f32 v136, v136
    v_exp_f32 v137, v137
    v_exp_f32 v138, v138
    v_exp_f32 v139, v139
    v_exp_f32 v140, v140
    v_exp_f32 v141, v141
    v_exp_f32 v142, v142
    v_exp_f32 v143, v143
    v_exp_f32 v144, v144
    v_exp_f32 v145, v145
    v_exp_f32 v146, v146
    v_exp_f32 v147, v147
    v_exp_f32 v148, v148
    v_exp_f32 v149, v149
    v_exp_f32 v150, v150
    v_exp_f32 v151, v151
    v_cvt_pk_bf16_f32 v80, v136, v137
    v_cvt_pk_bf16_f32 v81, v138, v139
    v_cvt_pk_bf16_f32 v82, v140, v141
    v_cvt_pk_bf16_f32 v83, v142, v143
    v_cvt_pk_bf16_f32 v84, v144, v145
    v_cvt_pk_bf16_f32 v85, v146, v147
    v_cvt_pk_bf16_f32 v86, v148, v149
    v_cvt_pk_bf16_f32 v87, v150, v151
    v_mfma_f32_32x32x16_bf16 v[168:183], v[48:51], v[80:83], v[168:183]
    s_nop 0
    v_mfma_f32_32x32x16_bf16 v[168:183], v[52:55], v[84:87], v[168:183]
    s_sub_u32 s41, s41, 1
    s_cmp_lg_u32 s41, 0
    s_cbranch_scc1 Lm63_fb2
    s_branch Lm40_tail
Lm43_adone:
    s_waitcnt vmcnt(0) lgkmcnt(0)
    s_barrier
    s_cmp_lg_u32 s16, 0
    s_cbranch_scc1 Lm64_pub
    v_mov_b32 v13, s79
    v_mov_b32 v14, s80
    s_mov_b64 exec, 1
    buffer_store_dword v14, v13, s[12:15], s26 offen sc1
    s_mov_b64 exec, -1
Lm64_pub:
    v_mbcnt_lo_u32_b32 v0, -1, 0
    v_mbcnt_hi_u32_b32 v0, -1, v0
    v_lshlrev_b32 v1, 4, v0
    v_and_b32 v2, 15, v0
    v_lshrrev_b32 v3, 4, v0
    s_bfe_u32 s17, s2, 0x20001
    s_lshl_b32 s17, s17, 4
    s_bfe_u32 s18, s2, 0x40003
    s_add_u32 s17, s17, s18
    s_and_b32 s18, s2, 1
    s_lshl_b32 s18, s18, 1
    s_lshr_b32 s19, s2, 7
    s_add_u32 s18, s18, s19
    s_mul_i32 s19, s18, 9
    s_add_u32 s31, s19, 8
    s_add_u32 s19, s19, s16
    s_mul_i32 s42, s17, 36864
    s_lshr_b32 s21, s16, 2
    s_mul_i32 s21, s21, 18432
    s_and_b32 s24, s16, 3
    s_lshl_b32 s24, s24, 12
    s_add_u32 s21, s21, s24
    s_add_u32 s43, s42, s21
    s_add_u32 s43, s43, 12582912
    s_lshl_b32 s32, s16, 15
    s_lshl_b32 s33, s17, 7
    s_add_u32 s32, s32, s33
    s_add_u32 s32, s32, 44302336
    s_lshl_b32 s33, s16, 8
    s_add_u32 s33, s33, 126976
    v_and_b32 v7, 3, v0
    v_lshlrev_b32 v7, 13, v7
    v_and_b32 v8, 60, v0
    v_add_u32 v7, v7, v8
    s_lshl_b32 s24, s19, 9
    s_add_u32 s24, s24, s42
    v_lshrrev_b32 v4, 1, v3
    v_lshlrev_b32 v4, 8, v4
    v_lshl_add_u32 v4, v2, 4, v4
    v_and_b32 v5, 1, v3
    v_mul_u32_u24 v8, 18432, v5
    v_add_u32 v8, v8, v4
    v_lshl_add_u32 v4, v5, 3, v4
    s_add_u32 s25, s24, 65536
    s_add_u32 s27, s24, 2424832
    s_and_b32 s34, s16, 1
    s_mul_i32 s34, s34, 18432
    s_lshl_b32 s35, s31, 9
    s_add_u32 s35, s35, s42
    s_add_u32 s35, s35, s34
    s_add_u32 s36, s35, 2424832
    s_add_u32 s35, s35, 65536
    s_add_u32 s34, s34, 110592
    v_add_u32 v6, s34, v1
    v_add_u32 v5, 110592, v1
    v_add_u32 v9, 110592, v1
    s_lshr_b32 s40, s17, 3
    s_lshl_b32 s40, s40, 12
    s_add_u32 s40, s40, 44597248
    s_lshl_b32 s37, s17, 2
    s_add_u32 s37, s37, s18
    s_lshl_b32 s37, s37, 7
    s_add_u32 s37, s37, 44630016
    s_mul_i32 s29, s17, 9216
    s_add_u32 s29, s29, 4849664
    s_lshl_b32 s30, s31, 8
    s_add_u32 s41, s29, s30
    s_and_b32 s30, s16, 1
    s_lshl_b32 s30, s30, 3
    s_add_u32 s41, s41, s30
    s_lshl_b32 s30, s19, 8
    s_add_u32 s29, s29, s30
    s_and_b32 s44, s2, 3
    s_lshl_b32 s44, s44, 3
    s_bfe_u32 s45, s2, 0x30003
    s_add_u32 s44, s44, s45
    s_mul_i32 s44, s44, 331776
    s_add_u32 s44, s44, 3145728
    s_mul_i32 s20, s16, 4608
    s_mov_b32 s22, -1
    s_mov_b32 s23, 0
    s_xor_b32 s38, s16, 7
    s_min_u32 s38, s38, s79
    s_cmp_eq_u32 s16, 7
    s_cbranch_scc1 Lm65_p
    s_cmp_ge_u32 s16, 2
    s_cbranch_scc1 Lm69_w9l
    s_mul_i32 s45, s31, 18432
    s_add_u32 s45, s45, 2097152
    buffer_load_dwordx4 v[16:19], v1, s[8:11], s45 offen offset:0 sc1
    buffer_load_dwordx4 v[20:23], v1, s[8:11], s45 offen offset:1024 sc1
    buffer_load_dwordx4 v[24:27], v1, s[8:11], s45 offen offset:2048 sc1
    buffer_load_dwordx4 v[28:31], v1, s[8:11], s45 offen offset:3072 sc1
    s_add_u32 s45, s45, 4096
    buffer_load_dwordx4 v[32:35], v1, s[8:11], s45 offen offset:0 sc1
    buffer_load_dwordx4 v[36:39], v1, s[8:11], s45 offen offset:1024 sc1
    buffer_load_dwordx4 v[40:43], v1, s[8:11], s45 offen offset:2048 sc1
    buffer_load_dwordx4 v[44:47], v1, s[8:11], s45 offen offset:3072 sc1
    s_add_u32 s45, s45, 4096
    buffer_load_dwordx4 v[48:51], v1, s[8:11], s45 offen offset:0 sc1
    buffer_load_dwordx4 v[52:55], v1, s[8:11], s45 offen offset:1024 sc1
    buffer_load_dwordx4 v[56:59], v1, s[8:11], s45 offen offset:2048 sc1
    buffer_load_dwordx4 v[60:63], v1, s[8:11], s45 offen offset:3072 sc1
    s_add_u32 s45, s45, 4096
    buffer_load_dwordx4 v[64:67], v1, s[8:11], s45 offen offset:0 sc1
    buffer_load_dwordx4 v[68:71], v1, s[8:11], s45 offen offset:1024 sc1
    buffer_load_dwordx4 v[72:75], v1, s[8:11], s45 offen offset:2048 sc1
    buffer_load_dwordx4 v[76:79], v1, s[8:11], s45 offen offset:3072 sc1
    s_add_u32 s45, s45, 4096
    buffer_load_dwordx4 v[80:83], v1, s[8:11], s45 offen offset:0 sc1
    buffer_load_dwordx4 v[84:87], v1, s[8:11], s45 offen offset:1024 sc1
Lm69_w9l:
    buffer_load_dwordx4 v[124:127], v8, s[12:15], s25 offen sc1
    buffer_load_dwordx2 v[128:129], v4, s[12:15], s35 offen sc1
    s_cmp_lg_u32 s38, 0
    s_cbranch_scc0 Lm70_f1
    s_cmp_ge_u32 s16, 4
    s_cbranch_scc1 Lm71_sp
    s_lshl_b32 s47, s16, 10
    s_add_u32 m0, s47, 81920
    s_add_u32 s26, s44, m0
    buffer_load_dwordx4 v1, s[8:11], s26 offen sc1 lds
Lm71_sp:
    s_lshl_b32 s47, s16, 10
    s_add_u32 m0, s47, 0
    s_add_u32 s26, s44, m0
    buffer_load_dwordx4 v1, s[8:11], s26 offen sc1 lds
    s_lshl_b32 s47, s16, 10
    s_cmp_ge_u32 s16, 4
    s_cselect_b32 s26, 24576, 0
    s_add_u32 s47, s47, s26
    s_add_u32 m0, s47, 8192
    s_add_u32 s26, s44, m0
    buffer_load_dwordx4 v1, s[8:11], s26 offen sc1 lds
    s_lshl_b32 s47, s16, 10
    s_add_u32 m0, s47, 40960
    s_add_u32 s26, s44, m0
    buffer_load_dwordx4 v1, s[8:11], s26 offen sc1 lds
    s_lshl_b32 s47, s16, 10
    s_add_u32 m0, s47, 73728
    s_add_u32 s26, s44, m0
    buffer_load_dwordx4 v1, s[8:11], s26 offen sc1 lds
Lm70_f1:
    s_barrier
    s_branch Lm66_j
Lm65_p:
    v_lshl_add_u32 v13, v0, 7, s79
    s_mov_b32 s3, 0x40000
    s_cmp_lg_u32 s79, 0
    s_cbranch_scc1 Lm77_b
    s_mov_b32 s40, 44597248
Lm76_a:
    buffer_load_dword v14, v13, s[12:15], s40 offen sc1
    v_add_u32 v15, 8192, v13
    buffer_load_dword v10, v15, s[12:15], s40 offen sc1
    v_add_u32 v15, 16384, v13
    buffer_load_dword v11, v15, s[12:15], s40 offen sc1
    v_add_u32 v15, 24576, v13
    buffer_load_dword v12, v15, s[12:15], s40 offen sc1
    s_waitcnt vmcnt(0)
    v_xor_b32 v14, s80, v14
    v_xor_b32 v10, s80, v10
    v_xor_b32 v11, s80, v11
    v_xor_b32 v12, s80, v12
    v_or3_b32 v14, v14, v10, v11
    v_or_b32 v14, v14, v12
    v_cmp_ne_u32 vcc, 0, v14
    s_sub_u32 s3, s3, 1
    s_cbranch_scc1 Lm68_d
    s_nop 2
    s_cbranch_vccz Lm68_d
    s_sleep 4
    s_branch Lm76_a
Lm77_b:
    s_mov_b32 exec_lo, 4294967295
    s_mov_b32 exec_hi, 0
Lm67_l:
    buffer_load_dword v14, v13, s[12:15], s40 offen sc1
    s_waitcnt vmcnt(0)
    v_cmp_ne_u32 vcc, s80, v14
    s_sub_u32 s3, s3, 1
    s_cbranch_scc1 Lm68_d
    s_nop 2
    s_cbranch_vccz Lm68_d
    s_sleep 4
    s_branch Lm67_l
Lm68_d:
    s_mov_b64 exec, -1
    s_barrier
    s_cmp_ge_u32 s16, 2
    s_cbranch_scc1 Lm78_w9l
    s_mul_i32 s45, s31, 18432
    s_add_u32 s45, s45, 2097152
    buffer_load_dwordx4 v[16:19], v1, s[8:11], s45 offen offset:0 sc1
    buffer_load_dwordx4 v[20:23], v1, s[8:11], s45 offen offset:1024 sc1
    buffer_load_dwordx4 v[24:27], v1, s[8:11], s45 offen offset:2048 sc1
    buffer_load_dwordx4 v[28:31], v1, s[8:11], s45 offen offset:3072 sc1
    s_add_u32 s45, s45, 4096
    buffer_load_dwordx4 v[32:35], v1, s[8:11], s45 offen offset:0 sc1
    buffer_load_dwordx4 v[36:39], v1, s[8:11], s45 offen offset:1024 sc1
    buffer_load_dwordx4 v[40:43], v1, s[8:11], s45 offen offset:2048 sc1
    buffer_load_dwordx4 v[44:47], v1, s[8:11], s45 offen offset:3072 sc1
    s_add_u32 s45, s45, 4096
    buffer_load_dwordx4 v[48:51], v1, s[8:11], s45 offen offset:0 sc1
    buffer_load_dwordx4 v[52:55], v1, s[8:11], s45 offen offset:1024 sc1
    buffer_load_dwordx4 v[56:59], v1, s[8:11], s45 offen offset:2048 sc1
    buffer_load_dwordx4 v[60:63], v1, s[8:11], s45 offen offset:3072 sc1
    s_add_u32 s45, s45, 4096
    buffer_load_dwordx4 v[64:67], v1, s[8:11], s45 offen offset:0 sc1
    buffer_load_dwordx4 v[68:71], v1, s[8:11], s45 offen offset:1024 sc1
    buffer_load_dwordx4 v[72:75], v1, s[8:11], s45 offen offset:2048 sc1
    buffer_load_dwordx4 v[76:79], v1, s[8:11], s45 offen offset:3072 sc1
    s_add_u32 s45, s45, 4096
    buffer_load_dwordx4 v[80:83], v1, s[8:11], s45 offen offset:0 sc1
    buffer_load_dwordx4 v[84:87], v1, s[8:11], s45 offen offset:1024 sc1
Lm78_w9l:
    buffer_load_dwordx4 v[124:127], v8, s[12:15], s25 offen sc1
    buffer_load_dwordx2 v[128:129], v4, s[12:15], s35 offen sc1
Lm66_j:
    s_add_u32 m0, s21, 110592
    s_nop 0
    buffer_load_dwordx4 v1, s[12:15], s43 offen offset:0 sc1 lds
    buffer_load_dwordx4 v1, s[12:15], s43 offen offset:1024 sc1 lds
    buffer_load_dwordx4 v1, s[12:15], s43 offen offset:2048 sc1 lds
    buffer_load_dwordx4 v1, s[12:15], s43 offen offset:3072 sc1 lds
    s_mov_b32 m0, s33
    s_nop 0
    buffer_load_dword v7, s[12:15], s32 offen sc1 lds
    s_add_u32 m0, s33, 18432
    s_add_u32 s32, s32, 64
    buffer_load_dword v7, s[12:15], s32 offen sc1 lds
    v_mov_b32 v14, 0x3f803f80
    s_waitcnt vmcnt(0)
    s_barrier
    ds_read_b128 v[88:91], v5 offset:0
    ds_read_b128 v[92:95], v5 offset:18432
    ds_read_b128 v[96:99], v5 offset:1024
    ds_read_b128 v[100:103], v5 offset:19456
    s_cmp_lg_u32 s38, 0
    s_cbranch_scc1 Lm79_f1
    s_cmp_ge_u32 s16, 4
    s_cbranch_scc1 Lm80_sp
    s_lshl_b32 s47, s16, 10
    s_add_u32 m0, s47, 81920
    s_add_u32 s26, s44, m0
    buffer_load_dwordx4 v1, s[8:11], s26 offen sc1 lds
Lm80_sp:
    s_lshl_b32 s47, s16, 10
    s_add_u32 m0, s47, 0
    s_add_u32 s26, s44, m0
    buffer_load_dwordx4 v1, s[8:11], s26 offen sc1 lds
    s_lshl_b32 s47, s16, 10
    s_cmp_ge_u32 s16, 4
    s_cselect_b32 s26, 24576, 0
    s_add_u32 s47, s47, s26
    s_add_u32 m0, s47, 8192
    s_add_u32 s26, s44, m0
    buffer_load_dwordx4 v1, s[8:11], s26 offen sc1 lds
    s_lshl_b32 s47, s16, 10
    s_add_u32 m0, s47, 40960
    s_add_u32 s26, s44, m0
    buffer_load_dwordx4 v1, s[8:11], s26 offen sc1 lds
    s_lshl_b32 s47, s16, 10
    s_add_u32 m0, s47, 73728
    s_add_u32 s26, s44, m0
    buffer_load_dwordx4 v1, s[8:11], s26 offen sc1 lds
Lm79_f1:
    ds_read_b128 v[104:107], v5 offset:2048
    s_waitcnt lgkmcnt(4)
    v_mfma_f32_16x16x32_bf16 v[112:115], v[184:187], v[88:91], 0
    ds_read_b128 v[108:111], v5 offset:20480
    s_waitcnt lgkmcnt(4)
    v_mfma_f32_16x16x32_bf16 v[116:119], v[184:187], v[92:95], 0
    ds_read_b128 v[88:91], v5 offset:3072
    s_waitcnt lgkmcnt(4)
    v_mfma_f32_16x16x32_bf16 v[112:115], v[188:191], v[96:99], v[112:115]
    ds_read_b128 v[92:95], v5 offset:21504
    s_waitcnt lgkmcnt(4)
    v_mfma_f32_16x16x32_bf16 v[116:119], v[188:191], v[100:103], v[116:119]
    ds_read_b128 v[96:99], v5 offset:4096
    s_waitcnt lgkmcnt(4)
    v_mfma_f32_16x16x32_bf16 v[112:115], v[192:195], v[104:107], v[112:115]
    ds_read_b128 v[100:103], v5 offset:22528
    s_waitcnt lgkmcnt(4)
    v_mfma_f32_16x16x32_bf16 v[116:119], v[192:195], v[108:111], v[116:119]
    ds_read_b128 v[104:107], v5 offset:5120
    s_waitcnt lgkmcnt(4)
    v_mfma_f32_16x16x32_bf16 v[112:115], v[196:199], v[88:91], v[112:115]
    ds_read_b128 v[108:111], v5 offset:23552
    s_waitcnt lgkmcnt(4)
    v_mfma_f32_16x16x32_bf16 v[116:119], v[196:199], v[92:95], v[116:119]
    ds_read_b128 v[88:91], v5 offset:6144
    s_waitcnt lgkmcnt(4)
    v_mfma_f32_16x16x32_bf16 v[112:115], v[200:203], v[96:99], v[112:115]
    ds_read_b128 v[92:95], v5 offset:24576
    s_waitcnt lgkmcnt(4)
    v_mfma_f32_16x16x32_bf16 v[116:119], v[200:203], v[100:103], v[116:119]
    ds_read_b128 v[96:99], v5 offset:7168
    s_waitcnt lgkmcnt(4)
    v_mfma_f32_16x16x32_bf16 v[112:115], v[204:207], v[104:107], v[112:115]
    ds_read_b128 v[100:103], v5 offset:25600
    s_waitcnt lgkmcnt(4)
    v_mfma_f32_16x16x32_bf16 v[116:119], v[204:207], v[108:111], v[116:119]
    ds_read_b128 v[104:107], v5 offset:8192
    s_waitcnt lgkmcnt(4)
    v_mfma_f32_16x16x32_bf16 v[112:115], v[208:211], v[88:91], v[112:115]
    ds_read_b128 v[108:111], v5 offset:26624
    s_waitcnt lgkmcnt(4)
    v_mfma_f32_16x16x32_bf16 v[116:119], v[208:211], v[92:95], v[116:119]
    ds_read_b128 v[88:91], v5 offset:9216
    s_waitcnt lgkmcnt(4)
    v_mfma_f32_16x16x32_bf16 v[112:115], v[212:215], v[96:99], v[112:115]
    ds_read_b128 v[92:95], v5 offset:27648
    s_waitcnt lgkmcnt(4)
    v_mfma_f32_16x16x32_bf16 v[116:119], v[212:215], v[100:103], v[116:119]
    ds_read_b128 v[96:99], v5 offset:10240
    s_waitcnt lgkmcnt(4)
    v_mfma_f32_16x16x32_bf16 v[112:115], v[216:219], v[104:107], v[112:115]
    ds_read_b128 v[100:103], v5 offset:28672
    s_waitcnt lgkmcnt(4)
    v_mfma_f32_16x16x32_bf16 v[116:119], v[216:219], v[108:111], v[116:119]
    ds_read_b128 v[104:107], v5 offset:11264
    s_waitcnt lgkmcnt(4)
    v_mfma_f32_16x16x32_bf16 v[112:115], v[220:223], v[88:91], v[112:115]
    ds_read_b128 v[108:111], v5 offset:29696
    s_waitcnt lgkmcnt(4)
    v_mfma_f32_16x16x32_bf16 v[116:119], v[220:223], v[92:95], v[116:119]
    ds_read_b128 v[88:91], v5 offset:12288
    s_waitcnt lgkmcnt(4)
    v_mfma_f32_16x16x32_bf16 v[112:115], v[224:227], v[96:99], v[112:115]
    ds_read_b128 v[92:95], v5 offset:30720
    s_waitcnt lgkmcnt(4)
    v_mfma_f32_16x16x32_bf16 v[116:119], v[224:227], v[100:103], v[116:119]
    ds_read_b128 v[96:99], v5 offset:13312
    s_waitcnt lgkmcnt(4)
    v_mfma_f32_16x16x32_bf16 v[112:115], v[228:231], v[104:107], v[112:115]
    ds_read_b128 v[100:103], v5 offset:31744
    s_waitcnt lgkmcnt(4)
    v_mfma_f32_16x16x32_bf16 v[116:119], v[228:231], v[108:111], v[116:119]
    ds_read_b128 v[104:107], v5 offset:14336
    s_waitcnt lgkmcnt(4)
    v_mfma_f32_16x16x32_bf16 v[112:115], v[232:235], v[88:91], v[112:115]
    ds_read_b128 v[108:111], v5 offset:32768
    s_waitcnt lgkmcnt(4)
    v_mfma_f32_16x16x32_bf16 v[116:119], v[232:235], v[92:95], v[116:119]
    ds_read_b128 v[88:91], v5 offset:15360
    s_waitcnt lgkmcnt(4)
    v_mfma_f32_16x16x32_bf16 v[112:115], v[236:239], v[96:99], v[112:115]
    ds_read_b128 v[92:95], v5 offset:33792
    s_waitcnt lgkmcnt(4)
    v_mfma_f32_16x16x32_bf16 v[116:119], v[236:239], v[100:103], v[116:119]
    ds_read_b128 v[96:99], v5 offset:16384
    s_waitcnt lgkmcnt(4)
    v_mfma_f32_16x16x32_bf16 v[112:115], v[240:243], v[104:107], v[112:115]
    ds_read_b128 v[100:103], v5 offset:34816
    s_waitcnt lgkmcnt(4)
    v_mfma_f32_16x16x32_bf16 v[116:119], v[240:243], v[108:111], v[116:119]
    ds_read_b128 v[104:107], v5 offset:17408
    s_waitcnt lgkmcnt(4)
    v_mfma_f32_16x16x32_bf16 v[112:115], v[244:247], v[88:91], v[112:115]
    ds_read_b128 v[108:111], v5 offset:35840
    s_waitcnt lgkmcnt(4)
    v_mfma_f32_16x16x32_bf16 v[116:119], v[244:247], v[92:95], v[116:119]
    s_waitcnt lgkmcnt(3)
    v_mfma_f32_16x16x32_bf16 v[112:115], v[248:251], v[96:99], v[112:115]
    s_waitcnt lgkmcnt(2)
    v_mfma_f32_16x16x32_bf16 v[116:119], v[248:251], v[100:103], v[116:119]
    s_waitcnt lgkmcnt(1)
    v_mfma_f32_16x16x32_bf16 v[112:115], v[252:255], v[104:107], v[112:115]
    s_waitcnt lgkmcnt(0)
    v_mfma_f32_16x16x32_bf16 v[116:119], v[252:255], v[108:111], v[116:119]
    s_cmp_ge_u32 s16, 2
    s_nop 5
    s_cbranch_scc1 Lm85_w9
    ds_read_b128 v[184:187], v6 offset:0
    ds_read_b128 v[188:191], v6 offset:1024
    ds_read_b128 v[192:195], v6 offset:2048
    ds_read_b128 v[196:199], v6 offset:3072
    ds_read_b128 v[200:203], v6 offset:4096
    ds_read_b128 v[204:207], v6 offset:5120
    s_waitcnt lgkmcnt(5)
    v_mfma_f32_16x16x32_bf16 v[120:123], v[16:19], v[184:187], 0
    ds_read_b128 v[208:211], v6 offset:6144
    s_waitcnt lgkmcnt(5)
    v_mfma_f32_16x16x32_bf16 v[120:123], v[20:23], v[188:191], v[120:123]
    ds_read_b128 v[212:215], v6 offset:7168
    s_waitcnt lgkmcnt(5)
    v_mfma_f32_16x16x32_bf16 v[120:123], v[24:27], v[192:195], v[120:123]
    ds_read_b128 v[216:219], v6 offset:8192
    s_waitcnt lgkmcnt(5)
    v_mfma_f32_16x16x32_bf16 v[120:123], v[28:31], v[196:199], v[120:123]
    ds_read_b128 v[220:223], v6 offset:9216
    s_waitcnt lgkmcnt(5)
    v_mfma_f32_16x16x32_bf16 v[120:123], v[32:35], v[200:203], v[120:123]
    ds_read_b128 v[224:227], v6 offset:10240
    s_waitcnt lgkmcnt(5)
    v_mfma_f32_16x16x32_bf16 v[120:123], v[36:39], v[204:207], v[120:123]
    ds_read_b128 v[228:231], v6 offset:11264
    s_waitcnt lgkmcnt(5)
    v_mfma_f32_16x16x32_bf16 v[120:123], v[40:43], v[208:211], v[120:123]
    ds_read_b128 v[232:235], v6 offset:12288
    s_waitcnt lgkmcnt(5)
    v_mfma_f32_16x16x32_bf16 v[120:123], v[44:47], v[212:215], v[120:123]
    ds_read_b128 v[236:239], v6 offset:13312
    s_waitcnt lgkmcnt(5)
    v_mfma_f32_16x16x32_bf16 v[120:123], v[48:51], v[216:219], v[120:123]
    ds_read_b128 v[240:243], v6 offset:14336
    s_waitcnt lgkmcnt(5)
    v_mfma_f32_16x16x32_bf16 v[120:123], v[52:55], v[220:223], v[120:123]
    ds_read_b128 v[244:247], v6 offset:15360
    s_waitcnt lgkmcnt(5)
    v_mfma_f32_16x16x32_bf16 v[120:123], v[56:59], v[224:227], v[120:123]
    ds_read_b128 v[248:251], v6 offset:16384
    s_waitcnt lgkmcnt(5)
    v_mfma_f32_16x16x32_bf16 v[120:123], v[60:63], v[228:231], v[120:123]
    ds_read_b128 v[252:255], v6 offset:17408
    s_waitcnt lgkmcnt(5)
    v_mfma_f32_16x16x32_bf16 v[120:123], v[64:67], v[232:235], v[120:123]
    s_waitcnt lgkmcnt(4)
    v_mfma_f32_16x16x32_bf16 v[120:123], v[68:71], v[236:239], v[120:123]
    s_waitcnt lgkmcnt(3)
    v_mfma_f32_16x16x32_bf16 v[120:123], v[72:75], v[240:243], v[120:123]
    s_waitcnt lgkmcnt(2)
    v_mfma_f32_16x16x32_bf16 v[120:123], v[76:79], v[244:247], v[120:123]
    s_waitcnt lgkmcnt(1)
    v_mfma_f32_16x16x32_bf16 v[120:123], v[80:83], v[248:251], v[120:123]
    s_waitcnt lgkmcnt(0)
    v_mfma_f32_16x16x32_bf16 v[120:123], v[84:87], v[252:255], v[120:123]
    s_nop 7
    v_cvt_pk_bf16_f32 v132, v120, v121
    v_cvt_pk_bf16_f32 v133, v122, v123
    v_lshlrev_b32 v136, 16, v128
    v_and_b32 v137, 0xffff0000, v128
    v_lshlrev_b32 v138, 16, v129
    v_and_b32 v139, 0xffff0000, v129
    v_lshlrev_b32 v120, 16, v132
    v_and_b32 v121, 0xffff0000, v132
    v_lshlrev_b32 v122, 16, v133
    v_and_b32 v123, 0xffff0000, v133
    v_add_f32 v120, v120, v136
    v_add_f32 v121, v121, v137
    v_add_f32 v122, v122, v138
    v_add_f32 v123, v123, v139
    v_cvt_pk_bf16_f32 v132, v120, v121
    v_cvt_pk_bf16_f32 v133, v122, v123
    buffer_store_dwordx2 v[132:133], v4, s[12:15], s36 offen sc1
    v_mov_b32 v10, 0
    v_mov_b32 v11, 0
    v_dot2c_f32_bf16 v10, v132, v14
    v_dot2c_f32_bf16 v11, v132, v132
    v_dot2c_f32_bf16 v10, v133, v14
    v_dot2c_f32_bf16 v11, v133, v133
    s_nop 2
    v_mov_b32 v12, v10
    v_mov_b32 v13, v11
    s_nop 0
    v_permlane32_swap_b32 v10, v12
    v_permlane32_swap_b32 v11, v13
    v_add_f32 v10, v10, v12
    v_add_f32 v11, v11, v13
    v_mov_b32 v12, v10
    v_mov_b32 v13, v11
    s_nop 0
    v_permlane16_swap_b32 v10, v12
    v_permlane16_swap_b32 v11, v13
    v_add_f32 v10, v10, v12
    v_add_f32 v11, v11, v13
    s_mov_b64 exec, 0xffff
    buffer_store_dwordx2 v[10:11], v1, s[12:15], s41 offen sc1
    s_mov_b64 exec, -1
Lm85_w9:
    v_permlane16_swap_b32 v112, v116
    v_permlane16_swap_b32 v113, v117
    v_permlane16_swap_b32 v114, v118
    v_permlane16_swap_b32 v115, v119
    v_cvt_pk_bf16_f32 v132, v112, v113
    v_cvt_pk_bf16_f32 v133, v114, v115
    v_lshlrev_b32 v136, 16, v124
    v_and_b32 v137, 0xffff0000, v124
    v_lshlrev_b32 v138, 16, v125
    v_and_b32 v139, 0xffff0000, v125
    v_lshlrev_b32 v112, 16, v132
    v_and_b32 v113, 0xffff0000, v132
    v_lshlrev_b32 v114, 16, v133
    v_and_b32 v115, 0xffff0000, v133
    v_add_f32 v112, v112, v136
    v_add_f32 v113, v113, v137
    v_add_f32 v114, v114, v138
    v_add_f32 v115, v115, v139
    v_cvt_pk_bf16_f32 v132, v112, v113
    v_cvt_pk_bf16_f32 v133, v114, v115
    v_cvt_pk_bf16_f32 v134, v116, v117
    v_cvt_pk_bf16_f32 v135, v118, v119
    v_lshlrev_b32 v136, 16, v126
    v_and_b32 v137, 0xffff0000, v126
    v_lshlrev_b32 v138, 16, v127
    v_and_b32 v139, 0xffff0000, v127
    v_lshlrev_b32 v116, 16, v134
    v_and_b32 v117, 0xffff0000, v134
    v_lshlrev_b32 v118, 16, v135
    v_and_b32 v119, 0xffff0000, v135
    v_add_f32 v116, v116, v136
    v_add_f32 v117, v117, v137
    v_add_f32 v118, v118, v138
    v_add_f32 v119, v119, v139
    v_cvt_pk_bf16_f32 v134, v116, v117
    v_cvt_pk_bf16_f32 v135, v118, v119
    buffer_store_dwordx4 v[132:135], v8, s[12:15], s27 offen sc1
    v_mov_b32 v136, 0
    v_mov_b32 v137, 0
    v_dot2c_f32_bf16 v136, v132, v14
    v_dot2c_f32_bf16 v137, v132, v132
    v_dot2c_f32_bf16 v136, v133, v14
    v_dot2c_f32_bf16 v137, v133, v133
    v_dot2c_f32_bf16 v136, v134, v14
    v_dot2c_f32_bf16 v137, v134, v134
    v_dot2c_f32_bf16 v136, v135, v14
    v_dot2c_f32_bf16 v137, v135, v135
    s_nop 2
    v_mov_b32 v138, v136
    v_mov_b32 v139, v137
    s_nop 0
    v_permlane32_swap_b32 v136, v138
    v_permlane32_swap_b32 v137, v139
    v_add_f32 v136, v136, v138
    v_add_f32 v137, v137, v139
    v_mov_b32 v138, v136
    v_mov_b32 v139, v137
    s_nop 0
    v_permlane16_swap_b32 v136, v138
    v_permlane16_swap_b32 v137, v139
    s_mov_b64 exec, 0xffff
    buffer_store_dwordx4 v[136:139], v1, s[12:15], s29 offen sc1
    s_mov_b64 exec, -1
    s_waitcnt vmcnt(0) lgkmcnt(0)
    s_barrier
    s_cmp_lg_u32 s16, 0
    s_cbranch_scc1 Lm86_pub
    v_mov_b32 v13, s79
    v_mov_b32 v14, s80
    s_mov_b64 exec, 1
    buffer_store_dword v14, v13, s[12:15], s37 offen sc1
    s_mov_b64 exec, -1
Lm86_pub:
    v_mbcnt_lo_u32_b32 v0, -1, 0
    v_mbcnt_hi_u32_b32 v0, -1, v0
    v_lshlrev_b32 v1, 4, v0
    v_and_b32 v2, 15, v0
    v_lshrrev_b32 v3, 4, v0
    v_mov_b32 v4, v1
    v_add_u32 v5, 36864, v1
    v_add_u32 v6, 73728, v1
    v_add_u32 v7, 110592, v1
    s_and_b32 s17, s2, 3
    s_lshl_b32 s17, s17, 3
    s_bfe_u32 s18, s2, 0x30003
    s_add_u32 s17, s17, s18
    s_bfe_u32 s18, s2, 0x10002
    s_lshl_b32 s18, s18, 2
    s_lshr_b32 s19, s2, 6
    s_add_u32 s18, s18, s19
    s_lshl_b32 s39, s18, 12
    s_lshl_b32 s40, s17, 7
    s_add_u32 s40, s40, s39
    s_add_u32 s40, s40, 44662784
    s_add_u32 s39, s39, 44630016
    s_lshl_b32 s19, s18, 4
    s_lshl_b32 s20, s16, 1
    s_add_u32 s19, s19, s20
    s_mul_i32 s20, s16, 4608
    s_mul_i32 s35, s17, 331776
    s_add_u32 s35, s35, 3145728
    s_add_u32 s21, s35, s20
    s_mov_b32 s22, -1
    s_mov_b32 s23, 0
    s_mul_i32 s24, s19, 18432
    s_add_u32 s24, s24, 2424832
    s_add_u32 s25, s24, 18432
    s_mul_i32 s28, s17, 1152
    s_add_u32 s28, s28, 20316160
    s_lshl_b32 s29, s16, 6
    v_add_u32 v8, s29, v0
    v_lshlrev_b32 v12, 2, v8
    v_add_u32 v9, s28, v12
    v_cmp_gt_u32 vcc, 288, v8
    v_mov_b32 v8, 2147483392
    s_mov_b32 s29, 0
    v_cndmask_b32 v9, v8, v9, vcc
    s_mul_i32 s30, s19, 147456
    s_add_u32 s30, s30, 14942208
    s_lshr_b32 s31, s17, 2
    s_mul_i32 s31, s31, 18432
    s_add_u32 s30, s30, s31
    s_and_b32 s31, s17, 3
    s_mul_i32 s32, s31, 3072
    s_add_u32 s33, s30, s32
    s_add_u32 s34, s33, 147456
    s_lshl_b32 s32, s31, 10
    s_add_u32 s36, s30, s32
    s_add_u32 s36, s36, 12288
    s_add_u32 s37, s36, 147456
    s_lshl_b32 s31, s31, 9
    s_add_u32 s30, s30, s31
    s_add_u32 s30, s30, 16384
    s_add_u32 s38, s40, 131072
    v_lshlrev_b32 v15, 4, v3
    v_add_u32 v15, 147456, v15
    s_mul_i32 s27, s19, 4608
    s_add_u32 s27, s27, 4849664
    v_and_b32 v10, 1, v3
    v_mul_u32_u24 v10, 147456, v10
    v_lshrrev_b32 v3, 1, v3
    v_lshl_add_u32 v3, v3, 8, v10
    v_lshl_add_u32 v3, v2, 4, v3
    s_lshr_b32 s41, s2, 6
    s_lshl_b32 s41, s41, 2
    s_and_b32 s42, s2, 3
    s_add_u32 s41, s41, s42
    s_mul_i32 s41, s41, 331776
    s_add_u32 s41, s41, 14680064
    s_cmp_eq_u32 s16, 7
    s_cbranch_scc1 Lm87_p
    s_cmp_ge_u32 s16, 5
    s_cbranch_scc1 Lm91_cs5
    buffer_load_dword v208, v9, s[8:11], s29 offen sc1
    s_add_u32 s29, s29, 36864
    buffer_load_dword v209, v9, s[8:11], s29 offen sc1
    s_add_u32 s29, s29, 36864
    buffer_load_dword v210, v9, s[8:11], s29 offen sc1
    s_add_u32 s29, s29, 36864
    buffer_load_dword v211, v9, s[8:11], s29 offen sc1
    s_add_u32 s29, s29, 36864
    buffer_load_dword v212, v9, s[8:11], s29 offen sc1
    s_add_u32 s29, s29, 36864
    buffer_load_dword v213, v9, s[8:11], s29 offen sc1
    s_add_u32 s29, s29, 36864
    buffer_load_dword v214, v9, s[8:11], s29 offen sc1
    s_add_u32 s29, s29, 36864
    buffer_load_dword v215, v9, s[8:11], s29 offen sc1
    s_add_u32 s29, s29, 36864
    buffer_load_dword v216, v9, s[8:11], s29 offen sc1
    s_add_u32 s29, s29, 36864
    buffer_load_dword v217, v9, s[8:11], s29 offen sc1
    s_add_u32 s29, s29, 36864
    buffer_load_dword v218, v9, s[8:11], s29 offen sc1
    s_add_u32 s29, s29, 36864
    buffer_load_dword v219, v9, s[8:11], s29 offen sc1
    s_add_u32 s29, s29, 36864
    buffer_load_dword v220, v9, s[8:11], s29 offen sc1
    s_add_u32 s29, s29, 36864
    buffer_load_dword v221, v9, s[8:11], s29 offen sc1
    s_add_u32 s29, s29, 36864
    buffer_load_dword v222, v9, s[8:11], s29 offen sc1
    s_add_u32 s29, s29, 36864
    buffer_load_dword v223, v9, s[8:11], s29 offen sc1
    s_add_u32 s29, s29, 36864
    buffer_load_dword v224, v9, s[8:11], s29 offen sc1
    s_add_u32 s29, s29, 36864
    buffer_load_dword v225, v9, s[8:11], s29 offen sc1
    s_add_u32 s29, s29, 36864
Lm91_cs5:
    s_cmp_ge_u32 s16, 4
    s_cbranch_scc1 Lm92_sp
    s_lshl_b32 s47, s16, 10
    s_add_u32 m0, s47, 94208
    s_add_u32 s26, s35, m0
    buffer_load_dwordx4 v1, s[8:11], s26 offen sc1 lds
Lm92_sp:
    s_lshl_b32 s47, s16, 10
    s_add_u32 m0, s47, 12288
    s_add_u32 s26, s35, m0
    buffer_load_dwordx4 v1, s[8:11], s26 offen sc1 lds
    s_lshl_b32 s47, s16, 10
    s_cmp_ge_u32 s16, 4
    s_cselect_b32 s26, 24576, 0
    s_add_u32 s47, s47, s26
    s_add_u32 m0, s47, 20480
    s_add_u32 s26, s35, m0
    buffer_load_dwordx4 v1, s[8:11], s26 offen sc1 lds
    s_lshl_b32 s47, s16, 10
    s_add_u32 m0, s47, 53248
    s_add_u32 s26, s35, m0
    buffer_load_dwordx4 v1, s[8:11], s26 offen sc1 lds
    s_lshl_b32 s47, s16, 10
    s_add_u32 m0, s47, 86016
    s_add_u32 s26, s35, m0
    buffer_load_dwordx4 v1, s[8:11], s26 offen sc1 lds
    s_barrier
    s_branch Lm88_j
Lm87_p:
    v_lshl_add_u32 v13, v0, 7, s79
    s_mov_b32 s3, 0x40000
    s_mov_b32 exec_lo, 4294967295
    s_mov_b32 exec_hi, 0
Lm89_l:
    buffer_load_dword v14, v13, s[12:15], s39 offen sc1
    s_waitcnt vmcnt(0)
    v_cmp_ne_u32 vcc, s80, v14
    s_sub_u32 s3, s3, 1
    s_cbranch_scc1 Lm90_d
    s_nop 2
    s_cbranch_vccz Lm90_d
    s_sleep 4
    s_branch Lm89_l
Lm90_d:
    s_mov_b64 exec, -1
    s_barrier
    s_cmp_ge_u32 s16, 5
    s_cbranch_scc1 Lm97_cs5
    buffer_load_dword v208, v9, s[8:11], s29 offen sc1
    s_add_u32 s29, s29, 36864
    buffer_load_dword v209, v9, s[8:11], s29 offen sc1
    s_add_u32 s29, s29, 36864
    buffer_load_dword v210, v9, s[8:11], s29 offen sc1
    s_add_u32 s29, s29, 36864
    buffer_load_dword v211, v9, s[8:11], s29 offen sc1
    s_add_u32 s29, s29, 36864
    buffer_load_dword v212, v9, s[8:11], s29 offen sc1
    s_add_u32 s29, s29, 36864
    buffer_load_dword v213, v9, s[8:11], s29 offen sc1
    s_add_u32 s29, s29, 36864
    buffer_load_dword v214, v9, s[8:11], s29 offen sc1
    s_add_u32 s29, s29, 36864
    buffer_load_dword v215, v9, s[8:11], s29 offen sc1
    s_add_u32 s29, s29, 36864
    buffer_load_dword v216, v9, s[8:11], s29 offen sc1
    s_add_u32 s29, s29, 36864
    buffer_load_dword v217, v9, s[8:11], s29 offen sc1
    s_add_u32 s29, s29, 36864
    buffer_load_dword v218, v9, s[8:11], s29 offen sc1
    s_add_u32 s29, s29, 36864
    buffer_load_dword v219, v9, s[8:11], s29 offen sc1
    s_add_u32 s29, s29, 36864
    buffer_load_dword v220, v9, s[8:11], s29 offen sc1
    s_add_u32 s29, s29, 36864
    buffer_load_dword v221, v9, s[8:11], s29 offen sc1
    s_add_u32 s29, s29, 36864
    buffer_load_dword v222, v9, s[8:11], s29 offen sc1
    s_add_u32 s29, s29, 36864
    buffer_load_dword v223, v9, s[8:11], s29 offen sc1
    s_add_u32 s29, s29, 36864
    buffer_load_dword v224, v9, s[8:11], s29 offen sc1
    s_add_u32 s29, s29, 36864
    buffer_load_dword v225, v9, s[8:11], s29 offen sc1
    s_add_u32 s29, s29, 36864
Lm97_cs5:
    s_cmp_ge_u32 s16, 4
    s_cbranch_scc1 Lm98_sp
    s_lshl_b32 s47, s16, 10
    s_add_u32 m0, s47, 94208
    s_add_u32 s26, s35, m0
    buffer_load_dwordx4 v1, s[8:11], s26 offen sc1 lds
Lm98_sp:
    s_lshl_b32 s47, s16, 10
    s_add_u32 m0, s47, 12288
    s_add_u32 s26, s35, m0
    buffer_load_dwordx4 v1, s[8:11], s26 offen sc1 lds
    s_lshl_b32 s47, s16, 10
    s_cmp_ge_u32 s16, 4
    s_cselect_b32 s26, 24576, 0
    s_add_u32 s47, s47, s26
    s_add_u32 m0, s47, 20480
    s_add_u32 s26, s35, m0
    buffer_load_dwordx4 v1, s[8:11], s26 offen sc1 lds
    s_lshl_b32 s47, s16, 10
    s_add_u32 m0, s47, 53248
    s_add_u32 s26, s35, m0
    buffer_load_dwordx4 v1, s[8:11], s26 offen sc1 lds
    s_lshl_b32 s47, s16, 10
    s_add_u32 m0, s47, 86016
    s_add_u32 s26, s35, m0
    buffer_load_dwordx4 v1, s[8:11], s26 offen sc1 lds
Lm88_j:
    v_add_u32 v14, 147456, v12
    buffer_load_dwordx4 v[16:19], v1, s[12:15], s24 offen offset:0 sc1
    buffer_load_dwordx4 v[88:91], v1, s[12:15], s25 offen offset:0 sc1
    buffer_load_dwordx4 v[20:23], v1, s[12:15], s24 offen offset:1024 sc1
    buffer_load_dwordx4 v[92:95], v1, s[12:15], s25 offen offset:1024 sc1
    buffer_load_dwordx4 v[24:27], v1, s[12:15], s24 offen offset:2048 sc1
    buffer_load_dwordx4 v[96:99], v1, s[12:15], s25 offen offset:2048 sc1
    ds_read_b128 v[240:243], v4 offset:0
    ds_read_b128 v[244:247], v4 offset:1024
    ds_read_b128 v[248:251], v5 offset:0
    ds_read_b128 v[252:255], v5 offset:1024
    s_waitcnt vmcnt(4) lgkmcnt(3)
    v_mfma_f32_16x16x32_bf16 v[160:163], v[240:243], v[16:19], 0
    v_mfma_f32_16x16x32_bf16 v[168:171], v[240:243], v[88:91], 0
    buffer_load_dwordx4 v[28:31], v1, s[12:15], s24 offen offset:3072 sc1
    ds_read_b128 v[240:243], v6 offset:0
    s_waitcnt lgkmcnt(3)
    v_mfma_f32_16x16x32_bf16 v[164:167], v[244:247], v[16:19], 0
    v_mfma_f32_16x16x32_bf16 v[172:175], v[244:247], v[88:91], 0
    ds_read_b128 v[244:247], v6 offset:1024
    s_waitcnt lgkmcnt(3)
    v_mfma_f32_16x16x32_bf16 v[176:179], v[248:251], v[16:19], 0
    v_mfma_f32_16x16x32_bf16 v[184:187], v[248:251], v[88:91], 0
    buffer_load_dwordx4 v[100:103], v1, s[12:15], s25 offen offset:3072 sc1
    ds_read_b128 v[248:251], v4 offset:2048
    s_waitcnt lgkmcnt(3)
    v_mfma_f32_16x16x32_bf16 v[180:183], v[252:255], v[16:19], 0
    v_mfma_f32_16x16x32_bf16 v[188:191], v[252:255], v[88:91], 0
    ds_read_b128 v[252:255], v4 offset:3072
    s_waitcnt lgkmcnt(3)
    v_mfma_f32_16x16x32_bf16 v[192:195], v[240:243], v[16:19], 0
    v_mfma_f32_16x16x32_bf16 v[200:203], v[240:243], v[88:91], 0
    s_cmp_ge_u32 s16, 4
    s_cbranch_scc1 Lm103_sp
    s_lshl_b32 s47, s16, 10
    s_add_u32 m0, s47, 106496
    s_add_u32 s26, s35, m0
    buffer_load_dwordx4 v1, s[8:11], s26 offen sc1 lds
Lm103_sp:
    ds_read_b128 v[240:243], v5 offset:2048
    s_waitcnt lgkmcnt(3)
    v_mfma_f32_16x16x32_bf16 v[196:199], v[244:247], v[16:19], 0
    v_mfma_f32_16x16x32_bf16 v[204:207], v[244:247], v[88:91], 0
    ds_read_b128 v[244:247], v5 offset:3072
    s_waitcnt vmcnt(4) lgkmcnt(3)
    v_mfma_f32_16x16x32_bf16 v[160:163], v[248:251], v[20:23], v[160:163]
    v_mfma_f32_16x16x32_bf16 v[168:171], v[248:251], v[92:95], v[168:171]
    s_add_u32 s24, s24, 4096
    buffer_load_dwordx4 v[32:35], v1, s[12:15], s24 offen offset:0 sc1
    ds_read_b128 v[248:251], v6 offset:2048
    s_waitcnt lgkmcnt(3)
    v_mfma_f32_16x16x32_bf16 v[164:167], v[252:255], v[20:23], v[164:167]
    v_mfma_f32_16x16x32_bf16 v[172:175], v[252:255], v[92:95], v[172:175]
    ds_read_b128 v[252:255], v6 offset:3072
    s_waitcnt lgkmcnt(3)
    v_mfma_f32_16x16x32_bf16 v[176:179], v[240:243], v[20:23], v[176:179]
    v_mfma_f32_16x16x32_bf16 v[184:187], v[240:243], v[92:95], v[184:187]
    s_add_u32 s25, s25, 4096
    buffer_load_dwordx4 v[104:107], v1, s[12:15], s25 offen offset:0 sc1
    v_add_f32 v208, v208, v209
    v_add_f32 v208, v208, v210
    v_add_f32 v208, v208, v211
    v_add_f32 v208, v208, v212
    v_add_f32 v208, v208, v213
    v_add_f32 v208, v208, v214
    v_add_f32 v208, v208, v215
    v_add_f32 v208, v208, v216
    v_add_f32 v208, v208, v217
    v_add_f32 v208, v208, v218
    v_add_f32 v208, v208, v219
    v_add_f32 v208, v208, v220
    v_add_f32 v208, v208, v221
    v_add_f32 v208, v208, v222
    v_add_f32 v208, v208, v223
    v_add_f32 v208, v208, v224
    v_add_f32 v208, v208, v225
    ds_write_b32 v14, v208
    ds_read_b128 v[240:243], v4 offset:4096
    s_waitcnt lgkmcnt(4)
    v_mfma_f32_16x16x32_bf16 v[180:183], v[244:247], v[20:23], v[180:183]
    v_mfma_f32_16x16x32_bf16 v[188:191], v[244:247], v[92:95], v[188:191]
    ds_read_b128 v[244:247], v4 offset:5120
    s_waitcnt lgkmcnt(4)
    v_mfma_f32_16x16x32_bf16 v[192:195], v[248:251], v[20:23], v[192:195]
    v_mfma_f32_16x16x32_bf16 v[200:203], v[248:251], v[92:95], v[200:203]
    s_lshl_b32 s47, s16, 10
    s_add_u32 m0, s47, 24576
    s_add_u32 s26, s35, m0
    buffer_load_dwordx4 v1, s[8:11], s26 offen sc1 lds
    ds_read_b128 v[248:251], v5 offset:4096
    s_waitcnt lgkmcnt(4)
    v_mfma_f32_16x16x32_bf16 v[196:199], v[252:255], v[20:23], v[196:199]
    v_mfma_f32_16x16x32_bf16 v[204:207], v[252:255], v[92:95], v[204:207]
    ds_read_b128 v[252:255], v5 offset:5120
    s_waitcnt vmcnt(5) lgkmcnt(3)
    v_mfma_f32_16x16x32_bf16 v[160:163], v[240:243], v[24:27], v[160:163]
    v_mfma_f32_16x16x32_bf16 v[168:171], v[240:243], v[96:99], v[168:171]
    buffer_load_dwordx4 v[36:39], v1, s[12:15], s24 offen offset:1024 sc1
    ds_read_b128 v[240:243], v6 offset:4096
    s_waitcnt lgkmcnt(3)
    v_mfma_f32_16x16x32_bf16 v[164:167], v[244:247], v[24:27], v[164:167]
    v_mfma_f32_16x16x32_bf16 v[172:175], v[244:247], v[96:99], v[172:175]
    ds_read_b128 v[244:247], v6 offset:5120
    s_waitcnt lgkmcnt(3)
    v_mfma_f32_16x16x32_bf16 v[176:179], v[248:251], v[24:27], v[176:179]
    v_mfma_f32_16x16x32_bf16 v[184:187], v[248:251], v[96:99], v[184:187]
    buffer_load_dwordx4 v[108:111], v1, s[12:15], s25 offen offset:1024 sc1
    ds_read_b128 v[248:251], v4 offset:6144
    s_waitcnt lgkmcnt(3)
    v_mfma_f32_16x16x32_bf16 v[180:183], v[252:255], v[24:27], v[180:183]
    v_mfma_f32_16x16x32_bf16 v[188:191], v[252:255], v[96:99], v[188:191]
    ds_read_b128 v[252:255], v4 offset:7168
    s_waitcnt lgkmcnt(3)
    v_mfma_f32_16x16x32_bf16 v[192:195], v[240:243], v[24:27], v[192:195]
    v_mfma_f32_16x16x32_bf16 v[200:203], v[240:243], v[96:99], v[200:203]
    s_lshl_b32 s47, s16, 10
    s_cmp_ge_u32 s16, 4
    s_cselect_b32 s26, 24576, 0
    s_add_u32 s47, s47, s26
    s_add_u32 m0, s47, 32768
    s_add_u32 s26, s35, m0
    buffer_load_dwordx4 v1, s[8:11], s26 offen sc1 lds
    ds_read_b128 v[240:243], v5 offset:6144
    s_waitcnt lgkmcnt(3)
    v_mfma_f32_16x16x32_bf16 v[196:199], v[244:247], v[24:27], v[196:199]
    v_mfma_f32_16x16x32_bf16 v[204:207], v[244:247], v[96:99], v[204:207]
    ds_read_b128 v[244:247], v5 offset:7168
    s_waitcnt vmcnt(6) lgkmcnt(3)
    v_mfma_f32_16x16x32_bf16 v[160:163], v[248:251], v[28:31], v[160:163]
    v_mfma_f32_16x16x32_bf16 v[168:171], v[248:251], v[100:103], v[168:171]
    buffer_load_dwordx4 v[40:43], v1, s[12:15], s24 offen offset:2048 sc1
    ds_read_b128 v[248:251], v6 offset:6144
    s_waitcnt lgkmcnt(3)
    v_mfma_f32_16x16x32_bf16 v[164:167], v[252:255], v[28:31], v[164:167]
    v_mfma_f32_16x16x32_bf16 v[172:175], v[252:255], v[100:103], v[172:175]
    ds_read_b128 v[252:255], v6 offset:7168
    s_waitcnt lgkmcnt(3)
    v_mfma_f32_16x16x32_bf16 v[176:179], v[240:243], v[28:31], v[176:179]
    v_mfma_f32_16x16x32_bf16 v[184:187], v[240:243], v[100:103], v[184:187]
    buffer_load_dwordx4 v[112:115], v1, s[12:15], s25 offen offset:2048 sc1
    ds_read_b128 v[240:243], v4 offset:8192
    s_waitcnt lgkmcnt(3)
    v_mfma_f32_16x16x32_bf16 v[180:183], v[244:247], v[28:31], v[180:183]
    v_mfma_f32_16x16x32_bf16 v[188:191], v[244:247], v[100:103], v[188:191]
    ds_read_b128 v[244:247], v4 offset:9216
    s_waitcnt lgkmcnt(3)
    v_mfma_f32_16x16x32_bf16 v[192:195], v[248:251], v[28:31], v[192:195]
    v_mfma_f32_16x16x32_bf16 v[200:203], v[248:251], v[100:103], v[200:203]
    s_lshl_b32 s47, s16, 10
    s_add_u32 m0, s47, 65536
    s_add_u32 s26, s35, m0
    buffer_load_dwordx4 v1, s[8:11], s26 offen sc1 lds
    ds_read_b128 v[248:251], v5 offset:8192
    s_waitcnt lgkmcnt(3)
    v_mfma_f32_16x16x32_bf16 v[196:199], v[252:255], v[28:31], v[196:199]
    v_mfma_f32_16x16x32_bf16 v[204:207], v[252:255], v[100:103], v[204:207]
    ds_read_b128 v[252:255], v5 offset:9216
    s_waitcnt vmcnt(7) lgkmcnt(3)
    v_mfma_f32_16x16x32_bf16 v[160:163], v[240:243], v[32:35], v[160:163]
    v_mfma_f32_16x16x32_bf16 v[168:171], v[240:243], v[104:107], v[168:171]
    buffer_load_dwordx4 v[44:47], v1, s[12:15], s24 offen offset:3072 sc1
    ds_read_b128 v[240:243], v6 offset:8192
    s_waitcnt lgkmcnt(3)
    v_mfma_f32_16x16x32_bf16 v[164:167], v[244:247], v[32:35], v[164:167]
    v_mfma_f32_16x16x32_bf16 v[172:175], v[244:247], v[104:107], v[172:175]
    ds_read_b128 v[244:247], v6 offset:9216
    s_waitcnt lgkmcnt(3)
    v_mfma_f32_16x16x32_bf16 v[176:179], v[248:251], v[32:35], v[176:179]
    v_mfma_f32_16x16x32_bf16 v[184:187], v[248:251], v[104:107], v[184:187]
    buffer_load_dwordx4 v[116:119], v1, s[12:15], s25 offen offset:3072 sc1
    ds_read_b128 v[248:251], v4 offset:10240
    s_waitcnt lgkmcnt(3)
    v_mfma_f32_16x16x32_bf16 v[180:183], v[252:255], v[32:35], v[180:183]
    v_mfma_f32_16x16x32_bf16 v[188:191], v[252:255], v[104:107], v[188:191]
    ds_read_b128 v[252:255], v4 offset:11264
    s_waitcnt lgkmcnt(3)
    v_mfma_f32_16x16x32_bf16 v[192:195], v[240:243], v[32:35], v[192:195]
    v_mfma_f32_16x16x32_bf16 v[200:203], v[240:243], v[104:107], v[200:203]
    s_lshl_b32 s47, s16, 10
    s_add_u32 m0, s47, 98304
    s_add_u32 s26, s35, m0
    buffer_load_dwordx4 v1, s[8:11], s26 offen sc1 lds
    ds_read_b128 v[240:243], v5 offset:10240
    s_waitcnt lgkmcnt(3)
    v_mfma_f32_16x16x32_bf16 v[196:199], v[244:247], v[32:35], v[196:199]
    v_mfma_f32_16x16x32_bf16 v[204:207], v[244:247], v[104:107], v[204:207]
    ds_read_b128 v[244:247], v5 offset:11264
    s_waitcnt vmcnt(7) lgkmcnt(3)
    v_mfma_f32_16x16x32_bf16 v[160:163], v[248:251], v[36:39], v[160:163]
    v_mfma_f32_16x16x32_bf16 v[168:171], v[248:251], v[108:111], v[168:171]
    s_add_u32 s24, s24, 4096
    buffer_load_dwordx4 v[48:51], v1, s[12:15], s24 offen offset:0 sc1
    ds_read_b128 v[248:251], v6 offset:10240
    s_waitcnt lgkmcnt(3)
    v_mfma_f32_16x16x32_bf16 v[164:167], v[252:255], v[36:39], v[164:167]
    v_mfma_f32_16x16x32_bf16 v[172:175], v[252:255], v[108:111], v[172:175]
    ds_read_b128 v[252:255], v6 offset:11264
    s_waitcnt lgkmcnt(3)
    v_mfma_f32_16x16x32_bf16 v[176:179], v[240:243], v[36:39], v[176:179]
    v_mfma_f32_16x16x32_bf16 v[184:187], v[240:243], v[108:111], v[184:187]
    s_add_u32 s25, s25, 4096
    buffer_load_dwordx4 v[120:123], v1, s[12:15], s25 offen offset:0 sc1
    s_barrier
    ds_read_b128 v[240:243], v4 offset:12288
    s_waitcnt lgkmcnt(3)
    v_mfma_f32_16x16x32_bf16 v[180:183], v[244:247], v[36:39], v[180:183]
    v_mfma_f32_16x16x32_bf16 v[188:191], v[244:247], v[108:111], v[188:191]
    ds_read_b128 v[244:247], v4 offset:13312
    s_waitcnt lgkmcnt(3)
    v_mfma_f32_16x16x32_bf16 v[192:195], v[248:251], v[36:39], v[192:195]
    v_mfma_f32_16x16x32_bf16 v[200:203], v[248:251], v[108:111], v[200:203]
    s_add_u32 m0, s20, 110592
    s_add_u32 s26, s21, 110592
    buffer_load_dwordx4 v1, s[8:11], s26 offen offset:0 sc1 lds
    ds_read_b128 v[248:251], v5 offset:12288
    s_waitcnt lgkmcnt(3)
    v_mfma_f32_16x16x32_bf16 v[196:199], v[252:255], v[36:39], v[196:199]
    v_mfma_f32_16x16x32_bf16 v[204:207], v[252:255], v[108:111], v[204:207]
    ds_read_b128 v[252:255], v5 offset:13312
    s_waitcnt vmcnt(7) lgkmcnt(3)
    v_mfma_f32_16x16x32_bf16 v[160:163], v[240:243], v[40:43], v[160:163]
    v_mfma_f32_16x16x32_bf16 v[168:171], v[240:243], v[112:115], v[168:171]
    buffer_load_dwordx4 v[52:55], v1, s[12:15], s24 offen offset:1024 sc1
    ds_read_b128 v[240:243], v6 offset:12288
    s_waitcnt lgkmcnt(3)
    v_mfma_f32_16x16x32_bf16 v[164:167], v[244:247], v[40:43], v[164:167]
    v_mfma_f32_16x16x32_bf16 v[172:175], v[244:247], v[112:115], v[172:175]
    ds_read_b128 v[244:247], v6 offset:13312
    s_waitcnt lgkmcnt(3)
    v_mfma_f32_16x16x32_bf16 v[176:179], v[248:251], v[40:43], v[176:179]
    v_mfma_f32_16x16x32_bf16 v[184:187], v[248:251], v[112:115], v[184:187]
    buffer_load_dwordx4 v[124:127], v1, s[12:15], s25 offen offset:1024 sc1
    ds_read_b128 v[248:251], v4 offset:14336
    s_waitcnt lgkmcnt(3)
    v_mfma_f32_16x16x32_bf16 v[180:183], v[252:255], v[40:43], v[180:183]
    v_mfma_f32_16x16x32_bf16 v[188:191], v[252:255], v[112:115], v[188:191]
    ds_read_b128 v[252:255], v4 offset:15360
    s_waitcnt lgkmcnt(3)
    v_mfma_f32_16x16x32_bf16 v[192:195], v[240:243], v[40:43], v[192:195]
    v_mfma_f32_16x16x32_bf16 v[200:203], v[240:243], v[112:115], v[200:203]
    buffer_load_dwordx4 v1, s[8:11], s26 offen offset:1024 sc1 lds
    ds_read_b128 v[240:243], v5 offset:14336
    s_waitcnt lgkmcnt(3)
    v_mfma_f32_16x16x32_bf16 v[196:199], v[244:247], v[40:43], v[196:199]
    v_mfma_f32_16x16x32_bf16 v[204:207], v[244:247], v[112:115], v[204:207]
    ds_read_b128 v[244:247], v5 offset:15360
    s_waitcnt vmcnt(7) lgkmcnt(3)
    v_mfma_f32_16x16x32_bf16 v[160:163], v[248:251], v[44:47], v[160:163]
    v_mfma_f32_16x16x32_bf16 v[168:171], v[248:251], v[116:119], v[168:171]
    buffer_load_dwordx4 v[56:59], v1, s[12:15], s24 offen offset:2048 sc1
    ds_read_b128 v[248:251], v6 offset:14336
    s_waitcnt lgkmcnt(3)
    v_mfma_f32_16x16x32_bf16 v[164:167], v[252:255], v[44:47], v[164:167]
    v_mfma_f32_16x16x32_bf16 v[172:175], v[252:255], v[116:119], v[172:175]
    ds_read_b128 v[252:255], v6 offset:15360
    s_waitcnt lgkmcnt(3)
    v_mfma_f32_16x16x32_bf16 v[176:179], v[240:243], v[44:47], v[176:179]
    v_mfma_f32_16x16x32_bf16 v[184:187], v[240:243], v[116:119], v[184:187]
    buffer_load_dwordx4 v[128:131], v1, s[12:15], s25 offen offset:2048 sc1
    ds_read_b128 v[240:243], v4 offset:16384
    s_waitcnt lgkmcnt(3)
    v_mfma_f32_16x16x32_bf16 v[180:183], v[244:247], v[44:47], v[180:183]
    v_mfma_f32_16x16x32_bf16 v[188:191], v[244:247], v[116:119], v[188:191]
    ds_read_b128 v[244:247], v4 offset:17408
    s_waitcnt lgkmcnt(3)
    v_mfma_f32_16x16x32_bf16 v[192:195], v[248:251], v[44:47], v[192:195]
    v_mfma_f32_16x16x32_bf16 v[200:203], v[248:251], v[116:119], v[200:203]
    buffer_load_dwordx4 v1, s[8:11], s26 offen offset:2048 sc1 lds
    ds_read_b128 v[248:251], v5 offset:16384
    s_waitcnt lgkmcnt(3)
    v_mfma_f32_16x16x32_bf16 v[196:199], v[252:255], v[44:47], v[196:199]
    v_mfma_f32_16x16x32_bf16 v[204:207], v[252:255], v[116:119], v[204:207]
    ds_read_b128 v[252:255], v5 offset:17408
    s_waitcnt vmcnt(7) lgkmcnt(3)
    v_mfma_f32_16x16x32_bf16 v[160:163], v[240:243], v[48:51], v[160:163]
    v_mfma_f32_16x16x32_bf16 v[168:171], v[240:243], v[120:123], v[168:171]
    buffer_load_dwordx4 v[60:63], v1, s[12:15], s24 offen offset:3072 sc1
    ds_read_b128 v[240:243], v6 offset:16384
    s_waitcnt lgkmcnt(3)
    v_mfma_f32_16x16x32_bf16 v[164:167], v[244:247], v[48:51], v[164:167]
    v_mfma_f32_16x16x32_bf16 v[172:175], v[244:247], v[120:123], v[172:175]
    ds_read_b128 v[244:247], v6 offset:17408
    s_waitcnt lgkmcnt(3)
    v_mfma_f32_16x16x32_bf16 v[176:179], v[248:251], v[48:51], v[176:179]
    v_mfma_f32_16x16x32_bf16 v[184:187], v[248:251], v[120:123], v[184:187]
    buffer_load_dwordx4 v[132:135], v1, s[12:15], s25 offen offset:3072 sc1
    ds_read_b128 v[248:251], v4 offset:18432
    s_waitcnt lgkmcnt(3)
    v_mfma_f32_16x16x32_bf16 v[180:183], v[252:255], v[48:51], v[180:183]
    v_mfma_f32_16x16x32_bf16 v[188:191], v[252:255], v[120:123], v[188:191]
    ds_read_b128 v[252:255], v4 offset:19456
    s_waitcnt lgkmcnt(3)
    v_mfma_f32_16x16x32_bf16 v[192:195], v[240:243], v[48:51], v[192:195]
    v_mfma_f32_16x16x32_bf16 v[200:203], v[240:243], v[120:123], v[200:203]
    buffer_load_dwordx4 v1, s[8:11], s26 offen offset:3072 sc1 lds
    ds_read_b128 v[240:243], v5 offset:18432
    s_waitcnt lgkmcnt(3)
    v_mfma_f32_16x16x32_bf16 v[196:199], v[244:247], v[48:51], v[196:199]
    v_mfma_f32_16x16x32_bf16 v[204:207], v[244:247], v[120:123], v[204:207]
    ds_read_b128 v[244:247], v5 offset:19456
    s_waitcnt vmcnt(7) lgkmcnt(3)
    v_mfma_f32_16x16x32_bf16 v[160:163], v[248:251], v[52:55], v[160:163]
    v_mfma_f32_16x16x32_bf16 v[168:171], v[248:251], v[124:127], v[168:171]
    s_add_u32 s24, s24, 4096
    buffer_load_dwordx4 v[64:67], v1, s[12:15], s24 offen offset:0 sc1
    ds_read_b128 v[248:251], v6 offset:18432
    s_waitcnt lgkmcnt(3)
    v_mfma_f32_16x16x32_bf16 v[164:167], v[252:255], v[52:55], v[164:167]
    v_mfma_f32_16x16x32_bf16 v[172:175], v[252:255], v[124:127], v[172:175]
    ds_read_b128 v[252:255], v6 offset:19456
    s_waitcnt lgkmcnt(3)
    v_mfma_f32_16x16x32_bf16 v[176:179], v[240:243], v[52:55], v[176:179]
    v_mfma_f32_16x16x32_bf16 v[184:187], v[240:243], v[124:127], v[184:187]
    s_add_u32 s25, s25, 4096
    buffer_load_dwordx4 v[136:139], v1, s[12:15], s25 offen offset:0 sc1
    ds_read_b128 v[240:243], v4 offset:20480
    s_waitcnt lgkmcnt(3)
    v_mfma_f32_16x16x32_bf16 v[180:183], v[244:247], v[52:55], v[180:183]
    v_mfma_f32_16x16x32_bf16 v[188:191], v[244:247], v[124:127], v[188:191]
    ds_read_b128 v[244:247], v4 offset:21504
    s_waitcnt lgkmcnt(3)
    v_mfma_f32_16x16x32_bf16 v[192:195], v[248:251], v[52:55], v[192:195]
    v_mfma_f32_16x16x32_bf16 v[200:203], v[248:251], v[124:127], v[200:203]
    s_add_u32 m0, m0, 4096
    s_add_u32 s26, s26, 4096
    s_mov_b64 exec, s[22:23]
    buffer_load_dwordx4 v1, s[8:11], s26 offen sc1 lds
    s_mov_b64 exec, -1
    ds_read_b128 v[248:251], v5 offset:20480
    s_waitcnt lgkmcnt(3)
    v_mfma_f32_16x16x32_bf16 v[196:199], v[252:255], v[52:55], v[196:199]
    v_mfma_f32_16x16x32_bf16 v[204:207], v[252:255], v[124:127], v[204:207]
    ds_read_b128 v[252:255], v5 offset:21504
    s_waitcnt vmcnt(7) lgkmcnt(3)
    v_mfma_f32_16x16x32_bf16 v[160:163], v[240:243], v[56:59], v[160:163]
    v_mfma_f32_16x16x32_bf16 v[168:171], v[240:243], v[128:131], v[168:171]
    buffer_load_dwordx4 v[68:71], v1, s[12:15], s24 offen offset:1024 sc1
    ds_read_b128 v[240:243], v6 offset:20480
    s_waitcnt lgkmcnt(3)
    v_mfma_f32_16x16x32_bf16 v[164:167], v[244:247], v[56:59], v[164:167]
    v_mfma_f32_16x16x32_bf16 v[172:175], v[244:247], v[128:131], v[172:175]
    ds_read_b128 v[244:247], v6 offset:21504
    s_waitcnt lgkmcnt(3)
    v_mfma_f32_16x16x32_bf16 v[176:179], v[248:251], v[56:59], v[176:179]
    v_mfma_f32_16x16x32_bf16 v[184:187], v[248:251], v[128:131], v[184:187]
    buffer_load_dwordx4 v[140:143], v1, s[12:15], s25 offen offset:1024 sc1
    ds_read_b128 v[248:251], v4 offset:22528
    s_waitcnt lgkmcnt(3)
    v_mfma_f32_16x16x32_bf16 v[180:183], v[252:255], v[56:59], v[180:183]
    v_mfma_f32_16x16x32_bf16 v[188:191], v[252:255], v[128:131], v[188:191]
    ds_read_b128 v[252:255], v4 offset:23552
    s_waitcnt lgkmcnt(3)
    v_mfma_f32_16x16x32_bf16 v[192:195], v[240:243], v[56:59], v[192:195]
    v_mfma_f32_16x16x32_bf16 v[200:203], v[240:243], v[128:131], v[200:203]
    buffer_load_dwordx4 v[208:211], v1, s[12:15], s27 offen offset:0 sc1
    ds_read_b128 v[240:243], v5 offset:22528
    s_waitcnt lgkmcnt(3)
    v_mfma_f32_16x16x32_bf16 v[196:199], v[244:247], v[56:59], v[196:199]
    v_mfma_f32_16x16x32_bf16 v[204:207], v[244:247], v[128:131], v[204:207]
    ds_read_b128 v[244:247], v5 offset:23552
    s_waitcnt vmcnt(7) lgkmcnt(3)
    v_mfma_f32_16x16x32_bf16 v[160:163], v[248:251], v[60:63], v[160:163]
    v_mfma_f32_16x16x32_bf16 v[168:171], v[248:251], v[132:135], v[168:171]
    buffer_load_dwordx4 v[72:75], v1, s[12:15], s24 offen offset:2048 sc1
    ds_read_b128 v[248:251], v6 offset:22528
    s_waitcnt lgkmcnt(3)
    v_mfma_f32_16x16x32_bf16 v[164:167], v[252:255], v[60:63], v[164:167]
    v_mfma_f32_16x16x32_bf16 v[172:175], v[252:255], v[132:135], v[172:175]
    ds_read_b128 v[252:255], v6 offset:23552
    s_waitcnt lgkmcnt(3)
    v_mfma_f32_16x16x32_bf16 v[176:179], v[240:243], v[60:63], v[176:179]
    v_mfma_f32_16x16x32_bf16 v[184:187], v[240:243], v[132:135], v[184:187]
    buffer_load_dwordx4 v[144:147], v1, s[12:15], s25 offen offset:2048 sc1
    s_barrier
    ds_read_b128 v[240:243], v4 offset:24576
    s_waitcnt lgkmcnt(3)
    v_mfma_f32_16x16x32_bf16 v[180:183], v[244:247], v[60:63], v[180:183]
    v_mfma_f32_16x16x32_bf16 v[188:191], v[244:247], v[132:135], v[188:191]
    ds_read_b128 v[244:247], v4 offset:25600
    s_waitcnt lgkmcnt(3)
    v_mfma_f32_16x16x32_bf16 v[192:195], v[248:251], v[60:63], v[192:195]
    v_mfma_f32_16x16x32_bf16 v[200:203], v[248:251], v[132:135], v[200:203]
    buffer_load_dwordx4 v[212:215], v1, s[12:15], s27 offen offset:1024 sc1
    ds_read_b128 v[248:251], v5 offset:24576
    s_waitcnt lgkmcnt(3)
    v_mfma_f32_16x16x32_bf16 v[196:199], v[252:255], v[60:63], v[196:199]
    v_mfma_f32_16x16x32_bf16 v[204:207], v[252:255], v[132:135], v[204:207]
    ds_read_b128 v[252:255], v5 offset:25600
    s_waitcnt vmcnt(7) lgkmcnt(3)
    v_mfma_f32_16x16x32_bf16 v[160:163], v[240:243], v[64:67], v[160:163]
    v_mfma_f32_16x16x32_bf16 v[168:171], v[240:243], v[136:139], v[168:171]
    buffer_load_dwordx4 v[76:79], v1, s[12:15], s24 offen offset:3072 sc1
    ds_read_b128 v[240:243], v6 offset:24576
    s_waitcnt lgkmcnt(3)
    v_mfma_f32_16x16x32_bf16 v[164:167], v[244:247], v[64:67], v[164:167]
    v_mfma_f32_16x16x32_bf16 v[172:175], v[244:247], v[136:139], v[172:175]
    ds_read_b128 v[244:247], v6 offset:25600
    s_waitcnt lgkmcnt(3)
    v_mfma_f32_16x16x32_bf16 v[176:179], v[248:251], v[64:67], v[176:179]
    v_mfma_f32_16x16x32_bf16 v[184:187], v[248:251], v[136:139], v[184:187]
    buffer_load_dwordx4 v[148:151], v1, s[12:15], s25 offen offset:3072 sc1
    ds_read_b128 v[248:251], v4 offset:26624
    s_waitcnt lgkmcnt(3)
    v_mfma_f32_16x16x32_bf16 v[180:183], v[252:255], v[64:67], v[180:183]
    v_mfma_f32_16x16x32_bf16 v[188:191], v[252:255], v[136:139], v[188:191]
    ds_read_b128 v[252:255], v4 offset:27648
    s_waitcnt lgkmcnt(3)
    v_mfma_f32_16x16x32_bf16 v[192:195], v[240:243], v[64:67], v[192:195]
    v_mfma_f32_16x16x32_bf16 v[200:203], v[240:243], v[136:139], v[200:203]
    buffer_load_dwordx4 v[216:219], v1, s[12:15], s27 offen offset:2048 sc1
    ds_read_b128 v[240:243], v5 offset:26624
    s_waitcnt lgkmcnt(3)
    v_mfma_f32_16x16x32_bf16 v[196:199], v[244:247], v[64:67], v[196:199]
    v_mfma_f32_16x16x32_bf16 v[204:207], v[244:247], v[136:139], v[204:207]
    ds_read_b128 v[244:247], v5 offset:27648
    s_waitcnt vmcnt(7) lgkmcnt(3)
    v_mfma_f32_16x16x32_bf16 v[160:163], v[248:251], v[68:71], v[160:163]
    v_mfma_f32_16x16x32_bf16 v[168:171], v[248:251], v[140:143], v[168:171]
    s_add_u32 s24, s24, 4096
    buffer_load_dwordx4 v[80:83], v1, s[12:15], s24 offen offset:0 sc1
    ds_read_b128 v[248:251], v6 offset:26624
    s_waitcnt lgkmcnt(3)
    v_mfma_f32_16x16x32_bf16 v[164:167], v[252:255], v[68:71], v[164:167]
    v_mfma_f32_16x16x32_bf16 v[172:175], v[252:255], v[140:143], v[172:175]
    ds_read_b128 v[252:255], v6 offset:27648
    s_waitcnt lgkmcnt(3)
    v_mfma_f32_16x16x32_bf16 v[176:179], v[240:243], v[68:71], v[176:179]
    v_mfma_f32_16x16x32_bf16 v[184:187], v[240:243], v[140:143], v[184:187]
    s_add_u32 s25, s25, 4096
    buffer_load_dwordx4 v[152:155], v1, s[12:15], s25 offen offset:0 sc1
    ds_read_b128 v[240:243], v4 offset:28672
    s_waitcnt lgkmcnt(3)
    v_mfma_f32_16x16x32_bf16 v[180:183], v[244:247], v[68:71], v[180:183]
    v_mfma_f32_16x16x32_bf16 v[188:191], v[244:247], v[140:143], v[188:191]
    ds_read_b128 v[244:247], v4 offset:29696
    s_waitcnt lgkmcnt(3)
    v_mfma_f32_16x16x32_bf16 v[192:195], v[248:251], v[68:71], v[192:195]
    v_mfma_f32_16x16x32_bf16 v[200:203], v[248:251], v[140:143], v[200:203]
    buffer_load_dwordx4 v[220:223], v1, s[12:15], s27 offen offset:3072 sc1
    ds_read_b128 v[248:251], v5 offset:28672
    s_waitcnt lgkmcnt(3)
    v_mfma_f32_16x16x32_bf16 v[196:199], v[252:255], v[68:71], v[196:199]
    v_mfma_f32_16x16x32_bf16 v[204:207], v[252:255], v[140:143], v[204:207]
    ds_read_b128 v[252:255], v5 offset:29696
    s_waitcnt vmcnt(7) lgkmcnt(3)
    v_mfma_f32_16x16x32_bf16 v[160:163], v[240:243], v[72:75], v[160:163]
    v_mfma_f32_16x16x32_bf16 v[168:171], v[240:243], v[144:147], v[168:171]
    buffer_load_dwordx4 v[84:87], v1, s[12:15], s24 offen offset:1024 sc1
    ds_read_b128 v[240:243], v6 offset:28672
    s_waitcnt lgkmcnt(3)
    v_mfma_f32_16x16x32_bf16 v[164:167], v[244:247], v[72:75], v[164:167]
    v_mfma_f32_16x16x32_bf16 v[172:175], v[244:247], v[144:147], v[172:175]
    ds_read_b128 v[244:247], v6 offset:29696
    s_waitcnt lgkmcnt(3)
    v_mfma_f32_16x16x32_bf16 v[176:179], v[248:251], v[72:75], v[176:179]
    v_mfma_f32_16x16x32_bf16 v[184:187], v[248:251], v[144:147], v[184:187]
    buffer_load_dwordx4 v[156:159], v1, s[12:15], s25 offen offset:1024 sc1
    ds_read_b128 v[248:251], v4 offset:30720
    s_waitcnt lgkmcnt(3)
    v_mfma_f32_16x16x32_bf16 v[180:183], v[252:255], v[72:75], v[180:183]
    v_mfma_f32_16x16x32_bf16 v[188:191], v[252:255], v[144:147], v[188:191]
    ds_read_b128 v[252:255], v4 offset:31744
    s_waitcnt lgkmcnt(3)
    v_mfma_f32_16x16x32_bf16 v[192:195], v[240:243], v[72:75], v[192:195]
    v_mfma_f32_16x16x32_bf16 v[200:203], v[240:243], v[144:147], v[200:203]
    s_add_u32 s27, s27, 4096
    buffer_load_dwordx4 v[224:227], v1, s[12:15], s27 offen offset:0 sc1
    ds_read_b128 v[240:243], v5 offset:30720
    s_waitcnt lgkmcnt(3)
    v_mfma_f32_16x16x32_bf16 v[196:199], v[244:247], v[72:75], v[196:199]
    v_mfma_f32_16x16x32_bf16 v[204:207], v[244:247], v[144:147], v[204:207]
    ds_read_b128 v[244:247], v5 offset:31744
    s_waitcnt vmcnt(7) lgkmcnt(3)
    v_mfma_f32_16x16x32_bf16 v[160:163], v[248:251], v[76:79], v[160:163]
    v_mfma_f32_16x16x32_bf16 v[168:171], v[248:251], v[148:151], v[168:171]
    buffer_load_dwordx4 v[228:231], v1, s[12:15], s27 offen offset:1024 sc1
    ds_read_b128 v[248:251], v6 offset:30720
    s_waitcnt lgkmcnt(3)
    v_mfma_f32_16x16x32_bf16 v[164:167], v[252:255], v[76:79], v[164:167]
    v_mfma_f32_16x16x32_bf16 v[172:175], v[252:255], v[148:151], v[172:175]
    ds_read_b128 v[252:255], v6 offset:31744
    s_waitcnt lgkmcnt(3)
    v_mfma_f32_16x16x32_bf16 v[176:179], v[240:243], v[76:79], v[176:179]
    v_mfma_f32_16x16x32_bf16 v[184:187], v[240:243], v[148:151], v[184:187]
    buffer_load_dwordx4 v[232:235], v1, s[12:15], s27 offen offset:2048 sc1
    ds_read_b128 v[240:243], v4 offset:32768
    s_waitcnt lgkmcnt(3)
    v_mfma_f32_16x16x32_bf16 v[180:183], v[244:247], v[76:79], v[180:183]
    v_mfma_f32_16x16x32_bf16 v[188:191], v[244:247], v[148:151], v[188:191]
    ds_read_b128 v[244:247], v4 offset:33792
    s_waitcnt lgkmcnt(3)
    s_waitcnt vmcnt(0)
    v_add_f32 v236, v208, v212
    v_add_f32 v237, v209, v213
    v_add_f32 v238, v210, v214
    v_add_f32 v239, v211, v215
    v_add_f32 v236, v236, v216
    v_add_f32 v237, v237, v217
    v_add_f32 v238, v238, v218
    v_add_f32 v239, v239, v219
    v_add_f32 v236, v236, v220
    v_add_f32 v237, v237, v221
    v_add_f32 v238, v238, v222
    v_add_f32 v239, v239, v223
    v_add_f32 v236, v236, v224
    v_add_f32 v237, v237, v225
    v_add_f32 v238, v238, v226
    v_add_f32 v239, v239, v227
    v_add_f32 v236, v236, v228
    v_add_f32 v237, v237, v229
    v_add_f32 v238, v238, v230
    v_add_f32 v239, v239, v231
    v_add_f32 v236, v236, v232
    v_add_f32 v237, v237, v233
    v_add_f32 v238, v238, v234
    v_add_f32 v239, v239, v235
    buffer_load_dwordx4 v[208:211], v1, s[12:15], s27 offen offset:3072 sc1
    s_add_u32 s27, s27, 4096
    buffer_load_dwordx4 v[212:215], v1, s[12:15], s27 offen offset:0 sc1
    v_mfma_f32_16x16x32_bf16 v[192:195], v[248:251], v[76:79], v[192:195]
    v_mfma_f32_16x16x32_bf16 v[200:203], v[248:251], v[148:151], v[200:203]
    ds_read_b128 v[248:251], v5 offset:32768
    s_waitcnt lgkmcnt(3)
    v_mfma_f32_16x16x32_bf16 v[196:199], v[252:255], v[76:79], v[196:199]
    v_mfma_f32_16x16x32_bf16 v[204:207], v[252:255], v[148:151], v[204:207]
    ds_read_b128 v[252:255], v5 offset:33792
    s_waitcnt lgkmcnt(3)
    v_mfma_f32_16x16x32_bf16 v[160:163], v[240:243], v[80:83], v[160:163]
    v_mfma_f32_16x16x32_bf16 v[168:171], v[240:243], v[152:155], v[168:171]
    ds_read_b128 v[240:243], v6 offset:32768
    s_waitcnt lgkmcnt(3)
    v_mfma_f32_16x16x32_bf16 v[164:167], v[244:247], v[80:83], v[164:167]
    v_mfma_f32_16x16x32_bf16 v[172:175], v[244:247], v[152:155], v[172:175]
    ds_read_b128 v[244:247], v6 offset:33792
    s_waitcnt lgkmcnt(3)
    v_mfma_f32_16x16x32_bf16 v[176:179], v[248:251], v[80:83], v[176:179]
    v_mfma_f32_16x16x32_bf16 v[184:187], v[248:251], v[152:155], v[184:187]
    ds_read_b128 v[248:251], v4 offset:34816
    s_waitcnt lgkmcnt(3)
    v_mfma_f32_16x16x32_bf16 v[180:183], v[252:255], v[80:83], v[180:183]
    v_mfma_f32_16x16x32_bf16 v[188:191], v[252:255], v[152:155], v[188:191]
    ds_read_b128 v[252:255], v4 offset:35840
    s_waitcnt lgkmcnt(3)
    v_mfma_f32_16x16x32_bf16 v[192:195], v[240:243], v[80:83], v[192:195]
    v_mfma_f32_16x16x32_bf16 v[200:203], v[240:243], v[152:155], v[200:203]
    ds_read_b128 v[240:243], v5 offset:34816
    s_waitcnt lgkmcnt(3)
    v_mfma_f32_16x16x32_bf16 v[196:199], v[244:247], v[80:83], v[196:199]
    v_mfma_f32_16x16x32_bf16 v[204:207], v[244:247], v[152:155], v[204:207]
    ds_read_b128 v[244:247], v5 offset:35840
    s_waitcnt lgkmcnt(3)
    v_mfma_f32_16x16x32_bf16 v[160:163], v[248:251], v[84:87], v[160:163]
    v_mfma_f32_16x16x32_bf16 v[168:171], v[248:251], v[156:159], v[168:171]
    ds_read_b128 v[248:251], v6 offset:34816
    s_waitcnt lgkmcnt(3)
    v_mfma_f32_16x16x32_bf16 v[164:167], v[252:255], v[84:87], v[164:167]
    v_mfma_f32_16x16x32_bf16 v[172:175], v[252:255], v[156:159], v[172:175]
    ds_read_b128 v[252:255], v6 offset:35840
    s_waitcnt lgkmcnt(3)
    s_waitcnt vmcnt(0)
    v_add_f32 v236, v236, v208
    v_add_f32 v237, v237, v209
    v_add_f32 v238, v238, v210
    v_add_f32 v239, v239, v211
    v_add_f32 v236, v236, v212
    v_add_f32 v237, v237, v213
    v_add_f32 v238, v238, v214
    v_add_f32 v239, v239, v215
    v_mov_b32 v208, v236
    v_mov_b32 v209, v237
    s_nop 0
    v_permlane32_swap_b32 v236, v208
    v_permlane32_swap_b32 v237, v209
    v_add_f32 v236, v236, v208
    v_add_f32 v237, v237, v209
    v_mov_b32 v208, v236
    v_mov_b32 v209, v237
    s_nop 0
    v_permlane16_swap_b32 v236, v208
    v_permlane16_swap_b32 v237, v209
    v_add_f32 v236, v236, v208
    v_add_f32 v237, v237, v209
    v_mul_f32 v8, 0x3ae38e39, v236
    v_mul_f32 v12, 0x3ae38e39, v237
    v_fma_f32 v12, -v8, v8, v12
    v_max_f32 v12, 0, v12
    v_add_f32 v12, 0x3727c5ac, v12
    v_rsq_f32 v10, v12
    v_sub_f32 v8, 0, v8
    v_mul_f32 v10, 0xbfb8aa3b, v10
    v_mov_b32 v208, v238
    v_mov_b32 v209, v239
    s_nop 0
    v_permlane32_swap_b32 v238, v208
    v_permlane32_swap_b32 v239, v209
    v_add_f32 v238, v238, v208
    v_add_f32 v239, v239, v209
    v_mov_b32 v208, v238
    v_mov_b32 v209, v239
    s_nop 0
    v_permlane16_swap_b32 v238, v208
    v_permlane16_swap_b32 v239, v209
    v_add_f32 v238, v238, v208
    v_add_f32 v239, v239, v209
    v_mul_f32 v9, 0x3ae38e39, v238
    v_mul_f32 v13, 0x3ae38e39, v239
    v_fma_f32 v13, -v9, v9, v13
    v_max_f32 v13, 0, v13
    v_add_f32 v13, 0x3727c5ac, v13
    v_rsq_f32 v11, v13
    v_sub_f32 v9, 0, v9
    v_mul_f32 v11, 0xbfb8aa3b, v11
    v_mfma_f32_16x16x32_bf16 v[176:179], v[240:243], v[84:87], v[176:179]
    v_mfma_f32_16x16x32_bf16 v[184:187], v[240:243], v[156:159], v[184:187]
    s_waitcnt lgkmcnt(0)
    s_barrier
    ds_read_b128 v[240:243], v7 offset:0
    v_mfma_f32_16x16x32_bf16 v[180:183], v[244:247], v[84:87], v[180:183]
    v_mfma_f32_16x16x32_bf16 v[188:191], v[244:247], v[156:159], v[188:191]
    ds_read_b128 v[244:247], v7 offset:1024
    v_mfma_f32_16x16x32_bf16 v[192:195], v[248:251], v[84:87], v[192:195]
    v_mfma_f32_16x16x32_bf16 v[200:203], v[248:251], v[156:159], v[200:203]
    s_add_u32 m0, s20, 0
    s_add_u32 s26, s21, 147456
    buffer_load_dwordx4 v1, s[8:11], s26 offen offset:0 sc1 lds
    ds_read_b128 v[248:251], v7 offset:2048
    v_mfma_f32_16x16x32_bf16 v[196:199], v[252:255], v[84:87], v[196:199]
    v_mfma_f32_16x16x32_bf16 v[204:207], v[252:255], v[156:159], v[204:207]
    ds_read_b128 v[252:255], v7 offset:3072
    s_waitcnt lgkmcnt(3)
    v_mfma_f32_16x16x32_bf16 v[208:211], v[240:243], v[16:19], 0
    ds_read_b128 v[224:227], v15 offset:0
    v_mfma_f32_16x16x32_bf16 v[216:219], v[240:243], v[88:91], 0
    buffer_load_dwordx4 v1, s[8:11], s26 offen offset:1024 sc1 lds
    ds_read_b128 v[240:243], v7 offset:4096
    s_waitcnt lgkmcnt(4)
    v_mfma_f32_16x16x32_bf16 v[212:215], v[244:247], v[16:19], 0
    ds_read_b128 v[228:231], v15 offset:64
    v_mfma_f32_16x16x32_bf16 v[220:223], v[244:247], v[88:91], 0
    ds_read_b128 v[244:247], v7 offset:5120
    s_waitcnt lgkmcnt(5)
    v_mfma_f32_16x16x32_bf16 v[208:211], v[248:251], v[20:23], v[208:211]
    s_waitcnt lgkmcnt(1)
    v_mfma_f32_16x16x32_bf16 v[216:219], v[248:251], v[92:95], v[216:219]
    buffer_load_dwordx4 v1, s[8:11], s26 offen offset:2048 sc1 lds
    ds_read_b128 v[248:251], v7 offset:6144
    v_mfma_f32_16x16x32_bf16 v[212:215], v[252:255], v[20:23], v[212:215]
    v_fmac_f32 v160, v8, v224
    v_fmac_f32 v164, v8, v228
    v_fmac_f32 v161, v8, v225
    v_mfma_f32_16x16x32_bf16 v[220:223], v[252:255], v[92:95], v[220:223]
    ds_read_b128 v[252:255], v7 offset:7168
    v_mfma_f32_16x16x32_bf16 v[208:211], v[240:243], v[24:27], v[208:211]
    v_fmac_f32 v165, v8, v229
    v_fmac_f32 v162, v8, v226
    v_fmac_f32 v166, v8, v230
    v_fmac_f32 v163, v8, v227
    v_mfma_f32_16x16x32_bf16 v[216:219], v[240:243], v[96:99], v[216:219]
    buffer_load_dwordx4 v1, s[8:11], s26 offen offset:3072 sc1 lds
    ds_read_b128 v[240:243], v7 offset:8192
    s_waitcnt lgkmcnt(3)
    v_mfma_f32_16x16x32_bf16 v[212:215], v[244:247], v[24:27], v[212:215]
    v_fmac_f32 v167, v8, v231
    v_mul_f32 v164, v160, v164
    v_mul_f32 v160, v10, v160
    v_mfma_f32_16x16x32_bf16 v[220:223], v[244:247], v[96:99], v[220:223]
    ds_read_b128 v[244:247], v7 offset:9216
    s_waitcnt lgkmcnt(3)
    v_mfma_f32_16x16x32_bf16 v[208:211], v[248:251], v[28:31], v[208:211]
    v_mul_f32 v165, v161, v165
    v_mul_f32 v161, v10, v161
    v_mul_f32 v166, v162, v166
    v_mfma_f32_16x16x32_bf16 v[216:219], v[248:251], v[100:103], v[216:219]
    s_add_u32 m0, m0, 4096
    s_add_u32 s26, s26, 4096
    s_mov_b64 exec, s[22:23]
    buffer_load_dwordx4 v1, s[8:11], s26 offen sc1 lds
    s_mov_b64 exec, -1
    ds_read_b128 v[248:251], v7 offset:10240
    s_waitcnt lgkmcnt(3)
    v_mfma_f32_16x16x32_bf16 v[212:215], v[252:255], v[28:31], v[212:215]
    v_mul_f32 v162, v10, v162
    v_mul_f32 v167, v163, v167
    v_mul_f32 v163, v10, v163
    v_mfma_f32_16x16x32_bf16 v[220:223], v[252:255], v[100:103], v[220:223]
    ds_read_b128 v[252:255], v7 offset:11264
    s_waitcnt lgkmcnt(3)
    v_mfma_f32_16x16x32_bf16 v[208:211], v[240:243], v[32:35], v[208:211]
    v_exp_f32 v160, v160
    v_exp_f32 v161, v161
    v_exp_f32 v162, v162
    v_mfma_f32_16x16x32_bf16 v[216:219], v[240:243], v[104:107], v[216:219]
    s_add_u32 m0, s20, 36864
    s_add_u32 s26, s21, 184320
    buffer_load_dwordx4 v1, s[8:11], s26 offen offset:0 sc1 lds
    ds_read_b128 v[240:243], v7 offset:12288
    s_waitcnt lgkmcnt(3)
    v_mfma_f32_16x16x32_bf16 v[212:215], v[244:247], v[32:35], v[212:215]
    v_exp_f32 v163, v163
    v_fma_f32 v160, v160, v12, v12
    v_fma_f32 v161, v161, v12, v12
    v_mfma_f32_16x16x32_bf16 v[220:223], v[244:247], v[104:107], v[220:223]
    ds_read_b128 v[244:247], v7 offset:13312
    s_waitcnt lgkmcnt(3)
    v_mfma_f32_16x16x32_bf16 v[208:211], v[248:251], v[36:39], v[208:211]
    v_fma_f32 v162, v162, v12, v12
    v_fma_f32 v163, v163, v12, v12
    v_rcp_f32 v160, v160
    v_mfma_f32_16x16x32_bf16 v[216:219], v[248:251], v[108:111], v[216:219]
    buffer_load_dwordx4 v1, s[8:11], s26 offen offset:1024 sc1 lds
    ds_read_b128 v[248:251], v7 offset:14336
    s_waitcnt lgkmcnt(3)
    v_mfma_f32_16x16x32_bf16 v[212:215], v[252:255], v[36:39], v[212:215]
    v_rcp_f32 v161, v161
    v_rcp_f32 v162, v162
    v_rcp_f32 v163, v163
    v_mfma_f32_16x16x32_bf16 v[220:223], v[252:255], v[108:111], v[220:223]
    ds_read_b128 v[252:255], v7 offset:15360
    s_waitcnt lgkmcnt(3)
    v_mfma_f32_16x16x32_bf16 v[208:211], v[240:243], v[40:43], v[208:211]
    v_mul_f32 v164, v164, v160
    v_mul_f32 v165, v165, v161
    v_mul_f32 v166, v166, v162
    v_mul_f32 v167, v167, v163
    v_mfma_f32_16x16x32_bf16 v[216:219], v[240:243], v[112:115], v[216:219]
    buffer_load_dwordx4 v1, s[8:11], s26 offen offset:2048 sc1 lds
    ds_read_b128 v[240:243], v7 offset:16384
    s_waitcnt lgkmcnt(3)
    v_mfma_f32_16x16x32_bf16 v[212:215], v[244:247], v[40:43], v[212:215]
    v_cvt_pk_bf16_f32 v232, v164, v165
    v_cvt_pk_bf16_f32 v233, v166, v167
    v_fmac_f32 v168, v9, v224
    v_mfma_f32_16x16x32_bf16 v[220:223], v[244:247], v[112:115], v[220:223]
    ds_read_b128 v[244:247], v7 offset:17408
    s_waitcnt lgkmcnt(3)
    v_mfma_f32_16x16x32_bf16 v[208:211], v[248:251], v[44:47], v[208:211]
    v_fmac_f32 v172, v9, v228
    v_fmac_f32 v169, v9, v225
    v_fmac_f32 v173, v9, v229
    v_mfma_f32_16x16x32_bf16 v[216:219], v[248:251], v[116:119], v[216:219]
    buffer_load_dwordx4 v1, s[8:11], s26 offen offset:3072 sc1 lds
    ds_read_b128 v[248:251], v7 offset:18432
    s_waitcnt lgkmcnt(3)
    v_mfma_f32_16x16x32_bf16 v[212:215], v[252:255], v[44:47], v[212:215]
    v_fmac_f32 v170, v9, v226
    v_fmac_f32 v174, v9, v230
    v_fmac_f32 v171, v9, v227
    v_mfma_f32_16x16x32_bf16 v[220:223], v[252:255], v[116:119], v[220:223]
    ds_read_b128 v[252:255], v7 offset:19456
    s_waitcnt lgkmcnt(3)
    v_mfma_f32_16x16x32_bf16 v[208:211], v[240:243], v[48:51], v[208:211]
    v_fmac_f32 v175, v9, v231
    v_mul_f32 v172, v168, v172
    v_mul_f32 v168, v11, v168
    v_mfma_f32_16x16x32_bf16 v[216:219], v[240:243], v[120:123], v[216:219]
    s_add_u32 m0, m0, 4096
    s_add_u32 s26, s26, 4096
    s_mov_b64 exec, s[22:23]
    buffer_load_dwordx4 v1, s[8:11], s26 offen sc1 lds
    s_mov_b64 exec, -1
    ds_read_b128 v[240:243], v7 offset:20480
    s_waitcnt lgkmcnt(3)
    v_mfma_f32_16x16x32_bf16 v[212:215], v[244:247], v[48:51], v[212:215]
    v_mul_f32 v173, v169, v173
    v_mul_f32 v169, v11, v169
    v_mul_f32 v174, v170, v174
    v_mfma_f32_16x16x32_bf16 v[220:223], v[244:247], v[120:123], v[220:223]
    ds_read_b128 v[244:247], v7 offset:21504
    s_waitcnt lgkmcnt(3)
    v_mfma_f32_16x16x32_bf16 v[208:211], v[248:251], v[52:55], v[208:211]
    v_mul_f32 v170, v11, v170
    v_mul_f32 v175, v171, v175
    v_mul_f32 v171, v11, v171
    v_mfma_f32_16x16x32_bf16 v[216:219], v[248:251], v[124:127], v[216:219]
    s_add_u32 m0, s20, 73728
    s_add_u32 s26, s21, 221184
    buffer_load_dwordx4 v1, s[8:11], s26 offen offset:0 sc1 lds
    ds_read_b128 v[248:251], v7 offset:22528
    s_waitcnt lgkmcnt(3)
    v_mfma_f32_16x16x32_bf16 v[212:215], v[252:255], v[52:55], v[212:215]
    v_exp_f32 v168, v168
    v_exp_f32 v169, v169
    v_exp_f32 v170, v170
    v_mfma_f32_16x16x32_bf16 v[220:223], v[252:255], v[124:127], v[220:223]
    ds_read_b128 v[252:255], v7 offset:23552
    s_waitcnt lgkmcnt(3)
    v_mfma_f32_16x16x32_bf16 v[208:211], v[240:243], v[56:59], v[208:211]
    v_exp_f32 v171, v171
    v_fma_f32 v168, v168, v13, v13
    v_fma_f32 v169, v169, v13, v13
    v_fma_f32 v170, v170, v13, v13
    v_mfma_f32_16x16x32_bf16 v[216:219], v[240:243], v[128:131], v[216:219]
    buffer_load_dwordx4 v1, s[8:11], s26 offen offset:1024 sc1 lds
    ds_read_b128 v[240:243], v7 offset:24576
    s_waitcnt lgkmcnt(3)
    v_mfma_f32_16x16x32_bf16 v[212:215], v[244:247], v[56:59], v[212:215]
    v_fma_f32 v171, v171, v13, v13
    v_rcp_f32 v168, v168
    v_rcp_f32 v169, v169
    v_mfma_f32_16x16x32_bf16 v[220:223], v[244:247], v[128:131], v[220:223]
    ds_read_b128 v[244:247], v7 offset:25600
    s_waitcnt lgkmcnt(3)
    v_mfma_f32_16x16x32_bf16 v[208:211], v[248:251], v[60:63], v[208:211]
    v_rcp_f32 v170, v170
    v_rcp_f32 v171, v171
    v_mul_f32 v172, v172, v168
    v_mfma_f32_16x16x32_bf16 v[216:219], v[248:251], v[132:135], v[216:219]
    buffer_load_dwordx4 v1, s[8:11], s26 offen offset:2048 sc1 lds
    ds_read_b128 v[248:251], v7 offset:26624
    s_waitcnt lgkmcnt(3)
    v_mfma_f32_16x16x32_bf16 v[212:215], v[252:255], v[60:63], v[212:215]
    v_mul_f32 v173, v173, v169
    v_mul_f32 v174, v174, v170
    v_mul_f32 v175, v175, v171
    v_mfma_f32_16x16x32_bf16 v[220:223], v[252:255], v[132:135], v[220:223]
    ds_read_b128 v[252:255], v7 offset:27648
    s_waitcnt lgkmcnt(3)
    v_mfma_f32_16x16x32_bf16 v[208:211], v[240:243], v[64:67], v[208:211]
    v_cvt_pk_bf16_f32 v236, v172, v173
    v_cvt_pk_bf16_f32 v237, v174, v175
    ds_read_b128 v[224:227], v15 offset:128
    v_mfma_f32_16x16x32_bf16 v[216:219], v[240:243], v[136:139], v[216:219]
    buffer_load_dwordx4 v1, s[8:11], s26 offen offset:3072 sc1 lds
    ds_read_b128 v[240:243], v7 offset:28672
    s_waitcnt lgkmcnt(4)
    v_mfma_f32_16x16x32_bf16 v[212:215], v[244:247], v[64:67], v[212:215]
    ds_read_b128 v[228:231], v15 offset:192
    v_mfma_f32_16x16x32_bf16 v[220:223], v[244:247], v[136:139], v[220:223]
    ds_read_b128 v[244:247], v7 offset:29696
    s_waitcnt lgkmcnt(5)
    v_mfma_f32_16x16x32_bf16 v[208:211], v[248:251], v[68:71], v[208:211]
    s_waitcnt lgkmcnt(1)
    v_mfma_f32_16x16x32_bf16 v[216:219], v[248:251], v[140:143], v[216:219]
    s_add_u32 m0, m0, 4096
    s_add_u32 s26, s26, 4096
    s_mov_b64 exec, s[22:23]
    buffer_load_dwordx4 v1, s[8:11], s26 offen sc1 lds
    s_mov_b64 exec, -1
    ds_read_b128 v[248:251], v7 offset:30720
    v_mfma_f32_16x16x32_bf16 v[212:215], v[252:255], v[68:71], v[212:215]
    v_fmac_f32 v176, v8, v224
    v_fmac_f32 v180, v8, v228
    v_fmac_f32 v177, v8, v225
    v_mfma_f32_16x16x32_bf16 v[220:223], v[252:255], v[140:143], v[220:223]
    ds_read_b128 v[252:255], v7 offset:31744
    v_mfma_f32_16x16x32_bf16 v[208:211], v[240:243], v[72:75], v[208:211]
    v_fmac_f32 v181, v8, v229
    v_fmac_f32 v178, v8, v226
    v_fmac_f32 v182, v8, v230
    v_fmac_f32 v179, v8, v227
    v_mfma_f32_16x16x32_bf16 v[216:219], v[240:243], v[144:147], v[216:219]
    ds_read_b128 v[240:243], v7 offset:32768
    s_waitcnt lgkmcnt(3)
    v_mfma_f32_16x16x32_bf16 v[212:215], v[244:247], v[72:75], v[212:215]
    v_fmac_f32 v183, v8, v231
    v_mul_f32 v180, v176, v180
    v_mul_f32 v176, v10, v176
    v_mfma_f32_16x16x32_bf16 v[220:223], v[244:247], v[144:147], v[220:223]
    ds_read_b128 v[244:247], v7 offset:33792
    s_waitcnt lgkmcnt(3)
    v_mfma_f32_16x16x32_bf16 v[208:211], v[248:251], v[76:79], v[208:211]
    v_mul_f32 v181, v177, v181
    v_mul_f32 v177, v10, v177
    v_mul_f32 v182, v178, v182
    v_mfma_f32_16x16x32_bf16 v[216:219], v[248:251], v[148:151], v[216:219]
    ds_read_b128 v[248:251], v7 offset:34816
    s_waitcnt lgkmcnt(3)
    v_mfma_f32_16x16x32_bf16 v[212:215], v[252:255], v[76:79], v[212:215]
    v_mul_f32 v178, v10, v178
    v_mul_f32 v183, v179, v183
    v_mul_f32 v179, v10, v179
    v_mfma_f32_16x16x32_bf16 v[220:223], v[252:255], v[148:151], v[220:223]
    ds_read_b128 v[252:255], v7 offset:35840
    s_waitcnt lgkmcnt(3)
    v_mfma_f32_16x16x32_bf16 v[208:211], v[240:243], v[80:83], v[208:211]
    v_exp_f32 v176, v176
    v_exp_f32 v177, v177
    v_exp_f32 v178, v178
    v_mfma_f32_16x16x32_bf16 v[216:219], v[240:243], v[152:155], v[216:219]
    s_waitcnt vmcnt(10)
    s_barrier
    ds_read_b128 v[240:243], v4 offset:0
    s_waitcnt lgkmcnt(3)
    v_mfma_f32_16x16x32_bf16 v[212:215], v[244:247], v[80:83], v[212:215]
    v_exp_f32 v179, v179
    v_fma_f32 v176, v176, v12, v12
    v_fma_f32 v177, v177, v12, v12
    v_mfma_f32_16x16x32_bf16 v[220:223], v[244:247], v[152:155], v[220:223]
    ds_read_b128 v[244:247], v4 offset:1024
    s_waitcnt lgkmcnt(3)
    v_mfma_f32_16x16x32_bf16 v[208:211], v[248:251], v[84:87], v[208:211]
    v_fma_f32 v178, v178, v12, v12
    v_fma_f32 v179, v179, v12, v12
    v_rcp_f32 v176, v176
    v_mfma_f32_16x16x32_bf16 v[216:219], v[248:251], v[156:159], v[216:219]
    ds_read_b128 v[248:251], v4 offset:2048
    s_waitcnt lgkmcnt(3)
    v_mfma_f32_16x16x32_bf16 v[212:215], v[252:255], v[84:87], v[212:215]
    v_rcp_f32 v177, v177
    v_rcp_f32 v178, v178
    v_rcp_f32 v179, v179
    v_mfma_f32_16x16x32_bf16 v[220:223], v[252:255], v[156:159], v[220:223]
    ds_read_b128 v[252:255], v4 offset:3072
    s_waitcnt lgkmcnt(3)
    v_mfma_f32_16x16x32_bf16 v[160:163], v[240:243], v[16:19], 0
    v_mul_f32 v180, v180, v176
    v_mul_f32 v181, v181, v177
    v_mul_f32 v182, v182, v178
    v_mul_f32 v183, v183, v179
    v_mfma_f32_16x16x32_bf16 v[168:171], v[240:243], v[88:91], 0
    ds_read_b128 v[240:243], v4 offset:4096
    s_waitcnt lgkmcnt(3)
    v_mfma_f32_16x16x32_bf16 v[164:167], v[244:247], v[16:19], 0
    v_cvt_pk_bf16_f32 v234, v180, v181
    v_cvt_pk_bf16_f32 v235, v182, v183
    buffer_store_dwordx4 v[232:235], v1, s[12:15], s33 offen offset:0 sc1
    v_mfma_f32_16x16x32_bf16 v[172:175], v[244:247], v[88:91], 0
    ds_read_b128 v[244:247], v4 offset:5120
    s_waitcnt lgkmcnt(3)
    v_mfma_f32_16x16x32_bf16 v[160:163], v[248:251], v[20:23], v[160:163]
    v_fmac_f32 v184, v9, v224
    v_fmac_f32 v188, v9, v228
    v_fmac_f32 v185, v9, v225
    v_mfma_f32_16x16x32_bf16 v[168:171], v[248:251], v[92:95], v[168:171]
    ds_read_b128 v[248:251], v4 offset:6144
    s_waitcnt lgkmcnt(3)
    v_mfma_f32_16x16x32_bf16 v[164:167], v[252:255], v[20:23], v[164:167]
    v_fmac_f32 v189, v9, v229
    v_fmac_f32 v186, v9, v226
    v_fmac_f32 v190, v9, v230
    v_mfma_f32_16x16x32_bf16 v[172:175], v[252:255], v[92:95], v[172:175]
    ds_read_b128 v[252:255], v4 offset:7168
    s_waitcnt lgkmcnt(3)
    v_mfma_f32_16x16x32_bf16 v[160:163], v[240:243], v[24:27], v[160:163]
    v_fmac_f32 v187, v9, v227
    v_fmac_f32 v191, v9, v231
    v_mul_f32 v188, v184, v188
    v_mfma_f32_16x16x32_bf16 v[168:171], v[240:243], v[96:99], v[168:171]
    ds_read_b128 v[240:243], v4 offset:8192
    s_waitcnt lgkmcnt(3)
    v_mfma_f32_16x16x32_bf16 v[164:167], v[244:247], v[24:27], v[164:167]
    v_mul_f32 v184, v11, v184
    v_mul_f32 v189, v185, v189
    v_mul_f32 v185, v11, v185
    v_mfma_f32_16x16x32_bf16 v[172:175], v[244:247], v[96:99], v[172:175]
    ds_read_b128 v[244:247], v4 offset:9216
    s_waitcnt lgkmcnt(3)
    v_mfma_f32_16x16x32_bf16 v[160:163], v[248:251], v[28:31], v[160:163]
    v_mul_f32 v190, v186, v190
    v_mul_f32 v186, v11, v186
    v_mul_f32 v191, v187, v191
    v_mfma_f32_16x16x32_bf16 v[168:171], v[248:251], v[100:103], v[168:171]
    ds_read_b128 v[248:251], v4 offset:10240
    s_waitcnt lgkmcnt(3)
    v_mfma_f32_16x16x32_bf16 v[164:167], v[252:255], v[28:31], v[164:167]
    v_mul_f32 v187, v11, v187
    v_exp_f32 v184, v184
    v_exp_f32 v185, v185
    v_mfma_f32_16x16x32_bf16 v[172:175], v[252:255], v[100:103], v[172:175]
    ds_read_b128 v[252:255], v4 offset:11264
    s_waitcnt lgkmcnt(3)
    v_mfma_f32_16x16x32_bf16 v[160:163], v[240:243], v[32:35], v[160:163]
    v_exp_f32 v186, v186
    v_exp_f32 v187, v187
    v_fma_f32 v184, v184, v13, v13
    v_fma_f32 v185, v185, v13, v13
    v_mfma_f32_16x16x32_bf16 v[168:171], v[240:243], v[104:107], v[168:171]
    ds_read_b128 v[240:243], v4 offset:12288
    s_waitcnt lgkmcnt(3)
    v_mfma_f32_16x16x32_bf16 v[164:167], v[244:247], v[32:35], v[164:167]
    v_fma_f32 v186, v186, v13, v13
    v_fma_f32 v187, v187, v13, v13
    v_rcp_f32 v184, v184
    v_mfma_f32_16x16x32_bf16 v[172:175], v[244:247], v[104:107], v[172:175]
    ds_read_b128 v[244:247], v4 offset:13312
    s_waitcnt lgkmcnt(3)
    v_mfma_f32_16x16x32_bf16 v[160:163], v[248:251], v[36:39], v[160:163]
    v_rcp_f32 v185, v185
    v_rcp_f32 v186, v186
    v_rcp_f32 v187, v187
    v_mfma_f32_16x16x32_bf16 v[168:171], v[248:251], v[108:111], v[168:171]
    ds_read_b128 v[248:251], v4 offset:14336
    s_waitcnt lgkmcnt(3)
    v_mfma_f32_16x16x32_bf16 v[164:167], v[252:255], v[36:39], v[164:167]
    v_mul_f32 v188, v188, v184
    v_mul_f32 v189, v189, v185
    v_mul_f32 v190, v190, v186
    v_mfma_f32_16x16x32_bf16 v[172:175], v[252:255], v[108:111], v[172:175]
    ds_read_b128 v[252:255], v4 offset:15360
    s_waitcnt lgkmcnt(3)
    v_mfma_f32_16x16x32_bf16 v[160:163], v[240:243], v[40:43], v[160:163]
    v_mul_f32 v191, v191, v187
    v_cvt_pk_bf16_f32 v238, v188, v189
    v_cvt_pk_bf16_f32 v239, v190, v191
    v_mfma_f32_16x16x32_bf16 v[168:171], v[240:243], v[112:115], v[168:171]
    ds_read_b128 v[240:243], v4 offset:16384
    s_waitcnt lgkmcnt(3)
    v_mfma_f32_16x16x32_bf16 v[164:167], v[244:247], v[40:43], v[164:167]
    buffer_store_dwordx4 v[236:239], v1, s[12:15], s34 offen offset:0 sc1
    ds_read_b128 v[224:227], v15 offset:256
    ds_read_b128 v[228:231], v15 offset:320
    v_mfma_f32_16x16x32_bf16 v[172:175], v[244:247], v[112:115], v[172:175]
    ds_read_b128 v[244:247], v4 offset:17408
    s_waitcnt lgkmcnt(5)
    v_mfma_f32_16x16x32_bf16 v[160:163], v[248:251], v[44:47], v[160:163]
    v_mfma_f32_16x16x32_bf16 v[168:171], v[248:251], v[116:119], v[168:171]
    ds_read_b128 v[248:251], v4 offset:18432
    s_waitcnt lgkmcnt(5)
    v_mfma_f32_16x16x32_bf16 v[164:167], v[252:255], v[44:47], v[164:167]
    s_waitcnt lgkmcnt(2)
    v_fmac_f32 v192, v8, v224
    v_mfma_f32_16x16x32_bf16 v[172:175], v[252:255], v[116:119], v[172:175]
    ds_read_b128 v[252:255], v4 offset:19456
    v_mfma_f32_16x16x32_bf16 v[160:163], v[240:243], v[48:51], v[160:163]
    v_fmac_f32 v196, v8, v228
    v_fmac_f32 v193, v8, v225
    v_fmac_f32 v197, v8, v229
    v_fmac_f32 v194, v8, v226
    v_mfma_f32_16x16x32_bf16 v[168:171], v[240:243], v[120:123], v[168:171]
    ds_read_b128 v[240:243], v4 offset:20480
    s_waitcnt lgkmcnt(3)
    v_mfma_f32_16x16x32_bf16 v[164:167], v[244:247], v[48:51], v[164:167]
    v_fmac_f32 v198, v8, v230
    v_fmac_f32 v195, v8, v227
    v_fmac_f32 v199, v8, v231
    v_mfma_f32_16x16x32_bf16 v[172:175], v[244:247], v[120:123], v[172:175]
    ds_read_b128 v[244:247], v4 offset:21504
    s_waitcnt lgkmcnt(3)
    v_mfma_f32_16x16x32_bf16 v[160:163], v[248:251], v[52:55], v[160:163]
    v_mul_f32 v196, v192, v196
    v_mul_f32 v192, v10, v192
    v_mul_f32 v197, v193, v197
    v_mfma_f32_16x16x32_bf16 v[168:171], v[248:251], v[124:127], v[168:171]
    ds_read_b128 v[248:251], v4 offset:22528
    s_waitcnt lgkmcnt(3)
    v_mfma_f32_16x16x32_bf16 v[164:167], v[252:255], v[52:55], v[164:167]
    v_mul_f32 v193, v10, v193
    v_mul_f32 v198, v194, v198
    v_mul_f32 v194, v10, v194
    v_mfma_f32_16x16x32_bf16 v[172:175], v[252:255], v[124:127], v[172:175]
    ds_read_b128 v[252:255], v4 offset:23552
    s_waitcnt lgkmcnt(3)
    v_mfma_f32_16x16x32_bf16 v[160:163], v[240:243], v[56:59], v[160:163]
    v_mul_f32 v199, v195, v199
    v_mul_f32 v195, v10, v195
    v_exp_f32 v192, v192
    v_mfma_f32_16x16x32_bf16 v[168:171], v[240:243], v[128:131], v[168:171]
    ds_read_b128 v[240:243], v4 offset:24576
    s_waitcnt lgkmcnt(3)
    v_mfma_f32_16x16x32_bf16 v[164:167], v[244:247], v[56:59], v[164:167]
    v_exp_f32 v193, v193
    v_exp_f32 v194, v194
    v_exp_f32 v195, v195
    v_mfma_f32_16x16x32_bf16 v[172:175], v[244:247], v[128:131], v[172:175]
    ds_read_b128 v[244:247], v4 offset:25600
    s_waitcnt lgkmcnt(3)
    v_mfma_f32_16x16x32_bf16 v[160:163], v[248:251], v[60:63], v[160:163]
    v_fma_f32 v192, v192, v12, v12
    v_fma_f32 v193, v193, v12, v12
    v_fma_f32 v194, v194, v12, v12
    v_mfma_f32_16x16x32_bf16 v[168:171], v[248:251], v[132:135], v[168:171]
    ds_read_b128 v[248:251], v4 offset:26624
    s_waitcnt lgkmcnt(3)
    v_mfma_f32_16x16x32_bf16 v[164:167], v[252:255], v[60:63], v[164:167]
    v_fma_f32 v195, v195, v12, v12
    v_rcp_f32 v192, v192
    v_rcp_f32 v193, v193
    v_mfma_f32_16x16x32_bf16 v[172:175], v[252:255], v[132:135], v[172:175]
    ds_read_b128 v[252:255], v4 offset:27648
    s_waitcnt lgkmcnt(3)
    v_mfma_f32_16x16x32_bf16 v[160:163], v[240:243], v[64:67], v[160:163]
    v_rcp_f32 v194, v194
    v_rcp_f32 v195, v195
    v_mul_f32 v196, v196, v192
    v_mul_f32 v197, v197, v193
    v_mfma_f32_16x16x32_bf16 v[168:171], v[240:243], v[136:139], v[168:171]
    ds_read_b128 v[240:243], v4 offset:28672
    s_waitcnt lgkmcnt(3)
    v_mfma_f32_16x16x32_bf16 v[164:167], v[244:247], v[64:67], v[164:167]
    v_mul_f32 v198, v198, v194
    v_mul_f32 v199, v199, v195
    v_cvt_pk_bf16_f32 v232, v196, v197
    v_mfma_f32_16x16x32_bf16 v[172:175], v[244:247], v[136:139], v[172:175]
    ds_read_b128 v[244:247], v4 offset:29696
    s_waitcnt lgkmcnt(3)
    v_mfma_f32_16x16x32_bf16 v[160:163], v[248:251], v[68:71], v[160:163]
    v_cvt_pk_bf16_f32 v233, v198, v199
    v_fmac_f32 v200, v9, v224
    v_fmac_f32 v204, v9, v228
    v_mfma_f32_16x16x32_bf16 v[168:171], v[248:251], v[140:143], v[168:171]
    ds_read_b128 v[248:251], v4 offset:30720
    s_waitcnt lgkmcnt(3)
    v_mfma_f32_16x16x32_bf16 v[164:167], v[252:255], v[68:71], v[164:167]
    v_fmac_f32 v201, v9, v225
    v_fmac_f32 v205, v9, v229
    v_fmac_f32 v202, v9, v226
    v_mfma_f32_16x16x32_bf16 v[172:175], v[252:255], v[140:143], v[172:175]
    ds_read_b128 v[252:255], v4 offset:31744
    s_waitcnt lgkmcnt(3)
    v_mfma_f32_16x16x32_bf16 v[160:163], v[240:243], v[72:75], v[160:163]
    v_fmac_f32 v206, v9, v230
    v_fmac_f32 v203, v9, v227
    v_fmac_f32 v207, v9, v231
    v_mfma_f32_16x16x32_bf16 v[168:171], v[240:243], v[144:147], v[168:171]
    ds_read_b128 v[240:243], v4 offset:32768
    s_waitcnt lgkmcnt(3)
    v_mfma_f32_16x16x32_bf16 v[164:167], v[244:247], v[72:75], v[164:167]
    v_mul_f32 v204, v200, v204
    v_mul_f32 v200, v11, v200
    v_mul_f32 v205, v201, v205
    v_mfma_f32_16x16x32_bf16 v[172:175], v[244:247], v[144:147], v[172:175]
    ds_read_b128 v[244:247], v4 offset:33792
    s_waitcnt lgkmcnt(3)
    v_mfma_f32_16x16x32_bf16 v[160:163], v[248:251], v[76:79], v[160:163]
    v_mul_f32 v201, v11, v201
    v_mul_f32 v206, v202, v206
    v_mul_f32 v202, v11, v202
    v_mfma_f32_16x16x32_bf16 v[168:171], v[248:251], v[148:151], v[168:171]
    ds_read_b128 v[248:251], v4 offset:34816
    s_waitcnt lgkmcnt(3)
    v_mfma_f32_16x16x32_bf16 v[164:167], v[252:255], v[76:79], v[164:167]
    v_mul_f32 v207, v203, v207
    v_mul_f32 v203, v11, v203
    v_exp_f32 v200, v200
    v_mfma_f32_16x16x32_bf16 v[172:175], v[252:255], v[148:151], v[172:175]
    ds_read_b128 v[252:255], v4 offset:35840
    s_waitcnt lgkmcnt(3)
    v_mfma_f32_16x16x32_bf16 v[160:163], v[240:243], v[80:83], v[160:163]
    v_exp_f32 v201, v201
    v_exp_f32 v202, v202
    v_exp_f32 v203, v203
    v_fma_f32 v200, v200, v13, v13
    v_mfma_f32_16x16x32_bf16 v[168:171], v[240:243], v[152:155], v[168:171]
    s_waitcnt vmcnt(7)
    s_barrier
    ds_read_b128 v[240:243], v5 offset:0
    s_waitcnt lgkmcnt(3)
    v_mfma_f32_16x16x32_bf16 v[164:167], v[244:247], v[80:83], v[164:167]
    v_fma_f32 v201, v201, v13, v13
    v_fma_f32 v202, v202, v13, v13
    v_fma_f32 v203, v203, v13, v13
    v_mfma_f32_16x16x32_bf16 v[172:175], v[244:247], v[152:155], v[172:175]
    ds_read_b128 v[244:247], v5 offset:1024
    s_waitcnt lgkmcnt(3)
    v_mfma_f32_16x16x32_bf16 v[160:163], v[248:251], v[84:87], v[160:163]
    v_rcp_f32 v200, v200
    v_rcp_f32 v201, v201
    v_rcp_f32 v202, v202
    v_mfma_f32_16x16x32_bf16 v[168:171], v[248:251], v[156:159], v[168:171]
    s_add_u32 m0, s20, 110592
    s_add_u32 s26, s21, 258048
    buffer_load_dwordx4 v1, s[8:11], s26 offen offset:0 sc1 lds
    ds_read_b128 v[248:251], v5 offset:2048
    s_waitcnt lgkmcnt(3)
    v_mfma_f32_16x16x32_bf16 v[164:167], v[252:255], v[84:87], v[164:167]
    v_rcp_f32 v203, v203
    v_mul_f32 v204, v204, v200
    v_mul_f32 v205, v205, v201
    v_mfma_f32_16x16x32_bf16 v[172:175], v[252:255], v[156:159], v[172:175]
    ds_read_b128 v[252:255], v5 offset:3072
    s_waitcnt lgkmcnt(3)
    v_mfma_f32_16x16x32_bf16 v[176:179], v[240:243], v[16:19], 0
    v_mul_f32 v206, v206, v202
    v_mul_f32 v207, v207, v203
    v_cvt_pk_bf16_f32 v236, v204, v205
    v_mfma_f32_16x16x32_bf16 v[184:187], v[240:243], v[88:91], 0
    buffer_load_dwordx4 v1, s[8:11], s26 offen offset:1024 sc1 lds
    ds_read_b128 v[240:243], v5 offset:4096
    s_waitcnt lgkmcnt(3)
    v_mfma_f32_16x16x32_bf16 v[180:183], v[244:247], v[16:19], 0
    v_cvt_pk_bf16_f32 v237, v206, v207
    v_mfma_f32_16x16x32_bf16 v[188:191], v[244:247], v[88:91], 0
    ds_read_b128 v[244:247], v5 offset:5120
    s_waitcnt lgkmcnt(3)
    v_mfma_f32_16x16x32_bf16 v[176:179], v[248:251], v[20:23], v[176:179]
    ds_read_b128 v[224:227], v15 offset:384
    ds_read_b128 v[228:231], v15 offset:448
    v_mfma_f32_16x16x32_bf16 v[184:187], v[248:251], v[92:95], v[184:187]
    buffer_load_dwordx4 v1, s[8:11], s26 offen offset:2048 sc1 lds
    ds_read_b128 v[248:251], v5 offset:6144
    s_waitcnt lgkmcnt(5)
    v_mfma_f32_16x16x32_bf16 v[180:183], v[252:255], v[20:23], v[180:183]
    v_mfma_f32_16x16x32_bf16 v[188:191], v[252:255], v[92:95], v[188:191]
    ds_read_b128 v[252:255], v5 offset:7168
    s_waitcnt lgkmcnt(5)
    v_mfma_f32_16x16x32_bf16 v[176:179], v[240:243], v[24:27], v[176:179]
    s_waitcnt lgkmcnt(2)
    v_fmac_f32 v208, v8, v224
    v_fmac_f32 v212, v8, v228
    v_mfma_f32_16x16x32_bf16 v[184:187], v[240:243], v[96:99], v[184:187]
    buffer_load_dwordx4 v1, s[8:11], s26 offen offset:3072 sc1 lds
    ds_read_b128 v[240:243], v5 offset:8192
    v_mfma_f32_16x16x32_bf16 v[180:183], v[244:247], v[24:27], v[180:183]
    v_fmac_f32 v209, v8, v225
    v_fmac_f32 v213, v8, v229
    v_fmac_f32 v210, v8, v226
    v_mfma_f32_16x16x32_bf16 v[188:191], v[244:247], v[96:99], v[188:191]
    ds_read_b128 v[244:247], v5 offset:9216
    s_waitcnt lgkmcnt(3)
    v_mfma_f32_16x16x32_bf16 v[176:179], v[248:251], v[28:31], v[176:179]
    v_fmac_f32 v214, v8, v230
    v_fmac_f32 v211, v8, v227
    v_fmac_f32 v215, v8, v231
    v_mfma_f32_16x16x32_bf16 v[184:187], v[248:251], v[100:103], v[184:187]
    s_add_u32 m0, m0, 4096
    s_add_u32 s26, s26, 4096
    s_mov_b64 exec, s[22:23]
    buffer_load_dwordx4 v1, s[8:11], s26 offen sc1 lds
    s_mov_b64 exec, -1
    ds_read_b128 v[248:251], v5 offset:10240
    s_waitcnt lgkmcnt(3)
    v_mfma_f32_16x16x32_bf16 v[180:183], v[252:255], v[28:31], v[180:183]
    v_mul_f32 v212, v208, v212
    v_mul_f32 v208, v10, v208
    v_mul_f32 v213, v209, v213
    v_mfma_f32_16x16x32_bf16 v[188:191], v[252:255], v[100:103], v[188:191]
    ds_read_b128 v[252:255], v5 offset:11264
    s_waitcnt lgkmcnt(3)
    v_mfma_f32_16x16x32_bf16 v[176:179], v[240:243], v[32:35], v[176:179]
    v_mul_f32 v209, v10, v209
    v_mul_f32 v214, v210, v214
    v_mul_f32 v210, v10, v210
    v_mfma_f32_16x16x32_bf16 v[184:187], v[240:243], v[104:107], v[184:187]
    ds_read_b128 v[240:243], v5 offset:12288
    s_waitcnt lgkmcnt(3)
    v_mfma_f32_16x16x32_bf16 v[180:183], v[244:247], v[32:35], v[180:183]
    v_mul_f32 v215, v211, v215
    v_mul_f32 v211, v10, v211
    v_exp_f32 v208, v208
    v_mfma_f32_16x16x32_bf16 v[188:191], v[244:247], v[104:107], v[188:191]
    ds_read_b128 v[244:247], v5 offset:13312
    s_waitcnt lgkmcnt(3)
    v_mfma_f32_16x16x32_bf16 v[176:179], v[248:251], v[36:39], v[176:179]
    v_exp_f32 v209, v209
    v_exp_f32 v210, v210
    v_exp_f32 v211, v211
    v_mfma_f32_16x16x32_bf16 v[184:187], v[248:251], v[108:111], v[184:187]
    ds_read_b128 v[248:251], v5 offset:14336
    s_waitcnt lgkmcnt(3)
    v_mfma_f32_16x16x32_bf16 v[180:183], v[252:255], v[36:39], v[180:183]
    v_fma_f32 v208, v208, v12, v12
    v_fma_f32 v209, v209, v12, v12
    v_fma_f32 v210, v210, v12, v12
    v_mfma_f32_16x16x32_bf16 v[188:191], v[252:255], v[108:111], v[188:191]
    ds_read_b128 v[252:255], v5 offset:15360
    s_waitcnt lgkmcnt(3)
    v_mfma_f32_16x16x32_bf16 v[176:179], v[240:243], v[40:43], v[176:179]
    v_fma_f32 v211, v211, v12, v12
    v_rcp_f32 v208, v208
    v_rcp_f32 v209, v209
    v_rcp_f32 v210, v210
    v_mfma_f32_16x16x32_bf16 v[184:187], v[240:243], v[112:115], v[184:187]
    ds_read_b128 v[240:243], v5 offset:16384
    s_waitcnt lgkmcnt(3)
    v_mfma_f32_16x16x32_bf16 v[180:183], v[244:247], v[40:43], v[180:183]
    v_rcp_f32 v211, v211
    v_mul_f32 v212, v212, v208
    v_mul_f32 v213, v213, v209
    v_mfma_f32_16x16x32_bf16 v[188:191], v[244:247], v[112:115], v[188:191]
    ds_read_b128 v[244:247], v5 offset:17408
    s_waitcnt lgkmcnt(3)
    v_mfma_f32_16x16x32_bf16 v[176:179], v[248:251], v[44:47], v[176:179]
    v_mul_f32 v214, v214, v210
    v_mul_f32 v215, v215, v211
    v_cvt_pk_bf16_f32 v234, v212, v213
    v_mfma_f32_16x16x32_bf16 v[184:187], v[248:251], v[116:119], v[184:187]
    ds_read_b128 v[248:251], v5 offset:18432
    s_waitcnt lgkmcnt(3)
    v_mfma_f32_16x16x32_bf16 v[180:183], v[252:255], v[44:47], v[180:183]
    v_cvt_pk_bf16_f32 v235, v214, v215
    buffer_store_dwordx4 v[232:235], v1, s[12:15], s33 offen offset:1024 sc1
    v_fmac_f32 v216, v9, v224
    v_mfma_f32_16x16x32_bf16 v[188:191], v[252:255], v[116:119], v[188:191]
    ds_read_b128 v[252:255], v5 offset:19456
    s_waitcnt lgkmcnt(3)
    v_mfma_f32_16x16x32_bf16 v[176:179], v[240:243], v[48:51], v[176:179]
    v_fmac_f32 v220, v9, v228
    v_fmac_f32 v217, v9, v225
    v_fmac_f32 v221, v9, v229
    v_mfma_f32_16x16x32_bf16 v[184:187], v[240:243], v[120:123], v[184:187]
    ds_read_b128 v[240:243], v5 offset:20480
    s_waitcnt lgkmcnt(3)
    v_mfma_f32_16x16x32_bf16 v[180:183], v[244:247], v[48:51], v[180:183]
    v_fmac_f32 v218, v9, v226
    v_fmac_f32 v222, v9, v230
    v_fmac_f32 v219, v9, v227
    v_mfma_f32_16x16x32_bf16 v[188:191], v[244:247], v[120:123], v[188:191]
    ds_read_b128 v[244:247], v5 offset:21504
    s_waitcnt lgkmcnt(3)
    v_mfma_f32_16x16x32_bf16 v[176:179], v[248:251], v[52:55], v[176:179]
    v_fmac_f32 v223, v9, v231
    v_mul_f32 v220, v216, v220
    v_mul_f32 v216, v11, v216
    v_mfma_f32_16x16x32_bf16 v[184:187], v[248:251], v[124:127], v[184:187]
    ds_read_b128 v[248:251], v5 offset:22528
    s_waitcnt lgkmcnt(3)
    v_mfma_f32_16x16x32_bf16 v[180:183], v[252:255], v[52:55], v[180:183]
    v_mul_f32 v221, v217, v221
    v_mul_f32 v217, v11, v217
    v_mul_f32 v222, v218, v222
    v_mfma_f32_16x16x32_bf16 v[188:191], v[252:255], v[124:127], v[188:191]
    ds_read_b128 v[252:255], v5 offset:23552
    s_waitcnt lgkmcnt(3)
    v_mfma_f32_16x16x32_bf16 v[176:179], v[240:243], v[56:59], v[176:179]
    v_mul_f32 v218, v11, v218
    v_mul_f32 v223, v219, v223
    v_mul_f32 v219, v11, v219
    v_exp_f32 v216, v216
    v_mfma_f32_16x16x32_bf16 v[184:187], v[240:243], v[128:131], v[184:187]
    ds_read_b128 v[240:243], v5 offset:24576
    s_waitcnt lgkmcnt(3)
    v_mfma_f32_16x16x32_bf16 v[180:183], v[244:247], v[56:59], v[180:183]
    v_exp_f32 v217, v217
    v_exp_f32 v218, v218
    v_exp_f32 v219, v219
    v_mfma_f32_16x16x32_bf16 v[188:191], v[244:247], v[128:131], v[188:191]
    ds_read_b128 v[244:247], v5 offset:25600
    s_waitcnt lgkmcnt(3)
    v_mfma_f32_16x16x32_bf16 v[176:179], v[248:251], v[60:63], v[176:179]
    v_fma_f32 v216, v216, v13, v13
    v_fma_f32 v217, v217, v13, v13
    v_fma_f32 v218, v218, v13, v13
    v_mfma_f32_16x16x32_bf16 v[184:187], v[248:251], v[132:135], v[184:187]
    ds_read_b128 v[248:251], v5 offset:26624
    s_waitcnt lgkmcnt(3)
    v_mfma_f32_16x16x32_bf16 v[180:183], v[252:255], v[60:63], v[180:183]
    v_fma_f32 v219, v219, v13, v13
    v_rcp_f32 v216, v216
    v_rcp_f32 v217, v217
    v_mfma_f32_16x16x32_bf16 v[188:191], v[252:255], v[132:135], v[188:191]
    ds_read_b128 v[252:255], v5 offset:27648
    s_waitcnt lgkmcnt(3)
    v_mfma_f32_16x16x32_bf16 v[176:179], v[240:243], v[64:67], v[176:179]
    v_rcp_f32 v218, v218
    v_rcp_f32 v219, v219
    v_mul_f32 v220, v220, v216
    v_mfma_f32_16x16x32_bf16 v[184:187], v[240:243], v[136:139], v[184:187]
    ds_read_b128 v[240:243], v5 offset:28672
    s_waitcnt lgkmcnt(3)
    v_mfma_f32_16x16x32_bf16 v[180:183], v[244:247], v[64:67], v[180:183]
    v_mul_f32 v221, v221, v217
    v_mul_f32 v222, v222, v218
    v_mul_f32 v223, v223, v219
    v_mfma_f32_16x16x32_bf16 v[188:191], v[244:247], v[136:139], v[188:191]
    ds_read_b128 v[244:247], v5 offset:29696
    s_waitcnt lgkmcnt(3)
    v_mfma_f32_16x16x32_bf16 v[176:179], v[248:251], v[68:71], v[176:179]
    v_cvt_pk_bf16_f32 v238, v220, v221
    v_cvt_pk_bf16_f32 v239, v222, v223
    buffer_store_dwordx4 v[236:239], v1, s[12:15], s34 offen offset:1024 sc1
    v_mfma_f32_16x16x32_bf16 v[184:187], v[248:251], v[140:143], v[184:187]
    ds_read_b128 v[248:251], v5 offset:30720
    s_waitcnt lgkmcnt(3)
    v_mfma_f32_16x16x32_bf16 v[180:183], v[252:255], v[68:71], v[180:183]
    v_mfma_f32_16x16x32_bf16 v[188:191], v[252:255], v[140:143], v[188:191]
    ds_read_b128 v[252:255], v5 offset:31744
    s_waitcnt lgkmcnt(3)
    v_mfma_f32_16x16x32_bf16 v[176:179], v[240:243], v[72:75], v[176:179]
    ds_read_b128 v[224:227], v15 offset:512
    ds_read_b128 v[228:231], v15 offset:576
    v_mfma_f32_16x16x32_bf16 v[184:187], v[240:243], v[144:147], v[184:187]
    ds_read_b128 v[240:243], v5 offset:32768
    s_waitcnt lgkmcnt(5)
    v_mfma_f32_16x16x32_bf16 v[180:183], v[244:247], v[72:75], v[180:183]
    s_waitcnt lgkmcnt(1)
    v_mfma_f32_16x16x32_bf16 v[188:191], v[244:247], v[144:147], v[188:191]
    ds_read_b128 v[244:247], v5 offset:33792
    v_mfma_f32_16x16x32_bf16 v[176:179], v[248:251], v[76:79], v[176:179]
    v_fmac_f32 v160, v8, v224
    v_fmac_f32 v164, v8, v228
    v_fmac_f32 v161, v8, v225
    v_mfma_f32_16x16x32_bf16 v[184:187], v[248:251], v[148:151], v[184:187]
    ds_read_b128 v[248:251], v5 offset:34816
    v_mfma_f32_16x16x32_bf16 v[180:183], v[252:255], v[76:79], v[180:183]
    v_fmac_f32 v165, v8, v229
    v_fmac_f32 v162, v8, v226
    v_fmac_f32 v166, v8, v230
    v_mfma_f32_16x16x32_bf16 v[188:191], v[252:255], v[148:151], v[188:191]
    ds_read_b128 v[252:255], v5 offset:35840
    s_waitcnt lgkmcnt(3)
    v_mfma_f32_16x16x32_bf16 v[176:179], v[240:243], v[80:83], v[176:179]
    v_fmac_f32 v163, v8, v227
    v_fmac_f32 v167, v8, v231
    v_mul_f32 v164, v160, v164
    v_mfma_f32_16x16x32_bf16 v[184:187], v[240:243], v[152:155], v[184:187]
    s_waitcnt vmcnt(9)
    s_barrier
    ds_read_b128 v[240:243], v6 offset:0
    s_waitcnt lgkmcnt(3)
    v_mfma_f32_16x16x32_bf16 v[180:183], v[244:247], v[80:83], v[180:183]
    v_mul_f32 v160, v10, v160
    v_mul_f32 v165, v161, v165
    v_mul_f32 v161, v10, v161
    v_mfma_f32_16x16x32_bf16 v[188:191], v[244:247], v[152:155], v[188:191]
    ds_read_b128 v[244:247], v6 offset:1024
    s_waitcnt lgkmcnt(3)
    v_mfma_f32_16x16x32_bf16 v[176:179], v[248:251], v[84:87], v[176:179]
    v_mul_f32 v166, v162, v166
    v_mul_f32 v162, v10, v162
    v_mul_f32 v167, v163, v167
    v_mfma_f32_16x16x32_bf16 v[184:187], v[248:251], v[156:159], v[184:187]
    s_add_u32 m0, s20, 0
    s_add_u32 s26, s21, 294912
    buffer_load_dwordx4 v1, s[8:11], s26 offen offset:0 sc1 lds
    ds_read_b128 v[248:251], v6 offset:2048
    s_waitcnt lgkmcnt(3)
    v_mfma_f32_16x16x32_bf16 v[180:183], v[252:255], v[84:87], v[180:183]
    v_mul_f32 v163, v10, v163
    v_exp_f32 v160, v160
    v_exp_f32 v161, v161
    v_mfma_f32_16x16x32_bf16 v[188:191], v[252:255], v[156:159], v[188:191]
    ds_read_b128 v[252:255], v6 offset:3072
    s_waitcnt lgkmcnt(3)
    v_mfma_f32_16x16x32_bf16 v[192:195], v[240:243], v[16:19], 0
    v_exp_f32 v162, v162
    v_exp_f32 v163, v163
    v_fma_f32 v160, v160, v12, v12
    v_fma_f32 v161, v161, v12, v12
    v_mfma_f32_16x16x32_bf16 v[200:203], v[240:243], v[88:91], 0
    buffer_load_dwordx4 v1, s[8:11], s26 offen offset:1024 sc1 lds
    ds_read_b128 v[240:243], v6 offset:4096
    s_waitcnt lgkmcnt(3)
    v_mfma_f32_16x16x32_bf16 v[196:199], v[244:247], v[16:19], 0
    v_fma_f32 v162, v162, v12, v12
    v_fma_f32 v163, v163, v12, v12
    v_rcp_f32 v160, v160
    v_mfma_f32_16x16x32_bf16 v[204:207], v[244:247], v[88:91], 0
    ds_read_b128 v[244:247], v6 offset:5120
    s_waitcnt lgkmcnt(3)
    v_mfma_f32_16x16x32_bf16 v[192:195], v[248:251], v[20:23], v[192:195]
    v_rcp_f32 v161, v161
    v_rcp_f32 v162, v162
    v_rcp_f32 v163, v163
    v_mfma_f32_16x16x32_bf16 v[200:203], v[248:251], v[92:95], v[200:203]
    buffer_load_dwordx4 v1, s[8:11], s26 offen offset:2048 sc1 lds
    ds_read_b128 v[248:251], v6 offset:6144
    s_waitcnt lgkmcnt(3)
    v_mfma_f32_16x16x32_bf16 v[196:199], v[252:255], v[20:23], v[196:199]
    v_mul_f32 v164, v164, v160
    v_mul_f32 v165, v165, v161
    v_mul_f32 v166, v166, v162
    v_mfma_f32_16x16x32_bf16 v[204:207], v[252:255], v[92:95], v[204:207]
    ds_read_b128 v[252:255], v6 offset:7168
    s_waitcnt lgkmcnt(3)
    v_mfma_f32_16x16x32_bf16 v[192:195], v[240:243], v[24:27], v[192:195]
    v_mul_f32 v167, v167, v163
    v_cvt_pk_bf16_f32 v232, v164, v165
    v_cvt_pk_bf16_f32 v233, v166, v167
    v_mfma_f32_16x16x32_bf16 v[200:203], v[240:243], v[96:99], v[200:203]
    buffer_load_dwordx4 v1, s[8:11], s26 offen offset:3072 sc1 lds
    ds_read_b128 v[240:243], v6 offset:8192
    s_waitcnt lgkmcnt(3)
    v_mfma_f32_16x16x32_bf16 v[196:199], v[244:247], v[24:27], v[196:199]
    v_fmac_f32 v168, v9, v224
    v_fmac_f32 v172, v9, v228
    v_fmac_f32 v169, v9, v225
    v_mfma_f32_16x16x32_bf16 v[204:207], v[244:247], v[96:99], v[204:207]
    ds_read_b128 v[244:247], v6 offset:9216
    s_waitcnt lgkmcnt(3)
    v_mfma_f32_16x16x32_bf16 v[192:195], v[248:251], v[28:31], v[192:195]
    v_fmac_f32 v173, v9, v229
    v_fmac_f32 v170, v9, v226
    v_fmac_f32 v174, v9, v230
    v_mfma_f32_16x16x32_bf16 v[200:203], v[248:251], v[100:103], v[200:203]
    s_add_u32 m0, m0, 4096
    s_add_u32 s26, s26, 4096
    s_mov_b64 exec, s[22:23]
    buffer_load_dwordx4 v1, s[8:11], s26 offen sc1 lds
    s_mov_b64 exec, -1
    ds_read_b128 v[248:251], v6 offset:10240
    s_waitcnt lgkmcnt(3)
    v_mfma_f32_16x16x32_bf16 v[196:199], v[252:255], v[28:31], v[196:199]
    v_fmac_f32 v171, v9, v227
    v_fmac_f32 v175, v9, v231
    v_mul_f32 v172, v168, v172
    v_mfma_f32_16x16x32_bf16 v[204:207], v[252:255], v[100:103], v[204:207]
    ds_read_b128 v[252:255], v6 offset:11264
    s_waitcnt lgkmcnt(3)
    v_mfma_f32_16x16x32_bf16 v[192:195], v[240:243], v[32:35], v[192:195]
    v_mul_f32 v168, v11, v168
    v_mul_f32 v173, v169, v173
    v_mul_f32 v169, v11, v169
    v_mul_f32 v174, v170, v174
    v_mfma_f32_16x16x32_bf16 v[200:203], v[240:243], v[104:107], v[200:203]
    ds_read_b128 v[240:243], v6 offset:12288
    s_waitcnt lgkmcnt(3)
    v_mfma_f32_16x16x32_bf16 v[196:199], v[244:247], v[32:35], v[196:199]
    v_mul_f32 v170, v11, v170
    v_mul_f32 v175, v171, v175
    v_mul_f32 v171, v11, v171
    v_mfma_f32_16x16x32_bf16 v[204:207], v[244:247], v[104:107], v[204:207]
    ds_read_b128 v[244:247], v6 offset:13312
    s_waitcnt lgkmcnt(3)
    v_mfma_f32_16x16x32_bf16 v[192:195], v[248:251], v[36:39], v[192:195]
    v_exp_f32 v168, v168
    v_exp_f32 v169, v169
    v_exp_f32 v170, v170
    v_mfma_f32_16x16x32_bf16 v[200:203], v[248:251], v[108:111], v[200:203]
    ds_read_b128 v[248:251], v6 offset:14336
    s_waitcnt lgkmcnt(3)
    v_mfma_f32_16x16x32_bf16 v[196:199], v[252:255], v[36:39], v[196:199]
    v_exp_f32 v171, v171
    v_fma_f32 v168, v168, v13, v13
    v_fma_f32 v169, v169, v13, v13
    v_mfma_f32_16x16x32_bf16 v[204:207], v[252:255], v[108:111], v[204:207]
    ds_read_b128 v[252:255], v6 offset:15360
    s_waitcnt lgkmcnt(3)
    v_mfma_f32_16x16x32_bf16 v[192:195], v[240:243], v[40:43], v[192:195]
    v_fma_f32 v170, v170, v13, v13
    v_fma_f32 v171, v171, v13, v13
    v_rcp_f32 v168, v168
    v_mfma_f32_16x16x32_bf16 v[200:203], v[240:243], v[112:115], v[200:203]
    ds_read_b128 v[240:243], v6 offset:16384
    s_waitcnt lgkmcnt(3)
    v_mfma_f32_16x16x32_bf16 v[196:199], v[244:247], v[40:43], v[196:199]
    v_rcp_f32 v169, v169
    v_rcp_f32 v170, v170
    v_rcp_f32 v171, v171
    v_mfma_f32_16x16x32_bf16 v[204:207], v[244:247], v[112:115], v[204:207]
    ds_read_b128 v[244:247], v6 offset:17408
    s_waitcnt lgkmcnt(3)
    v_mfma_f32_16x16x32_bf16 v[192:195], v[248:251], v[44:47], v[192:195]
    v_mul_f32 v172, v172, v168
    v_mul_f32 v173, v173, v169
    v_mul_f32 v174, v174, v170
    v_mfma_f32_16x16x32_bf16 v[200:203], v[248:251], v[116:119], v[200:203]
    ds_read_b128 v[248:251], v6 offset:18432
    s_waitcnt lgkmcnt(3)
    v_mfma_f32_16x16x32_bf16 v[196:199], v[252:255], v[44:47], v[196:199]
    v_mul_f32 v175, v175, v171
    v_cvt_pk_bf16_f32 v236, v172, v173
    v_cvt_pk_bf16_f32 v237, v174, v175
    v_mfma_f32_16x16x32_bf16 v[204:207], v[252:255], v[116:119], v[204:207]
    ds_read_b128 v[252:255], v6 offset:19456
    s_waitcnt lgkmcnt(3)
    v_mfma_f32_16x16x32_bf16 v[192:195], v[240:243], v[48:51], v[192:195]
    ds_read_b128 v[224:227], v15 offset:640
    v_mfma_f32_16x16x32_bf16 v[200:203], v[240:243], v[120:123], v[200:203]
    ds_read_b128 v[240:243], v6 offset:20480
    s_waitcnt lgkmcnt(4)
    v_mfma_f32_16x16x32_bf16 v[196:199], v[244:247], v[48:51], v[196:199]
    ds_read_b128 v[228:231], v15 offset:704
    v_mfma_f32_16x16x32_bf16 v[204:207], v[244:247], v[120:123], v[204:207]
    ds_read_b128 v[244:247], v6 offset:21504
    s_waitcnt lgkmcnt(5)
    v_mfma_f32_16x16x32_bf16 v[192:195], v[248:251], v[52:55], v[192:195]
    s_waitcnt lgkmcnt(1)
    v_mfma_f32_16x16x32_bf16 v[200:203], v[248:251], v[124:127], v[200:203]
    ds_read_b128 v[248:251], v6 offset:22528
    v_mfma_f32_16x16x32_bf16 v[196:199], v[252:255], v[52:55], v[196:199]
    v_fmac_f32 v176, v8, v224
    v_fmac_f32 v180, v8, v228
    v_fmac_f32 v177, v8, v225
    v_mfma_f32_16x16x32_bf16 v[204:207], v[252:255], v[124:127], v[204:207]
    ds_read_b128 v[252:255], v6 offset:23552
    v_mfma_f32_16x16x32_bf16 v[192:195], v[240:243], v[56:59], v[192:195]
    v_fmac_f32 v181, v8, v229
    v_fmac_f32 v178, v8, v226
    v_fmac_f32 v182, v8, v230
    v_mfma_f32_16x16x32_bf16 v[200:203], v[240:243], v[128:131], v[200:203]
    ds_read_b128 v[240:243], v6 offset:24576
    s_waitcnt lgkmcnt(3)
    v_mfma_f32_16x16x32_bf16 v[196:199], v[244:247], v[56:59], v[196:199]
    v_fmac_f32 v179, v8, v227
    v_fmac_f32 v183, v8, v231
    v_mul_f32 v180, v176, v180
    v_mfma_f32_16x16x32_bf16 v[204:207], v[244:247], v[128:131], v[204:207]
    ds_read_b128 v[244:247], v6 offset:25600
    s_waitcnt lgkmcnt(3)
    v_mfma_f32_16x16x32_bf16 v[192:195], v[248:251], v[60:63], v[192:195]
    v_mul_f32 v176, v10, v176
    v_mul_f32 v181, v177, v181
    v_mul_f32 v177, v10, v177
    v_mfma_f32_16x16x32_bf16 v[200:203], v[248:251], v[132:135], v[200:203]
    ds_read_b128 v[248:251], v6 offset:26624
    s_waitcnt lgkmcnt(3)
    v_mfma_f32_16x16x32_bf16 v[196:199], v[252:255], v[60:63], v[196:199]
    v_mul_f32 v182, v178, v182
    v_mul_f32 v178, v10, v178
    v_mul_f32 v183, v179, v183
    v_mfma_f32_16x16x32_bf16 v[204:207], v[252:255], v[132:135], v[204:207]
    ds_read_b128 v[252:255], v6 offset:27648
    s_waitcnt lgkmcnt(3)
    v_mfma_f32_16x16x32_bf16 v[192:195], v[240:243], v[64:67], v[192:195]
    v_mul_f32 v179, v10, v179
    v_exp_f32 v176, v176
    v_exp_f32 v177, v177
    v_exp_f32 v178, v178
    v_mfma_f32_16x16x32_bf16 v[200:203], v[240:243], v[136:139], v[200:203]
    ds_read_b128 v[240:243], v6 offset:28672
    s_waitcnt lgkmcnt(3)
    v_mfma_f32_16x16x32_bf16 v[196:199], v[244:247], v[64:67], v[196:199]
    v_exp_f32 v179, v179
    v_fma_f32 v176, v176, v12, v12
    v_fma_f32 v177, v177, v12, v12
    v_mfma_f32_16x16x32_bf16 v[204:207], v[244:247], v[136:139], v[204:207]
    ds_read_b128 v[244:247], v6 offset:29696
    s_waitcnt lgkmcnt(3)
    v_mfma_f32_16x16x32_bf16 v[192:195], v[248:251], v[68:71], v[192:195]
    v_fma_f32 v178, v178, v12, v12
    v_fma_f32 v179, v179, v12, v12
    v_rcp_f32 v176, v176
    v_mfma_f32_16x16x32_bf16 v[200:203], v[248:251], v[140:143], v[200:203]
    ds_read_b128 v[248:251], v6 offset:30720
    s_waitcnt lgkmcnt(3)
    v_mfma_f32_16x16x32_bf16 v[196:199], v[252:255], v[68:71], v[196:199]
    v_rcp_f32 v177, v177
    v_rcp_f32 v178, v178
    v_rcp_f32 v179, v179
    v_mfma_f32_16x16x32_bf16 v[204:207], v[252:255], v[140:143], v[204:207]
    ds_read_b128 v[252:255], v6 offset:31744
    s_waitcnt lgkmcnt(3)
    v_mfma_f32_16x16x32_bf16 v[192:195], v[240:243], v[72:75], v[192:195]
    v_mul_f32 v180, v180, v176
    v_mul_f32 v181, v181, v177
    v_mul_f32 v182, v182, v178
    v_mfma_f32_16x16x32_bf16 v[200:203], v[240:243], v[144:147], v[200:203]
    ds_read_b128 v[240:243], v6 offset:32768
    s_waitcnt lgkmcnt(3)
    v_mfma_f32_16x16x32_bf16 v[196:199], v[244:247], v[72:75], v[196:199]
    v_mul_f32 v183, v183, v179
    v_cvt_pk_bf16_f32 v234, v180, v181
    v_cvt_pk_bf16_f32 v235, v182, v183
    v_mfma_f32_16x16x32_bf16 v[204:207], v[244:247], v[144:147], v[204:207]
    ds_read_b128 v[244:247], v6 offset:33792
    s_waitcnt lgkmcnt(3)
    v_mfma_f32_16x16x32_bf16 v[192:195], v[248:251], v[76:79], v[192:195]
    buffer_store_dwordx4 v[232:235], v1, s[12:15], s33 offen offset:2048 sc1
    v_fmac_f32 v184, v9, v224
    v_fmac_f32 v188, v9, v228
    v_mfma_f32_16x16x32_bf16 v[200:203], v[248:251], v[148:151], v[200:203]
    ds_read_b128 v[248:251], v6 offset:34816
    s_waitcnt lgkmcnt(3)
    v_mfma_f32_16x16x32_bf16 v[196:199], v[252:255], v[76:79], v[196:199]
    v_fmac_f32 v185, v9, v225
    v_fmac_f32 v189, v9, v229
    v_fmac_f32 v186, v9, v226
    v_mfma_f32_16x16x32_bf16 v[204:207], v[252:255], v[148:151], v[204:207]
    ds_read_b128 v[252:255], v6 offset:35840
    s_waitcnt lgkmcnt(3)
    v_mfma_f32_16x16x32_bf16 v[192:195], v[240:243], v[80:83], v[192:195]
    v_fmac_f32 v190, v9, v230
    v_fmac_f32 v187, v9, v227
    v_fmac_f32 v191, v9, v231
    v_mul_f32 v188, v184, v188
    v_mfma_f32_16x16x32_bf16 v[200:203], v[240:243], v[152:155], v[200:203]
    s_waitcnt vmcnt(8)
    s_barrier
    ds_read_b128 v[240:243], v7 offset:0
    s_waitcnt lgkmcnt(3)
    v_mfma_f32_16x16x32_bf16 v[196:199], v[244:247], v[80:83], v[196:199]
    v_mul_f32 v184, v11, v184
    v_mul_f32 v189, v185, v189
    v_mul_f32 v185, v11, v185
    v_mfma_f32_16x16x32_bf16 v[204:207], v[244:247], v[152:155], v[204:207]
    ds_read_b128 v[244:247], v7 offset:1024
    s_waitcnt lgkmcnt(3)
    v_mfma_f32_16x16x32_bf16 v[192:195], v[248:251], v[84:87], v[192:195]
    v_mul_f32 v190, v186, v190
    v_mul_f32 v186, v11, v186
    v_mul_f32 v191, v187, v191
    v_mfma_f32_16x16x32_bf16 v[200:203], v[248:251], v[156:159], v[200:203]
    s_add_u32 m0, s20, 36864
    s_add_u32 s26, s41, s20
    s_add_u32 s26, s26, 0
    buffer_load_dwordx4 v1, s[8:11], s26 offen offset:0 sc1 lds
    ds_read_b128 v[248:251], v7 offset:2048
    s_waitcnt lgkmcnt(3)
    v_mfma_f32_16x16x32_bf16 v[196:199], v[252:255], v[84:87], v[196:199]
    v_mul_f32 v187, v11, v187
    v_exp_f32 v184, v184
    v_exp_f32 v185, v185
    v_mfma_f32_16x16x32_bf16 v[204:207], v[252:255], v[156:159], v[204:207]
    ds_read_b128 v[252:255], v7 offset:3072
    s_waitcnt lgkmcnt(3)
    v_mfma_f32_16x16x32_bf16 v[208:211], v[240:243], v[16:19], 0
    v_exp_f32 v186, v186
    v_exp_f32 v187, v187
    v_fma_f32 v184, v184, v13, v13
    v_mfma_f32_16x16x32_bf16 v[216:219], v[240:243], v[88:91], 0
    buffer_load_dwordx4 v1, s[8:11], s26 offen offset:1024 sc1 lds
    ds_read_b128 v[240:243], v7 offset:4096
    s_waitcnt lgkmcnt(3)
    v_mfma_f32_16x16x32_bf16 v[212:215], v[244:247], v[16:19], 0
    v_fma_f32 v185, v185, v13, v13
    v_fma_f32 v186, v186, v13, v13
    v_fma_f32 v187, v187, v13, v13
    v_mfma_f32_16x16x32_bf16 v[220:223], v[244:247], v[88:91], 0
    ds_read_b128 v[244:247], v7 offset:5120
    s_waitcnt lgkmcnt(3)
    v_mfma_f32_16x16x32_bf16 v[208:211], v[248:251], v[20:23], v[208:211]
    v_rcp_f32 v184, v184
    v_rcp_f32 v185, v185
    v_rcp_f32 v186, v186
    v_mfma_f32_16x16x32_bf16 v[216:219], v[248:251], v[92:95], v[216:219]
    buffer_load_dwordx4 v1, s[8:11], s26 offen offset:2048 sc1 lds
    ds_read_b128 v[248:251], v7 offset:6144
    s_waitcnt lgkmcnt(3)
    v_mfma_f32_16x16x32_bf16 v[212:215], v[252:255], v[20:23], v[212:215]
    v_rcp_f32 v187, v187
    v_mul_f32 v188, v188, v184
    v_mul_f32 v189, v189, v185
    v_mfma_f32_16x16x32_bf16 v[220:223], v[252:255], v[92:95], v[220:223]
    ds_read_b128 v[252:255], v7 offset:7168
    s_waitcnt lgkmcnt(3)
    v_mfma_f32_16x16x32_bf16 v[208:211], v[240:243], v[24:27], v[208:211]
    v_mul_f32 v190, v190, v186
    v_mul_f32 v191, v191, v187
    v_cvt_pk_bf16_f32 v238, v188, v189
    v_cvt_pk_bf16_f32 v239, v190, v191
    v_mfma_f32_16x16x32_bf16 v[216:219], v[240:243], v[96:99], v[216:219]
    buffer_load_dwordx4 v1, s[8:11], s26 offen offset:3072 sc1 lds
    ds_read_b128 v[240:243], v7 offset:8192
    s_waitcnt lgkmcnt(3)
    v_mfma_f32_16x16x32_bf16 v[212:215], v[244:247], v[24:27], v[212:215]
    buffer_store_dwordx4 v[236:239], v1, s[12:15], s34 offen offset:2048 sc1
    v_mfma_f32_16x16x32_bf16 v[220:223], v[244:247], v[96:99], v[220:223]
    ds_read_b128 v[244:247], v7 offset:9216
    s_waitcnt lgkmcnt(3)
    v_mfma_f32_16x16x32_bf16 v[208:211], v[248:251], v[28:31], v[208:211]
    ds_read_b128 v[224:227], v15 offset:768
    ds_read_b128 v[228:231], v15 offset:832
    v_mfma_f32_16x16x32_bf16 v[216:219], v[248:251], v[100:103], v[216:219]
    s_add_u32 m0, m0, 4096
    s_add_u32 s26, s26, 4096
    s_mov_b64 exec, s[22:23]
    buffer_load_dwordx4 v1, s[8:11], s26 offen sc1 lds
    s_mov_b64 exec, -1
    ds_read_b128 v[248:251], v7 offset:10240
    s_waitcnt lgkmcnt(5)
    v_mfma_f32_16x16x32_bf16 v[212:215], v[252:255], v[28:31], v[212:215]
    v_mfma_f32_16x16x32_bf16 v[220:223], v[252:255], v[100:103], v[220:223]
    ds_read_b128 v[252:255], v7 offset:11264
    s_waitcnt lgkmcnt(5)
    v_mfma_f32_16x16x32_bf16 v[208:211], v[240:243], v[32:35], v[208:211]
    s_waitcnt lgkmcnt(2)
    v_fmac_f32 v192, v8, v224
    v_mfma_f32_16x16x32_bf16 v[216:219], v[240:243], v[104:107], v[216:219]
    ds_read_b128 v[240:243], v7 offset:12288
    v_mfma_f32_16x16x32_bf16 v[212:215], v[244:247], v[32:35], v[212:215]
    v_fmac_f32 v196, v8, v228
    v_fmac_f32 v193, v8, v225
    v_fmac_f32 v197, v8, v229
    v_mfma_f32_16x16x32_bf16 v[220:223], v[244:247], v[104:107], v[220:223]
    ds_read_b128 v[244:247], v7 offset:13312
    s_waitcnt lgkmcnt(3)
    v_mfma_f32_16x16x32_bf16 v[208:211], v[248:251], v[36:39], v[208:211]
    v_fmac_f32 v194, v8, v226
    v_fmac_f32 v198, v8, v230
    v_fmac_f32 v195, v8, v227
    v_mfma_f32_16x16x32_bf16 v[216:219], v[248:251], v[108:111], v[216:219]
    ds_read_b128 v[248:251], v7 offset:14336
    s_waitcnt lgkmcnt(3)
    v_mfma_f32_16x16x32_bf16 v[212:215], v[252:255], v[36:39], v[212:215]
    v_fmac_f32 v199, v8, v231
    v_mul_f32 v196, v192, v196
    v_mul_f32 v192, v10, v192
    v_mfma_f32_16x16x32_bf16 v[220:223], v[252:255], v[108:111], v[220:223]
    ds_read_b128 v[252:255], v7 offset:15360
    s_waitcnt lgkmcnt(3)
    v_mfma_f32_16x16x32_bf16 v[208:211], v[240:243], v[40:43], v[208:211]
    v_mul_f32 v197, v193, v197
    v_mul_f32 v193, v10, v193
    v_mul_f32 v198, v194, v198
    v_mul_f32 v194, v10, v194
    v_mfma_f32_16x16x32_bf16 v[216:219], v[240:243], v[112:115], v[216:219]
    ds_read_b128 v[240:243], v7 offset:16384
    s_waitcnt lgkmcnt(3)
    v_mfma_f32_16x16x32_bf16 v[212:215], v[244:247], v[40:43], v[212:215]
    v_mul_f32 v199, v195, v199
    v_mul_f32 v195, v10, v195
    v_exp_f32 v192, v192
    v_mfma_f32_16x16x32_bf16 v[220:223], v[244:247], v[112:115], v[220:223]
    ds_read_b128 v[244:247], v7 offset:17408
    s_waitcnt lgkmcnt(3)
    v_mfma_f32_16x16x32_bf16 v[208:211], v[248:251], v[44:47], v[208:211]
    v_exp_f32 v193, v193
    v_exp_f32 v194, v194
    v_exp_f32 v195, v195
    v_mfma_f32_16x16x32_bf16 v[216:219], v[248:251], v[116:119], v[216:219]
    ds_read_b128 v[248:251], v7 offset:18432
    s_waitcnt lgkmcnt(3)
    v_mfma_f32_16x16x32_bf16 v[212:215], v[252:255], v[44:47], v[212:215]
    v_fma_f32 v192, v192, v12, v12
    v_fma_f32 v193, v193, v12, v12
    v_fma_f32 v194, v194, v12, v12
    v_mfma_f32_16x16x32_bf16 v[220:223], v[252:255], v[116:119], v[220:223]
    ds_read_b128 v[252:255], v7 offset:19456
    s_waitcnt lgkmcnt(3)
    v_mfma_f32_16x16x32_bf16 v[208:211], v[240:243], v[48:51], v[208:211]
    v_fma_f32 v195, v195, v12, v12
    v_rcp_f32 v192, v192
    v_rcp_f32 v193, v193
    v_mfma_f32_16x16x32_bf16 v[216:219], v[240:243], v[120:123], v[216:219]
    ds_read_b128 v[240:243], v7 offset:20480
    s_waitcnt lgkmcnt(3)
    v_mfma_f32_16x16x32_bf16 v[212:215], v[244:247], v[48:51], v[212:215]
    v_rcp_f32 v194, v194
    v_rcp_f32 v195, v195
    v_mul_f32 v196, v196, v192
    v_mfma_f32_16x16x32_bf16 v[220:223], v[244:247], v[120:123], v[220:223]
    ds_read_b128 v[244:247], v7 offset:21504
    s_waitcnt lgkmcnt(3)
    v_mfma_f32_16x16x32_bf16 v[208:211], v[248:251], v[52:55], v[208:211]
    v_mul_f32 v197, v197, v193
    v_mul_f32 v198, v198, v194
    v_mul_f32 v199, v199, v195
    v_mfma_f32_16x16x32_bf16 v[216:219], v[248:251], v[124:127], v[216:219]
    ds_read_b128 v[248:251], v7 offset:22528
    s_waitcnt lgkmcnt(3)
    v_mfma_f32_16x16x32_bf16 v[212:215], v[252:255], v[52:55], v[212:215]
    v_cvt_pk_bf16_f32 v232, v196, v197
    v_cvt_pk_bf16_f32 v233, v198, v199
    v_fmac_f32 v200, v9, v224
    v_mfma_f32_16x16x32_bf16 v[220:223], v[252:255], v[124:127], v[220:223]
    ds_read_b128 v[252:255], v7 offset:23552
    s_waitcnt lgkmcnt(3)
    v_mfma_f32_16x16x32_bf16 v[208:211], v[240:243], v[56:59], v[208:211]
    v_fmac_f32 v204, v9, v228
    v_fmac_f32 v201, v9, v225
    v_fmac_f32 v205, v9, v229
    v_fmac_f32 v202, v9, v226
    v_mfma_f32_16x16x32_bf16 v[216:219], v[240:243], v[128:131], v[216:219]
    ds_read_b128 v[240:243], v7 offset:24576
    s_waitcnt lgkmcnt(3)
    v_mfma_f32_16x16x32_bf16 v[212:215], v[244:247], v[56:59], v[212:215]
    v_fmac_f32 v206, v9, v230
    v_fmac_f32 v203, v9, v227
    v_fmac_f32 v207, v9, v231
    v_mfma_f32_16x16x32_bf16 v[220:223], v[244:247], v[128:131], v[220:223]
    ds_read_b128 v[244:247], v7 offset:25600
    s_waitcnt lgkmcnt(3)
    v_mfma_f32_16x16x32_bf16 v[208:211], v[248:251], v[60:63], v[208:211]
    v_mul_f32 v204, v200, v204
    v_mul_f32 v200, v11, v200
    v_mul_f32 v205, v201, v205
    v_mfma_f32_16x16x32_bf16 v[216:219], v[248:251], v[132:135], v[216:219]
    ds_read_b128 v[248:251], v7 offset:26624
    s_waitcnt lgkmcnt(3)
    v_mfma_f32_16x16x32_bf16 v[212:215], v[252:255], v[60:63], v[212:215]
    v_mul_f32 v201, v11, v201
    v_mul_f32 v206, v202, v206
    v_mul_f32 v202, v11, v202
    v_mfma_f32_16x16x32_bf16 v[220:223], v[252:255], v[132:135], v[220:223]
    ds_read_b128 v[252:255], v7 offset:27648
    s_waitcnt lgkmcnt(3)
    v_mfma_f32_16x16x32_bf16 v[208:211], v[240:243], v[64:67], v[208:211]
    v_mul_f32 v207, v203, v207
    v_mul_f32 v203, v11, v203
    v_exp_f32 v200, v200
    v_mfma_f32_16x16x32_bf16 v[216:219], v[240:243], v[136:139], v[216:219]
    ds_read_b128 v[240:243], v7 offset:28672
    s_waitcnt lgkmcnt(3)
    v_mfma_f32_16x16x32_bf16 v[212:215], v[244:247], v[64:67], v[212:215]
    v_exp_f32 v201, v201
    v_exp_f32 v202, v202
    v_exp_f32 v203, v203
    v_mfma_f32_16x16x32_bf16 v[220:223], v[244:247], v[136:139], v[220:223]
    ds_read_b128 v[244:247], v7 offset:29696
    s_waitcnt lgkmcnt(3)
    v_mfma_f32_16x16x32_bf16 v[208:211], v[248:251], v[68:71], v[208:211]
    v_fma_f32 v200, v200, v13, v13
    v_fma_f32 v201, v201, v13, v13
    v_fma_f32 v202, v202, v13, v13
    v_mfma_f32_16x16x32_bf16 v[216:219], v[248:251], v[140:143], v[216:219]
    ds_read_b128 v[248:251], v7 offset:30720
    s_waitcnt lgkmcnt(3)
    v_mfma_f32_16x16x32_bf16 v[212:215], v[252:255], v[68:71], v[212:215]
    v_fma_f32 v203, v203, v13, v13
    v_rcp_f32 v200, v200
    v_rcp_f32 v201, v201
    v_mfma_f32_16x16x32_bf16 v[220:223], v[252:255], v[140:143], v[220:223]
    ds_read_b128 v[252:255], v7 offset:31744
    s_waitcnt lgkmcnt(3)
    v_mfma_f32_16x16x32_bf16 v[208:211], v[240:243], v[72:75], v[208:211]
    v_rcp_f32 v202, v202
    v_rcp_f32 v203, v203
    v_mul_f32 v204, v204, v200
    v_mul_f32 v205, v205, v201
    v_mfma_f32_16x16x32_bf16 v[216:219], v[240:243], v[144:147], v[216:219]
    ds_read_b128 v[240:243], v7 offset:32768
    s_waitcnt lgkmcnt(3)
    v_mfma_f32_16x16x32_bf16 v[212:215], v[244:247], v[72:75], v[212:215]
    v_mul_f32 v206, v206, v202
    v_mul_f32 v207, v207, v203
    v_cvt_pk_bf16_f32 v236, v204, v205
    v_mfma_f32_16x16x32_bf16 v[220:223], v[244:247], v[144:147], v[220:223]
    ds_read_b128 v[244:247], v7 offset:33792
    s_waitcnt lgkmcnt(3)
    v_mfma_f32_16x16x32_bf16 v[208:211], v[248:251], v[76:79], v[208:211]
    v_cvt_pk_bf16_f32 v237, v206, v207
    v_mfma_f32_16x16x32_bf16 v[216:219], v[248:251], v[148:151], v[216:219]
    ds_read_b128 v[248:251], v7 offset:34816
    s_waitcnt lgkmcnt(3)
    v_mfma_f32_16x16x32_bf16 v[212:215], v[252:255], v[76:79], v[212:215]
    v_mfma_f32_16x16x32_bf16 v[220:223], v[252:255], v[148:151], v[220:223]
    ds_read_b128 v[252:255], v7 offset:35840
    s_waitcnt lgkmcnt(3)
    v_mfma_f32_16x16x32_bf16 v[208:211], v[240:243], v[80:83], v[208:211]
    v_mfma_f32_16x16x32_bf16 v[216:219], v[240:243], v[152:155], v[216:219]
    s_waitcnt vmcnt(0)
    s_barrier
    s_cmp_lg_u32 s16, 0
    s_cbranch_scc1 Lm108_early
    v_mov_b32 v2, s79
    v_mov_b32 v14, s80
    s_mov_b64 exec, 1
    buffer_store_dword v14, v2, s[12:15], s38 offen sc1
    s_mov_b64 exec, -1
Lm108_early:
    ds_read_b128 v[240:243], v4 offset:0
    s_waitcnt lgkmcnt(3)
    v_mfma_f32_16x16x32_bf16 v[212:215], v[244:247], v[80:83], v[212:215]
    v_mfma_f32_16x16x32_bf16 v[220:223], v[244:247], v[152:155], v[220:223]
    ds_read_b128 v[244:247], v4 offset:1024
    s_waitcnt lgkmcnt(3)
    v_mfma_f32_16x16x32_bf16 v[208:211], v[248:251], v[84:87], v[208:211]
    v_mfma_f32_16x16x32_bf16 v[216:219], v[248:251], v[156:159], v[216:219]
    s_add_u32 m0, s20, 73728
    s_add_u32 s26, s41, s20
    s_add_u32 s26, s26, 36864
    buffer_load_dwordx4 v1, s[8:11], s26 offen offset:0 sc1 lds
    ds_read_b128 v[248:251], v4 offset:2048
    s_waitcnt lgkmcnt(3)
    v_mfma_f32_16x16x32_bf16 v[212:215], v[252:255], v[84:87], v[212:215]
    v_mfma_f32_16x16x32_bf16 v[220:223], v[252:255], v[156:159], v[220:223]
    ds_read_b128 v[252:255], v4 offset:3072
    s_waitcnt lgkmcnt(3)
    v_mfma_f32_16x16x32_bf16 v[160:163], v[240:243], v[16:19], 0
    v_mfma_f32_16x16x32_bf16 v[168:171], v[240:243], v[88:91], 0
    buffer_load_dwordx4 v1, s[8:11], s26 offen offset:1024 sc1 lds
    ds_read_b128 v[240:243], v4 offset:4096
    s_waitcnt lgkmcnt(3)
    v_mfma_f32_16x16x32_bf16 v[164:167], v[244:247], v[16:19], 0
    ds_read_b128 v[224:227], v15 offset:896
    v_mfma_f32_16x16x32_bf16 v[172:175], v[244:247], v[88:91], 0
    ds_read_b128 v[244:247], v4 offset:5120
    s_waitcnt lgkmcnt(4)
    v_mfma_f32_16x16x32_bf16 v[160:163], v[248:251], v[20:23], v[160:163]
    ds_read_b128 v[228:231], v15 offset:960
    v_mfma_f32_16x16x32_bf16 v[168:171], v[248:251], v[92:95], v[168:171]
    buffer_load_dwordx4 v1, s[8:11], s26 offen offset:2048 sc1 lds
    ds_read_b128 v[248:251], v4 offset:6144
    s_waitcnt lgkmcnt(5)
    v_mfma_f32_16x16x32_bf16 v[164:167], v[252:255], v[20:23], v[164:167]
    s_waitcnt lgkmcnt(1)
    v_mfma_f32_16x16x32_bf16 v[172:175], v[252:255], v[92:95], v[172:175]
    ds_read_b128 v[252:255], v4 offset:7168
    v_mfma_f32_16x16x32_bf16 v[160:163], v[240:243], v[24:27], v[160:163]
    v_fmac_f32 v208, v8, v224
    v_fmac_f32 v212, v8, v228
    v_fmac_f32 v209, v8, v225
    v_fmac_f32 v213, v8, v229
    v_mfma_f32_16x16x32_bf16 v[168:171], v[240:243], v[96:99], v[168:171]
    buffer_load_dwordx4 v1, s[8:11], s26 offen offset:3072 sc1 lds
    ds_read_b128 v[240:243], v4 offset:8192
    v_mfma_f32_16x16x32_bf16 v[164:167], v[244:247], v[24:27], v[164:167]
    v_fmac_f32 v210, v8, v226
    v_fmac_f32 v214, v8, v230
    v_fmac_f32 v211, v8, v227
    v_mfma_f32_16x16x32_bf16 v[172:175], v[244:247], v[96:99], v[172:175]
    ds_read_b128 v[244:247], v4 offset:9216
    s_waitcnt lgkmcnt(3)
    v_mfma_f32_16x16x32_bf16 v[160:163], v[248:251], v[28:31], v[160:163]
    v_fmac_f32 v215, v8, v231
    v_mul_f32 v212, v208, v212
    v_mul_f32 v208, v10, v208
    v_mfma_f32_16x16x32_bf16 v[168:171], v[248:251], v[100:103], v[168:171]
    s_add_u32 m0, m0, 4096
    s_add_u32 s26, s26, 4096
    s_mov_b64 exec, s[22:23]
    buffer_load_dwordx4 v1, s[8:11], s26 offen sc1 lds
    s_mov_b64 exec, -1
    ds_read_b128 v[248:251], v4 offset:10240
    s_waitcnt lgkmcnt(3)
    v_mfma_f32_16x16x32_bf16 v[164:167], v[252:255], v[28:31], v[164:167]
    v_mul_f32 v213, v209, v213
    v_mul_f32 v209, v10, v209
    v_mul_f32 v214, v210, v214
    v_mfma_f32_16x16x32_bf16 v[172:175], v[252:255], v[100:103], v[172:175]
    ds_read_b128 v[252:255], v4 offset:11264
    s_waitcnt lgkmcnt(3)
    v_mfma_f32_16x16x32_bf16 v[160:163], v[240:243], v[32:35], v[160:163]
    v_mul_f32 v210, v10, v210
    v_mul_f32 v215, v211, v215
    v_mul_f32 v211, v10, v211
    v_mfma_f32_16x16x32_bf16 v[168:171], v[240:243], v[104:107], v[168:171]
    ds_read_b128 v[240:243], v4 offset:12288
    s_waitcnt lgkmcnt(3)
    v_mfma_f32_16x16x32_bf16 v[164:167], v[244:247], v[32:35], v[164:167]
    v_exp_f32 v208, v208
    v_exp_f32 v209, v209
    v_exp_f32 v210, v210
    v_mfma_f32_16x16x32_bf16 v[172:175], v[244:247], v[104:107], v[172:175]
    ds_read_b128 v[244:247], v4 offset:13312
    s_waitcnt lgkmcnt(3)
    v_mfma_f32_16x16x32_bf16 v[160:163], v[248:251], v[36:39], v[160:163]
    v_exp_f32 v211, v211
    v_fma_f32 v208, v208, v12, v12
    v_fma_f32 v209, v209, v12, v12
    v_mfma_f32_16x16x32_bf16 v[168:171], v[248:251], v[108:111], v[168:171]
    ds_read_b128 v[248:251], v4 offset:14336
    s_waitcnt lgkmcnt(3)
    v_mfma_f32_16x16x32_bf16 v[164:167], v[252:255], v[36:39], v[164:167]
    v_fma_f32 v210, v210, v12, v12
    v_fma_f32 v211, v211, v12, v12
    v_rcp_f32 v208, v208
    v_mfma_f32_16x16x32_bf16 v[172:175], v[252:255], v[108:111], v[172:175]
    ds_read_b128 v[252:255], v4 offset:15360
    s_waitcnt lgkmcnt(3)
    v_mfma_f32_16x16x32_bf16 v[160:163], v[240:243], v[40:43], v[160:163]
    v_rcp_f32 v209, v209
    v_rcp_f32 v210, v210
    v_rcp_f32 v211, v211
    v_mul_f32 v212, v212, v208
    v_mfma_f32_16x16x32_bf16 v[168:171], v[240:243], v[112:115], v[168:171]
    ds_read_b128 v[240:243], v4 offset:16384
    s_waitcnt lgkmcnt(3)
    v_mfma_f32_16x16x32_bf16 v[164:167], v[244:247], v[40:43], v[164:167]
    v_mul_f32 v213, v213, v209
    v_mul_f32 v214, v214, v210
    v_mul_f32 v215, v215, v211
    v_mfma_f32_16x16x32_bf16 v[172:175], v[244:247], v[112:115], v[172:175]
    ds_read_b128 v[244:247], v4 offset:17408
    s_waitcnt lgkmcnt(3)
    v_mfma_f32_16x16x32_bf16 v[160:163], v[248:251], v[44:47], v[160:163]
    v_cvt_pk_bf16_f32 v234, v212, v213
    v_cvt_pk_bf16_f32 v235, v214, v215
    buffer_store_dwordx4 v[232:235], v1, s[12:15], s36 offen sc1
    v_mfma_f32_16x16x32_bf16 v[168:171], v[248:251], v[116:119], v[168:171]
    ds_read_b128 v[248:251], v4 offset:18432
    s_waitcnt lgkmcnt(3)
    v_mfma_f32_16x16x32_bf16 v[164:167], v[252:255], v[44:47], v[164:167]
    v_fmac_f32 v216, v9, v224
    v_fmac_f32 v220, v9, v228
    v_fmac_f32 v217, v9, v225
    v_mfma_f32_16x16x32_bf16 v[172:175], v[252:255], v[116:119], v[172:175]
    ds_read_b128 v[252:255], v4 offset:19456
    s_waitcnt lgkmcnt(3)
    v_mfma_f32_16x16x32_bf16 v[160:163], v[240:243], v[48:51], v[160:163]
    v_fmac_f32 v221, v9, v229
    v_fmac_f32 v218, v9, v226
    v_fmac_f32 v222, v9, v230
    v_mfma_f32_16x16x32_bf16 v[168:171], v[240:243], v[120:123], v[168:171]
    ds_read_b128 v[240:243], v4 offset:20480
    s_waitcnt lgkmcnt(3)
    v_mfma_f32_16x16x32_bf16 v[164:167], v[244:247], v[48:51], v[164:167]
    v_fmac_f32 v219, v9, v227
    v_fmac_f32 v223, v9, v231
    v_mul_f32 v220, v216, v220
    v_mfma_f32_16x16x32_bf16 v[172:175], v[244:247], v[120:123], v[172:175]
    ds_read_b128 v[244:247], v4 offset:21504
    s_waitcnt lgkmcnt(3)
    v_mfma_f32_16x16x32_bf16 v[160:163], v[248:251], v[52:55], v[160:163]
    v_mul_f32 v216, v11, v216
    v_mul_f32 v221, v217, v221
    v_mul_f32 v217, v11, v217
    v_mfma_f32_16x16x32_bf16 v[168:171], v[248:251], v[124:127], v[168:171]
    ds_read_b128 v[248:251], v4 offset:22528
    s_waitcnt lgkmcnt(3)
    v_mfma_f32_16x16x32_bf16 v[164:167], v[252:255], v[52:55], v[164:167]
    v_mul_f32 v222, v218, v222
    v_mul_f32 v218, v11, v218
    v_mul_f32 v223, v219, v223
    v_mfma_f32_16x16x32_bf16 v[172:175], v[252:255], v[124:127], v[172:175]
    ds_read_b128 v[252:255], v4 offset:23552
    s_waitcnt lgkmcnt(3)
    v_mfma_f32_16x16x32_bf16 v[160:163], v[240:243], v[56:59], v[160:163]
    v_mul_f32 v219, v11, v219
    v_exp_f32 v216, v216
    v_exp_f32 v217, v217
    v_exp_f32 v218, v218
    v_mfma_f32_16x16x32_bf16 v[168:171], v[240:243], v[128:131], v[168:171]
    ds_read_b128 v[240:243], v4 offset:24576
    s_waitcnt lgkmcnt(3)
    v_mfma_f32_16x16x32_bf16 v[164:167], v[244:247], v[56:59], v[164:167]
    v_exp_f32 v219, v219
    v_fma_f32 v216, v216, v13, v13
    v_fma_f32 v217, v217, v13, v13
    v_mfma_f32_16x16x32_bf16 v[172:175], v[244:247], v[128:131], v[172:175]
    ds_read_b128 v[244:247], v4 offset:25600
    s_waitcnt lgkmcnt(3)
    v_mfma_f32_16x16x32_bf16 v[160:163], v[248:251], v[60:63], v[160:163]
    v_fma_f32 v218, v218, v13, v13
    v_fma_f32 v219, v219, v13, v13
    v_rcp_f32 v216, v216
    v_mfma_f32_16x16x32_bf16 v[168:171], v[248:251], v[132:135], v[168:171]
    ds_read_b128 v[248:251], v4 offset:26624
    s_waitcnt lgkmcnt(3)
    v_mfma_f32_16x16x32_bf16 v[164:167], v[252:255], v[60:63], v[164:167]
    v_rcp_f32 v217, v217
    v_rcp_f32 v218, v218
    v_rcp_f32 v219, v219
    v_mfma_f32_16x16x32_bf16 v[172:175], v[252:255], v[132:135], v[172:175]
    ds_read_b128 v[252:255], v4 offset:27648
    s_waitcnt lgkmcnt(3)
    v_mfma_f32_16x16x32_bf16 v[160:163], v[240:243], v[64:67], v[160:163]
    v_mul_f32 v220, v220, v216
    v_mul_f32 v221, v221, v217
    v_mul_f32 v222, v222, v218
    v_mfma_f32_16x16x32_bf16 v[168:171], v[240:243], v[136:139], v[168:171]
    ds_read_b128 v[240:243], v4 offset:28672
    s_waitcnt lgkmcnt(3)
    v_mfma_f32_16x16x32_bf16 v[164:167], v[244:247], v[64:67], v[164:167]
    v_mul_f32 v223, v223, v219
    v_cvt_pk_bf16_f32 v238, v220, v221
    v_cvt_pk_bf16_f32 v239, v222, v223
    v_mfma_f32_16x16x32_bf16 v[172:175], v[244:247], v[136:139], v[172:175]
    ds_read_b128 v[244:247], v4 offset:29696
    s_waitcnt lgkmcnt(3)
    v_mfma_f32_16x16x32_bf16 v[160:163], v[248:251], v[68:71], v[160:163]
    buffer_store_dwordx4 v[236:239], v1, s[12:15], s37 offen sc1
    v_mfma_f32_16x16x32_bf16 v[168:171], v[248:251], v[140:143], v[168:171]
    ds_read_b128 v[248:251], v4 offset:30720
    s_waitcnt lgkmcnt(3)
    v_mfma_f32_16x16x32_bf16 v[164:167], v[252:255], v[68:71], v[164:167]
    v_mfma_f32_16x16x32_bf16 v[172:175], v[252:255], v[140:143], v[172:175]
    ds_read_b128 v[252:255], v4 offset:31744
    s_waitcnt lgkmcnt(3)
    v_mfma_f32_16x16x32_bf16 v[160:163], v[240:243], v[72:75], v[160:163]
    v_mfma_f32_16x16x32_bf16 v[168:171], v[240:243], v[144:147], v[168:171]
    ds_read_b128 v[240:243], v4 offset:32768
    s_waitcnt lgkmcnt(3)
    v_mfma_f32_16x16x32_bf16 v[164:167], v[244:247], v[72:75], v[164:167]
    v_mfma_f32_16x16x32_bf16 v[172:175], v[244:247], v[144:147], v[172:175]
    ds_read_b128 v[244:247], v4 offset:33792
    s_waitcnt lgkmcnt(3)
    v_mfma_f32_16x16x32_bf16 v[160:163], v[248:251], v[76:79], v[160:163]
    v_mfma_f32_16x16x32_bf16 v[168:171], v[248:251], v[148:151], v[168:171]
    ds_read_b128 v[248:251], v4 offset:34816
    s_waitcnt lgkmcnt(3)
    v_mfma_f32_16x16x32_bf16 v[164:167], v[252:255], v[76:79], v[164:167]
    v_mfma_f32_16x16x32_bf16 v[172:175], v[252:255], v[148:151], v[172:175]
    ds_read_b128 v[252:255], v4 offset:35840
    s_waitcnt lgkmcnt(3)
    v_mfma_f32_16x16x32_bf16 v[160:163], v[240:243], v[80:83], v[160:163]
    v_mfma_f32_16x16x32_bf16 v[168:171], v[240:243], v[152:155], v[168:171]
    s_waitcnt lgkmcnt(2)
    v_mfma_f32_16x16x32_bf16 v[164:167], v[244:247], v[80:83], v[164:167]
    v_mfma_f32_16x16x32_bf16 v[172:175], v[244:247], v[152:155], v[172:175]
    s_waitcnt lgkmcnt(1)
    v_mfma_f32_16x16x32_bf16 v[160:163], v[248:251], v[84:87], v[160:163]
    v_mfma_f32_16x16x32_bf16 v[168:171], v[248:251], v[156:159], v[168:171]
    s_waitcnt lgkmcnt(0)
    v_mfma_f32_16x16x32_bf16 v[164:167], v[252:255], v[84:87], v[164:167]
    v_mfma_f32_16x16x32_bf16 v[172:175], v[252:255], v[156:159], v[172:175]
    ds_read_b128 v[224:227], v15 offset:1024
    ds_read_b128 v[228:231], v15 offset:1088
    s_waitcnt lgkmcnt(0)
    s_nop 0
    v_fmac_f32 v160, v8, v224
    s_nop 1
    v_fmac_f32 v164, v8, v228
    v_fmac_f32 v161, v8, v225
    v_fmac_f32 v165, v8, v229
    v_fmac_f32 v162, v8, v226
    v_fmac_f32 v166, v8, v230
    v_fmac_f32 v163, v8, v227
    v_fmac_f32 v167, v8, v231
    v_mul_f32 v164, v160, v164
    v_mul_f32 v160, v10, v160
    v_mul_f32 v165, v161, v165
    v_mul_f32 v161, v10, v161
    v_mul_f32 v166, v162, v166
    v_mul_f32 v162, v10, v162
    v_mul_f32 v167, v163, v167
    v_mul_f32 v163, v10, v163
    v_exp_f32 v160, v160
    v_exp_f32 v161, v161
    v_exp_f32 v162, v162
    v_exp_f32 v163, v163
    v_fma_f32 v160, v160, v12, v12
    v_fma_f32 v161, v161, v12, v12
    v_fma_f32 v162, v162, v12, v12
    v_fma_f32 v163, v163, v12, v12
    v_rcp_f32 v160, v160
    v_rcp_f32 v161, v161
    v_rcp_f32 v162, v162
    v_rcp_f32 v163, v163
    v_mul_f32 v164, v164, v160
    v_mul_f32 v165, v165, v161
    v_mul_f32 v166, v166, v162
    v_mul_f32 v167, v167, v163
    v_cvt_pk_bf16_f32 v232, v164, v165
    v_cvt_pk_bf16_f32 v233, v166, v167
    v_fmac_f32 v168, v9, v224
    v_fmac_f32 v172, v9, v228
    v_fmac_f32 v169, v9, v225
    v_fmac_f32 v173, v9, v229
    v_fmac_f32 v170, v9, v226
    v_fmac_f32 v174, v9, v230
    v_fmac_f32 v171, v9, v227
    v_fmac_f32 v175, v9, v231
    v_mul_f32 v172, v168, v172
    v_mul_f32 v168, v11, v168
    v_mul_f32 v173, v169, v173
    v_mul_f32 v169, v11, v169
    v_mul_f32 v174, v170, v174
    v_mul_f32 v170, v11, v170
    v_mul_f32 v175, v171, v175
    v_mul_f32 v171, v11, v171
    v_exp_f32 v168, v168
    v_exp_f32 v169, v169
    v_exp_f32 v170, v170
    v_exp_f32 v171, v171
    v_fma_f32 v168, v168, v13, v13
    v_fma_f32 v169, v169, v13, v13
    v_fma_f32 v170, v170, v13, v13
    v_fma_f32 v171, v171, v13, v13
    v_rcp_f32 v168, v168
    v_rcp_f32 v169, v169
    v_rcp_f32 v170, v170
    v_rcp_f32 v171, v171
    v_mul_f32 v172, v172, v168
    v_mul_f32 v173, v173, v169
    v_mul_f32 v174, v174, v170
    v_mul_f32 v175, v175, v171
    v_cvt_pk_bf16_f32 v234, v172, v173
    v_cvt_pk_bf16_f32 v235, v174, v175
    s_nop 0
    v_permlane16_swap_b32 v232, v234
    v_permlane16_swap_b32 v233, v235
    buffer_store_dwordx4 v[232:235], v3, s[12:15], s30 offen sc1
    v_mbcnt_lo_u32_b32 v0, -1, 0
    v_mbcnt_hi_u32_b32 v0, -1, v0
    v_lshlrev_b32 v1, 4, v0
    v_and_b32 v2, 15, v0
    v_lshrrev_b32 v3, 4, v0
    s_and_b32 s17, s16, 3
    s_lshr_b32 s18, s16, 2
    s_mul_i32 s19, s18, 9216
    v_add_u32 v4, s19, v1
    v_add_u32 v5, 36864, v4
    v_add_u32 v6, 73728, v4
    v_add_u32 v7, 110592, v4
    s_mul_i32 s20, s16, 4608
    s_mul_i32 s21, s16, 2304
    s_mov_b32 s22, -1
    s_mov_b32 s23, 0
    s_mov_b32 s24, 0xffff
    s_mov_b32 s25, 0
    s_and_b32 s30, s2, 3
    s_bfe_u32 s31, s2, 0x10002
    s_lshl_b32 s31, s31, 3
    s_bfe_u32 s32, s2, 0x30003
    s_add_u32 s31, s31, s32
    s_lshr_b32 s32, s2, 6
    s_lshl_b32 s33, s32, 2
    s_add_u32 s33, s33, s30
    s_mul_i32 s33, s33, 331776
    s_add_u32 s33, s33, 14680064
    s_lshl_b32 s34, s31, 3
    s_lshl_b32 s35, s17, 1
    s_add_u32 s34, s34, s35
    s_add_u32 s36, s34, s18
    s_xor_b32 s35, s18, 1
    s_add_u32 s37, s34, s35
    s_mul_i32 s35, s30, 36
    s_mul_i32 s38, s18, 18
    s_add_u32 s35, s35, s38
    s_mul_i32 s38, s36, 144
    s_add_u32 s38, s38, s35
    s_lshl_b32 s38, s38, 10
    s_add_u32 s38, s38, 14942208
    s_mul_i32 s39, s37, 144
    s_add_u32 s39, s39, s35
    s_lshl_b32 s39, s39, 10
    s_add_u32 s39, s39, 14942208
    s_lshr_b32 s27, s31, 1
    s_lshl_b32 s27, s27, 2
    s_add_u32 s27, s27, s30
    s_lshl_b32 s27, s27, 10
    s_add_u32 s27, s27, 44662784
    s_lshl_b32 s28, s31, 2
    s_add_u32 s28, s28, s32
    s_lshl_b32 s28, s28, 9
    s_lshl_b32 s29, s30, 7
    s_add_u32 s29, s29, s28
    s_add_u32 s19, s29, 44695552
    s_add_u32 s29, s29, 44990464
    s_add_u32 s28, s28, 44695552
    s_lshl_b32 s46, s32, 2
    s_bfe_u32 s47, s2, 0x20001
    s_add_u32 s46, s46, s47
    s_mul_i32 s46, s46, 165888
    s_add_u32 s46, s46, 0
    s_cmp_eq_u32 s79, 0
    s_cselect_b32 s46, s46, 2146434816
    s_add_u32 s44, s27, 131072
    v_lshl_add_u32 v13, v0, 7, s79
    s_mov_b32 s3, 0x40000
    s_mov_b32 exec_lo, 255
    s_mov_b32 exec_hi, 0
Lm109_l:
    buffer_load_dword v14, v13, s[12:15], s44 offen sc1
    s_waitcnt vmcnt(0)
    v_cmp_ne_u32 vcc, s80, v14
    s_sub_u32 s3, s3, 1
    s_cbranch_scc1 Lm110_d
    s_nop 2
    s_cbranch_vccz Lm110_d
    s_sleep 4
    s_branch Lm109_l
Lm110_d:
    s_mov_b64 exec, -1
    buffer_load_dwordx4 v[112:115], v1, s[12:15], s38 offen offset:0 sc1
    buffer_load_dwordx4 v[116:119], v1, s[12:15], s39 offen offset:0 sc1
    buffer_load_dwordx4 v[120:123], v1, s[12:15], s38 offen offset:1024 sc1
    buffer_load_dwordx4 v[124:127], v1, s[12:15], s39 offen offset:1024 sc1
    buffer_load_dwordx4 v[128:131], v1, s[12:15], s38 offen offset:2048 sc1
    buffer_load_dwordx4 v[132:135], v1, s[12:15], s39 offen offset:2048 sc1
    buffer_load_dwordx4 v[136:139], v1, s[12:15], s38 offen offset:3072 sc1
    buffer_load_dwordx4 v[140:143], v1, s[12:15], s39 offen offset:3072 sc1
    s_barrier
    s_cmp_lg_u32 s16, 0
    s_cbranch_scc1 Lm111_late
    v_mov_b32 v13, s79
    v_mov_b32 v14, s80
    s_mov_b64 exec, 1
    buffer_store_dword v14, v13, s[12:15], s40 offen sc1
    s_mov_b64 exec, -1
Lm111_late:
    v_lshl_add_u32 v13, v0, 7, s79
    v_mov_b32 v14, s80
    ds_read_b128 v[88:91], v5 offset:0
    ds_read_b128 v[92:95], v5 offset:1024
    ds_read_b128 v[96:99], v5 offset:2048
    ds_read_b128 v[100:103], v5 offset:3072
    ds_read_b128 v[104:107], v5 offset:4096
    s_waitcnt vmcnt(6) lgkmcnt(4)
    v_mfma_f32_16x16x32_bf16 v[16:19], v[88:91], v[112:115], 0
    v_mfma_f32_16x16x32_bf16 v[52:55], v[88:91], v[116:119], 0
    s_add_u32 m0, s20, 110592
    s_add_u32 s26, s33, s20
    s_add_u32 s26, s26, 73728
    buffer_load_dwordx4 v1, s[8:11], s26 offen offset:0 sc1 lds
    ds_read_b128 v[108:111], v5 offset:5120
    s_waitcnt lgkmcnt(4)
    v_mfma_f32_16x16x32_bf16 v[20:23], v[92:95], v[112:115], 0
    v_mfma_f32_16x16x32_bf16 v[56:59], v[92:95], v[116:119], 0
    buffer_load_dwordx4 v1, s[8:11], s26 offen offset:1024 sc1 lds
    ds_read_b128 v[88:91], v5 offset:6144
    s_waitcnt lgkmcnt(4)
    v_mfma_f32_16x16x32_bf16 v[24:27], v[96:99], v[112:115], 0
    v_mfma_f32_16x16x32_bf16 v[60:63], v[96:99], v[116:119], 0
    buffer_load_dwordx4 v1, s[8:11], s26 offen offset:2048 sc1 lds
    ds_read_b128 v[92:95], v5 offset:7168
    s_waitcnt lgkmcnt(4)
    v_mfma_f32_16x16x32_bf16 v[28:31], v[100:103], v[112:115], 0
    v_mfma_f32_16x16x32_bf16 v[64:67], v[100:103], v[116:119], 0
    buffer_load_dwordx4 v1, s[8:11], s26 offen offset:3072 sc1 lds
    ds_read_b128 v[96:99], v5 offset:8192
    s_waitcnt lgkmcnt(4)
    v_mfma_f32_16x16x32_bf16 v[32:35], v[104:107], v[112:115], 0
    v_mfma_f32_16x16x32_bf16 v[68:71], v[104:107], v[116:119], 0
    s_add_u32 m0, m0, 4096
    s_add_u32 s26, s26, 4096
    s_mov_b64 exec, s[22:23]
    buffer_load_dwordx4 v1, s[8:11], s26 offen sc1 lds
    s_mov_b64 exec, -1
    ds_read_b128 v[100:103], v5 offset:18432
    s_waitcnt lgkmcnt(4)
    v_mfma_f32_16x16x32_bf16 v[36:39], v[108:111], v[112:115], 0
    v_mfma_f32_16x16x32_bf16 v[72:75], v[108:111], v[116:119], 0
    ds_read_b128 v[104:107], v5 offset:19456
    s_waitcnt lgkmcnt(4)
    v_mfma_f32_16x16x32_bf16 v[40:43], v[88:91], v[112:115], 0
    v_mfma_f32_16x16x32_bf16 v[76:79], v[88:91], v[116:119], 0
    s_add_u32 s38, s38, 4096
    buffer_load_dwordx4 v[144:147], v1, s[12:15], s38 offen offset:0 sc1
    ds_read_b128 v[108:111], v5 offset:20480
    s_waitcnt lgkmcnt(4)
    v_mfma_f32_16x16x32_bf16 v[44:47], v[92:95], v[112:115], 0
    v_mfma_f32_16x16x32_bf16 v[80:83], v[92:95], v[116:119], 0
    ds_read_b128 v[88:91], v5 offset:21504
    s_waitcnt lgkmcnt(4)
    v_mfma_f32_16x16x32_bf16 v[48:51], v[96:99], v[112:115], 0
    v_mfma_f32_16x16x32_bf16 v[84:87], v[96:99], v[116:119], 0
    s_add_u32 s39, s39, 4096
    buffer_load_dwordx4 v[148:151], v1, s[12:15], s39 offen offset:0 sc1
    ds_read_b128 v[92:95], v5 offset:22528
    s_waitcnt vmcnt(11) lgkmcnt(4)
    v_mfma_f32_16x16x32_bf16 v[16:19], v[100:103], v[120:123], v[16:19]
    v_mfma_f32_16x16x32_bf16 v[52:55], v[100:103], v[124:127], v[52:55]
    ds_read_b128 v[96:99], v5 offset:23552
    s_waitcnt lgkmcnt(4)
    v_mfma_f32_16x16x32_bf16 v[20:23], v[104:107], v[120:123], v[20:23]
    v_mfma_f32_16x16x32_bf16 v[56:59], v[104:107], v[124:127], v[56:59]
    buffer_load_dwordx4 v[152:155], v1, s[12:15], s38 offen offset:1024 sc1
    ds_read_b128 v[100:103], v5 offset:24576
    s_waitcnt lgkmcnt(4)
    v_mfma_f32_16x16x32_bf16 v[24:27], v[108:111], v[120:123], v[24:27]
    v_mfma_f32_16x16x32_bf16 v[60:63], v[108:111], v[124:127], v[60:63]
    ds_read_b128 v[104:107], v5 offset:25600
    s_waitcnt lgkmcnt(4)
    v_mfma_f32_16x16x32_bf16 v[28:31], v[88:91], v[120:123], v[28:31]
    v_mfma_f32_16x16x32_bf16 v[64:67], v[88:91], v[124:127], v[64:67]
    buffer_load_dwordx4 v[156:159], v1, s[12:15], s39 offen offset:1024 sc1
    ds_read_b128 v[108:111], v5 offset:26624
    s_waitcnt lgkmcnt(4)
    v_mfma_f32_16x16x32_bf16 v[32:35], v[92:95], v[120:123], v[32:35]
    v_mfma_f32_16x16x32_bf16 v[68:71], v[92:95], v[124:127], v[68:71]
    s_barrier
    ds_read_b128 v[88:91], v6 offset:0
    s_waitcnt lgkmcnt(4)
    v_mfma_f32_16x16x32_bf16 v[36:39], v[96:99], v[120:123], v[36:39]
    v_mfma_f32_16x16x32_bf16 v[72:75], v[96:99], v[124:127], v[72:75]
    s_add_u32 m0, s20, 0
    s_add_u32 s26, s33, s20
    s_add_u32 s26, s26, 110592
    buffer_load_dwordx4 v1, s[8:11], s26 offen offset:0 sc1 lds
    ds_read_b128 v[92:95], v6 offset:1024
    s_waitcnt lgkmcnt(4)
    v_mfma_f32_16x16x32_bf16 v[40:43], v[100:103], v[120:123], v[40:43]
    v_mfma_f32_16x16x32_bf16 v[76:79], v[100:103], v[124:127], v[76:79]
    ds_read_b128 v[96:99], v6 offset:2048
    s_waitcnt lgkmcnt(4)
    v_mfma_f32_16x16x32_bf16 v[44:47], v[104:107], v[120:123], v[44:47]
    v_mfma_f32_16x16x32_bf16 v[80:83], v[104:107], v[124:127], v[80:83]
    buffer_load_dwordx4 v1, s[8:11], s26 offen offset:1024 sc1 lds
    ds_read_b128 v[100:103], v6 offset:3072
    s_waitcnt lgkmcnt(4)
    v_mfma_f32_16x16x32_bf16 v[48:51], v[108:111], v[120:123], v[48:51]
    v_mfma_f32_16x16x32_bf16 v[84:87], v[108:111], v[124:127], v[84:87]
    ds_read_b128 v[104:107], v6 offset:4096
    s_waitcnt vmcnt(13) lgkmcnt(4)
    v_mfma_f32_16x16x32_bf16 v[16:19], v[88:91], v[128:131], v[16:19]
    v_mfma_f32_16x16x32_bf16 v[52:55], v[88:91], v[132:135], v[52:55]
    buffer_load_dwordx4 v1, s[8:11], s26 offen offset:2048 sc1 lds
    ds_read_b128 v[108:111], v6 offset:5120
    s_waitcnt lgkmcnt(4)
    v_mfma_f32_16x16x32_bf16 v[20:23], v[92:95], v[128:131], v[20:23]
    v_mfma_f32_16x16x32_bf16 v[56:59], v[92:95], v[132:135], v[56:59]
    ds_read_b128 v[88:91], v6 offset:6144
    s_waitcnt lgkmcnt(4)
    v_mfma_f32_16x16x32_bf16 v[24:27], v[96:99], v[128:131], v[24:27]
    v_mfma_f32_16x16x32_bf16 v[60:63], v[96:99], v[132:135], v[60:63]
    buffer_load_dwordx4 v1, s[8:11], s26 offen offset:3072 sc1 lds
    ds_read_b128 v[92:95], v6 offset:7168
    s_waitcnt lgkmcnt(4)
    v_mfma_f32_16x16x32_bf16 v[28:31], v[100:103], v[128:131], v[28:31]
    v_mfma_f32_16x16x32_bf16 v[64:67], v[100:103], v[132:135], v[64:67]
    ds_read_b128 v[96:99], v6 offset:8192
    s_waitcnt lgkmcnt(4)
    v_mfma_f32_16x16x32_bf16 v[32:35], v[104:107], v[128:131], v[32:35]
    v_mfma_f32_16x16x32_bf16 v[68:71], v[104:107], v[132:135], v[68:71]
    s_add_u32 m0, m0, 4096
    s_add_u32 s26, s26, 4096
    s_mov_b64 exec, s[22:23]
    buffer_load_dwordx4 v1, s[8:11], s26 offen sc1 lds
    s_mov_b64 exec, -1
    ds_read_b128 v[100:103], v6 offset:18432
    s_waitcnt lgkmcnt(4)
    v_mfma_f32_16x16x32_bf16 v[36:39], v[108:111], v[128:131], v[36:39]
    v_mfma_f32_16x16x32_bf16 v[72:75], v[108:111], v[132:135], v[72:75]
    ds_read_b128 v[104:107], v6 offset:19456
    s_waitcnt lgkmcnt(4)
    v_mfma_f32_16x16x32_bf16 v[40:43], v[88:91], v[128:131], v[40:43]
    v_mfma_f32_16x16x32_bf16 v[76:79], v[88:91], v[132:135], v[76:79]
    buffer_load_dwordx4 v[160:163], v1, s[12:15], s38 offen offset:2048 sc1
    ds_read_b128 v[108:111], v6 offset:20480
    s_waitcnt lgkmcnt(4)
    v_mfma_f32_16x16x32_bf16 v[44:47], v[92:95], v[128:131], v[44:47]
    v_mfma_f32_16x16x32_bf16 v[80:83], v[92:95], v[132:135], v[80:83]
    ds_read_b128 v[88:91], v6 offset:21504
    s_waitcnt lgkmcnt(4)
    v_mfma_f32_16x16x32_bf16 v[48:51], v[96:99], v[128:131], v[48:51]
    v_mfma_f32_16x16x32_bf16 v[84:87], v[96:99], v[132:135], v[84:87]
    buffer_load_dwordx4 v[164:167], v1, s[12:15], s39 offen offset:2048 sc1
    ds_read_b128 v[92:95], v6 offset:22528
    s_waitcnt vmcnt(16) lgkmcnt(4)
    v_mfma_f32_16x16x32_bf16 v[16:19], v[100:103], v[136:139], v[16:19]
    v_mfma_f32_16x16x32_bf16 v[52:55], v[100:103], v[140:143], v[52:55]
    ds_read_b128 v[96:99], v6 offset:23552
    s_waitcnt lgkmcnt(4)
    v_mfma_f32_16x16x32_bf16 v[20:23], v[104:107], v[136:139], v[20:23]
    v_mfma_f32_16x16x32_bf16 v[56:59], v[104:107], v[140:143], v[56:59]
    buffer_load_dwordx4 v[168:171], v1, s[12:15], s38 offen offset:3072 sc1
    ds_read_b128 v[100:103], v6 offset:24576
    s_waitcnt lgkmcnt(4)
    v_mfma_f32_16x16x32_bf16 v[24:27], v[108:111], v[136:139], v[24:27]
    v_mfma_f32_16x16x32_bf16 v[60:63], v[108:111], v[140:143], v[60:63]
    ds_read_b128 v[104:107], v6 offset:25600
    s_waitcnt lgkmcnt(4)
    v_mfma_f32_16x16x32_bf16 v[28:31], v[88:91], v[136:139], v[28:31]
    v_mfma_f32_16x16x32_bf16 v[64:67], v[88:91], v[140:143], v[64:67]
    buffer_load_dwordx4 v[172:175], v1, s[12:15], s39 offen offset:3072 sc1
    ds_read_b128 v[108:111], v6 offset:26624
    s_waitcnt lgkmcnt(4)
    v_mfma_f32_16x16x32_bf16 v[32:35], v[92:95], v[136:139], v[32:35]
    v_mfma_f32_16x16x32_bf16 v[68:71], v[92:95], v[140:143], v[68:71]
    s_waitcnt vmcnt(13)
    s_barrier
    ds_read_b128 v[88:91], v7 offset:0
    s_waitcnt lgkmcnt(4)
    v_mfma_f32_16x16x32_bf16 v[36:39], v[96:99], v[136:139], v[36:39]
    v_mfma_f32_16x16x32_bf16 v[72:75], v[96:99], v[140:143], v[72:75]
    s_add_u32 m0, s20, 36864
    s_add_u32 s26, s33, s20
    s_add_u32 s26, s26, 147456
    buffer_load_dwordx4 v1, s[8:11], s26 offen offset:0 sc1 lds
    ds_read_b128 v[92:95], v7 offset:1024
    s_waitcnt lgkmcnt(4)
    v_mfma_f32_16x16x32_bf16 v[40:43], v[100:103], v[136:139], v[40:43]
    v_mfma_f32_16x16x32_bf16 v[76:79], v[100:103], v[140:143], v[76:79]
    buffer_load_dwordx4 v1, s[8:11], s26 offen offset:1024 sc1 lds
    ds_read_b128 v[96:99], v7 offset:2048
    s_waitcnt lgkmcnt(4)
    v_mfma_f32_16x16x32_bf16 v[44:47], v[104:107], v[136:139], v[44:47]
    v_mfma_f32_16x16x32_bf16 v[80:83], v[104:107], v[140:143], v[80:83]
    buffer_load_dwordx4 v1, s[8:11], s26 offen offset:2048 sc1 lds
    ds_read_b128 v[100:103], v7 offset:3072
    s_waitcnt lgkmcnt(4)
    v_mfma_f32_16x16x32_bf16 v[48:51], v[108:111], v[136:139], v[48:51]
    v_mfma_f32_16x16x32_bf16 v[84:87], v[108:111], v[140:143], v[84:87]
    ds_read_b128 v[104:107], v7 offset:4096
    s_waitcnt vmcnt(14) lgkmcnt(4)
    v_mfma_f32_16x16x32_bf16 v[16:19], v[88:91], v[144:147], v[16:19]
    v_mfma_f32_16x16x32_bf16 v[52:55], v[88:91], v[148:151], v[52:55]
    buffer_load_dwordx4 v1, s[8:11], s26 offen offset:3072 sc1 lds
    ds_read_b128 v[108:111], v7 offset:5120
    s_waitcnt lgkmcnt(4)
    v_mfma_f32_16x16x32_bf16 v[20:23], v[92:95], v[144:147], v[20:23]
    v_mfma_f32_16x16x32_bf16 v[56:59], v[92:95], v[148:151], v[56:59]
    ds_read_b128 v[88:91], v7 offset:6144
    s_waitcnt lgkmcnt(4)
    v_mfma_f32_16x16x32_bf16 v[24:27], v[96:99], v[144:147], v[24:27]
    v_mfma_f32_16x16x32_bf16 v[60:63], v[96:99], v[148:151], v[60:63]
    s_add_u32 m0, m0, 4096
    s_add_u32 s26, s26, 4096
    s_mov_b64 exec, s[22:23]
    buffer_load_dwordx4 v1, s[8:11], s26 offen sc1 lds
    s_mov_b64 exec, -1
    ds_read_b128 v[92:95], v7 offset:7168
    s_waitcnt lgkmcnt(4)
    v_mfma_f32_16x16x32_bf16 v[28:31], v[100:103], v[144:147], v[28:31]
    v_mfma_f32_16x16x32_bf16 v[64:67], v[100:103], v[148:151], v[64:67]
    ds_read_b128 v[96:99], v7 offset:8192
    s_waitcnt lgkmcnt(4)
    v_mfma_f32_16x16x32_bf16 v[32:35], v[104:107], v[144:147], v[32:35]
    v_mfma_f32_16x16x32_bf16 v[68:71], v[104:107], v[148:151], v[68:71]
    s_add_u32 s38, s38, 4096
    buffer_load_dwordx4 v[112:115], v1, s[12:15], s38 offen offset:0 sc1
    ds_read_b128 v[100:103], v7 offset:18432
    s_waitcnt lgkmcnt(4)
    v_mfma_f32_16x16x32_bf16 v[36:39], v[108:111], v[144:147], v[36:39]
    v_mfma_f32_16x16x32_bf16 v[72:75], v[108:111], v[148:151], v[72:75]
    ds_read_b128 v[104:107], v7 offset:19456
    s_waitcnt lgkmcnt(4)
    v_mfma_f32_16x16x32_bf16 v[40:43], v[88:91], v[144:147], v[40:43]
    v_mfma_f32_16x16x32_bf16 v[76:79], v[88:91], v[148:151], v[76:79]
    s_add_u32 s39, s39, 4096
    buffer_load_dwordx4 v[116:119], v1, s[12:15], s39 offen offset:0 sc1
    ds_read_b128 v[108:111], v7 offset:20480
    s_waitcnt lgkmcnt(4)
    v_mfma_f32_16x16x32_bf16 v[44:47], v[92:95], v[144:147], v[44:47]
    v_mfma_f32_16x16x32_bf16 v[80:83], v[92:95], v[148:151], v[80:83]
    ds_read_b128 v[88:91], v7 offset:21504
    s_waitcnt lgkmcnt(4)
    v_mfma_f32_16x16x32_bf16 v[48:51], v[96:99], v[144:147], v[48:51]
    v_mfma_f32_16x16x32_bf16 v[84:87], v[96:99], v[148:151], v[84:87]
    buffer_load_dwordx4 v[120:123], v1, s[12:15], s38 offen offset:1024 sc1
    ds_read_b128 v[92:95], v7 offset:22528
    s_waitcnt vmcnt(17) lgkmcnt(4)
    v_mfma_f32_16x16x32_bf16 v[16:19], v[100:103], v[152:155], v[16:19]
    v_mfma_f32_16x16x32_bf16 v[52:55], v[100:103], v[156:159], v[52:55]
    ds_read_b128 v[96:99], v7 offset:23552
    s_waitcnt lgkmcnt(4)
    v_mfma_f32_16x16x32_bf16 v[20:23], v[104:107], v[152:155], v[20:23]
    v_mfma_f32_16x16x32_bf16 v[56:59], v[104:107], v[156:159], v[56:59]
    buffer_load_dwordx4 v[124:127], v1, s[12:15], s39 offen offset:1024 sc1
    ds_read_b128 v[100:103], v7 offset:24576
    s_waitcnt lgkmcnt(4)
    v_mfma_f32_16x16x32_bf16 v[24:27], v[108:111], v[152:155], v[24:27]
    v_mfma_f32_16x16x32_bf16 v[60:63], v[108:111], v[156:159], v[60:63]
    ds_read_b128 v[104:107], v7 offset:25600
    s_waitcnt lgkmcnt(4)
    v_mfma_f32_16x16x32_bf16 v[28:31], v[88:91], v[152:155], v[28:31]
    v_mfma_f32_16x16x32_bf16 v[64:67], v[88:91], v[156:159], v[64:67]
    s_mov_b64 exec, 0xff
    buffer_load_dword v14, v13, s[12:15], s27 offen sc1
    s_mov_b64 exec, -1
    ds_read_b128 v[108:111], v7 offset:26624
    s_waitcnt lgkmcnt(4)
    v_mfma_f32_16x16x32_bf16 v[32:35], v[92:95], v[152:155], v[32:35]
    v_mfma_f32_16x16x32_bf16 v[68:71], v[92:95], v[156:159], v[68:71]
    s_waitcnt vmcnt(14)
    s_barrier
    ds_read_b128 v[88:91], v4 offset:0
    s_waitcnt lgkmcnt(4)
    v_mfma_f32_16x16x32_bf16 v[36:39], v[96:99], v[152:155], v[36:39]
    v_mfma_f32_16x16x32_bf16 v[72:75], v[96:99], v[156:159], v[72:75]
    s_add_u32 m0, s20, 73728
    s_add_u32 s26, s33, s20
    s_add_u32 s26, s26, 184320
    buffer_load_dwordx4 v1, s[8:11], s26 offen offset:0 sc1 lds
    ds_read_b128 v[92:95], v4 offset:1024
    s_waitcnt lgkmcnt(4)
    v_mfma_f32_16x16x32_bf16 v[40:43], v[100:103], v[152:155], v[40:43]
    v_mfma_f32_16x16x32_bf16 v[76:79], v[100:103], v[156:159], v[76:79]
    ds_read_b128 v[96:99], v4 offset:2048
    s_waitcnt lgkmcnt(4)
    v_mfma_f32_16x16x32_bf16 v[44:47], v[104:107], v[152:155], v[44:47]
    v_mfma_f32_16x16x32_bf16 v[80:83], v[104:107], v[156:159], v[80:83]
    buffer_load_dwordx4 v1, s[8:11], s26 offen offset:1024 sc1 lds
    ds_read_b128 v[100:103], v4 offset:3072
    s_waitcnt lgkmcnt(4)
    v_mfma_f32_16x16x32_bf16 v[48:51], v[108:111], v[152:155], v[48:51]
    v_mfma_f32_16x16x32_bf16 v[84:87], v[108:111], v[156:159], v[84:87]
    ds_read_b128 v[104:107], v4 offset:4096
    s_waitcnt vmcnt(14) lgkmcnt(4)
    v_mfma_f32_16x16x32_bf16 v[16:19], v[88:91], v[160:163], v[16:19]
    v_mfma_f32_16x16x32_bf16 v[52:55], v[88:91], v[164:167], v[52:55]
    buffer_load_dwordx4 v1, s[8:11], s26 offen offset:2048 sc1 lds
    ds_read_b128 v[108:111], v4 offset:5120
    s_waitcnt lgkmcnt(4)
    v_mfma_f32_16x16x32_bf16 v[20:23], v[92:95], v[160:163], v[20:23]
    v_mfma_f32_16x16x32_bf16 v[56:59], v[92:95], v[164:167], v[56:59]
    ds_read_b128 v[88:91], v4 offset:6144
    s_waitcnt lgkmcnt(4)
    v_mfma_f32_16x16x32_bf16 v[24:27], v[96:99], v[160:163], v[24:27]
    v_mfma_f32_16x16x32_bf16 v[60:63], v[96:99], v[164:167], v[60:63]
    buffer_load_dwordx4 v1, s[8:11], s26 offen offset:3072 sc1 lds
    ds_read_b128 v[92:95], v4 offset:7168
    s_waitcnt lgkmcnt(4)
    v_mfma_f32_16x16x32_bf16 v[28:31], v[100:103], v[160:163], v[28:31]
    v_mfma_f32_16x16x32_bf16 v[64:67], v[100:103], v[164:167], v[64:67]
    ds_read_b128 v[96:99], v4 offset:8192
    s_waitcnt lgkmcnt(4)
    v_mfma_f32_16x16x32_bf16 v[32:35], v[104:107], v[160:163], v[32:35]
    v_mfma_f32_16x16x32_bf16 v[68:71], v[104:107], v[164:167], v[68:71]
    s_add_u32 m0, m0, 4096
    s_add_u32 s26, s26, 4096
    s_mov_b64 exec, s[22:23]
    buffer_load_dwordx4 v1, s[8:11], s26 offen sc1 lds
    s_mov_b64 exec, -1
    ds_read_b128 v[100:103], v4 offset:18432
    s_waitcnt lgkmcnt(4)
    v_mfma_f32_16x16x32_bf16 v[36:39], v[108:111], v[160:163], v[36:39]
    v_mfma_f32_16x16x32_bf16 v[72:75], v[108:111], v[164:167], v[72:75]
    ds_read_b128 v[104:107], v4 offset:19456
    s_waitcnt lgkmcnt(4)
    v_mfma_f32_16x16x32_bf16 v[40:43], v[88:91], v[160:163], v[40:43]
    v_mfma_f32_16x16x32_bf16 v[76:79], v[88:91], v[164:167], v[76:79]
    buffer_load_dwordx4 v[128:131], v1, s[12:15], s38 offen offset:2048 sc1
    ds_read_b128 v[108:111], v4 offset:20480
    s_waitcnt lgkmcnt(4)
    v_mfma_f32_16x16x32_bf16 v[44:47], v[92:95], v[160:163], v[44:47]
    v_mfma_f32_16x16x32_bf16 v[80:83], v[92:95], v[164:167], v[80:83]
    ds_read_b128 v[88:91], v4 offset:21504
    s_waitcnt lgkmcnt(4)
    v_mfma_f32_16x16x32_bf16 v[48:51], v[96:99], v[160:163], v[48:51]
    v_mfma_f32_16x16x32_bf16 v[84:87], v[96:99], v[164:167], v[84:87]
    buffer_load_dwordx4 v[132:135], v1, s[12:15], s39 offen offset:2048 sc1
    ds_read_b128 v[92:95], v4 offset:22528
    s_waitcnt vmcnt(17) lgkmcnt(4)
    v_mfma_f32_16x16x32_bf16 v[16:19], v[100:103], v[168:171], v[16:19]
    v_mfma_f32_16x16x32_bf16 v[52:55], v[100:103], v[172:175], v[52:55]
    ds_read_b128 v[96:99], v4 offset:23552
    s_waitcnt lgkmcnt(4)
    v_mfma_f32_16x16x32_bf16 v[20:23], v[104:107], v[168:171], v[20:23]
    v_mfma_f32_16x16x32_bf16 v[56:59], v[104:107], v[172:175], v[56:59]
    buffer_load_dwordx4 v[136:139], v1, s[12:15], s38 offen offset:3072 sc1
    ds_read_b128 v[100:103], v4 offset:24576
    s_waitcnt lgkmcnt(4)
    v_mfma_f32_16x16x32_bf16 v[24:27], v[108:111], v[168:171], v[24:27]
    v_mfma_f32_16x16x32_bf16 v[60:63], v[108:111], v[172:175], v[60:63]
    ds_read_b128 v[104:107], v4 offset:25600
    s_waitcnt lgkmcnt(4)
    v_mfma_f32_16x16x32_bf16 v[28:31], v[88:91], v[168:171], v[28:31]
    v_mfma_f32_16x16x32_bf16 v[64:67], v[88:91], v[172:175], v[64:67]
    buffer_load_dwordx4 v[140:143], v1, s[12:15], s39 offen offset:3072 sc1
    ds_read_b128 v[108:111], v4 offset:26624
    s_waitcnt lgkmcnt(4)
    v_mfma_f32_16x16x32_bf16 v[32:35], v[92:95], v[168:171], v[32:35]
    v_mfma_f32_16x16x32_bf16 v[68:71], v[92:95], v[172:175], v[68:71]
    s_waitcnt vmcnt(14)
    s_waitcnt vmcnt(9)
    v_cmp_ne_u32 vcc, s80, v14
    s_nop 4
    s_cbranch_vccz Lm112_lok
    v_lshl_add_u32 v13, v0, 7, s79
    s_mov_b32 s3, 0x40000
    s_mov_b32 exec_lo, 255
    s_mov_b32 exec_hi, 0
Lm113_l:
    buffer_load_dword v14, v13, s[12:15], s27 offen sc1
    s_waitcnt vmcnt(0)
    v_cmp_ne_u32 vcc, s80, v14
    s_sub_u32 s3, s3, 1
    s_cbranch_scc1 Lm114_d
    s_nop 2
    s_cbranch_vccz Lm114_d
    s_sleep 4
    s_branch Lm113_l
Lm114_d:
    s_mov_b64 exec, -1
Lm112_lok:
    s_barrier
    ds_read_b128 v[88:91], v5 offset:0
    s_waitcnt lgkmcnt(4)
    v_mfma_f32_16x16x32_bf16 v[36:39], v[96:99], v[168:171], v[36:39]
    v_mfma_f32_16x16x32_bf16 v[72:75], v[96:99], v[172:175], v[72:75]
    s_add_u32 m0, s20, 110592
    s_add_u32 s26, s33, s20
    s_add_u32 s26, s26, 221184
    buffer_load_dwordx4 v1, s[8:11], s26 offen offset:0 sc1 lds
    ds_read_b128 v[92:95], v5 offset:1024
    s_waitcnt lgkmcnt(4)
    v_mfma_f32_16x16x32_bf16 v[40:43], v[100:103], v[168:171], v[40:43]
    v_mfma_f32_16x16x32_bf16 v[76:79], v[100:103], v[172:175], v[76:79]
    ds_read_b128 v[96:99], v5 offset:2048
    s_waitcnt lgkmcnt(4)
    v_mfma_f32_16x16x32_bf16 v[44:47], v[104:107], v[168:171], v[44:47]
    v_mfma_f32_16x16x32_bf16 v[80:83], v[104:107], v[172:175], v[80:83]
    buffer_load_dwordx4 v1, s[8:11], s26 offen offset:1024 sc1 lds
    ds_read_b128 v[100:103], v5 offset:3072
    s_waitcnt lgkmcnt(4)
    v_mfma_f32_16x16x32_bf16 v[48:51], v[108:111], v[168:171], v[48:51]
    v_mfma_f32_16x16x32_bf16 v[84:87], v[108:111], v[172:175], v[84:87]
    ds_read_b128 v[104:107], v5 offset:4096
    s_waitcnt lgkmcnt(4)
    v_mfma_f32_16x16x32_bf16 v[16:19], v[88:91], v[112:115], v[16:19]
    v_mfma_f32_16x16x32_bf16 v[52:55], v[88:91], v[116:119], v[52:55]
    buffer_load_dwordx4 v1, s[8:11], s26 offen offset:2048 sc1 lds
    ds_read_b128 v[108:111], v5 offset:5120
    s_waitcnt lgkmcnt(4)
    v_mfma_f32_16x16x32_bf16 v[20:23], v[92:95], v[112:115], v[20:23]
    v_mfma_f32_16x16x32_bf16 v[56:59], v[92:95], v[116:119], v[56:59]
    ds_read_b128 v[88:91], v5 offset:6144
    s_waitcnt lgkmcnt(4)
    v_mfma_f32_16x16x32_bf16 v[24:27], v[96:99], v[112:115], v[24:27]
    v_mfma_f32_16x16x32_bf16 v[60:63], v[96:99], v[116:119], v[60:63]
    buffer_load_dwordx4 v1, s[8:11], s26 offen offset:3072 sc1 lds
    ds_read_b128 v[92:95], v5 offset:7168
    s_waitcnt lgkmcnt(4)
    v_mfma_f32_16x16x32_bf16 v[28:31], v[100:103], v[112:115], v[28:31]
    v_mfma_f32_16x16x32_bf16 v[64:67], v[100:103], v[116:119], v[64:67]
    ds_read_b128 v[96:99], v5 offset:8192
    s_waitcnt lgkmcnt(4)
    v_mfma_f32_16x16x32_bf16 v[32:35], v[104:107], v[112:115], v[32:35]
    v_mfma_f32_16x16x32_bf16 v[68:71], v[104:107], v[116:119], v[68:71]
    s_add_u32 m0, m0, 4096
    s_add_u32 s26, s26, 4096
    s_mov_b64 exec, s[22:23]
    buffer_load_dwordx4 v1, s[8:11], s26 offen sc1 lds
    s_mov_b64 exec, -1
    ds_read_b128 v[100:103], v5 offset:18432
    s_waitcnt lgkmcnt(4)
    v_mfma_f32_16x16x32_bf16 v[36:39], v[108:111], v[112:115], v[36:39]
    v_mfma_f32_16x16x32_bf16 v[72:75], v[108:111], v[116:119], v[72:75]
    ds_read_b128 v[104:107], v5 offset:19456
    s_waitcnt lgkmcnt(4)
    v_mfma_f32_16x16x32_bf16 v[40:43], v[88:91], v[112:115], v[40:43]
    v_mfma_f32_16x16x32_bf16 v[76:79], v[88:91], v[116:119], v[76:79]
    s_add_u32 s38, s38, 4096
    buffer_load_dwordx4 v[144:147], v1, s[12:15], s38 offen offset:0 sc1
    ds_read_b128 v[108:111], v5 offset:20480
    s_waitcnt lgkmcnt(4)
    v_mfma_f32_16x16x32_bf16 v[44:47], v[92:95], v[112:115], v[44:47]
    v_mfma_f32_16x16x32_bf16 v[80:83], v[92:95], v[116:119], v[80:83]
    ds_read_b128 v[88:91], v5 offset:21504
    s_waitcnt lgkmcnt(4)
    v_mfma_f32_16x16x32_bf16 v[48:51], v[96:99], v[112:115], v[48:51]
    v_mfma_f32_16x16x32_bf16 v[84:87], v[96:99], v[116:119], v[84:87]
    s_add_u32 s39, s39, 4096
    buffer_load_dwordx4 v[148:151], v1, s[12:15], s39 offen offset:0 sc1
    ds_read_b128 v[92:95], v5 offset:22528
    s_waitcnt lgkmcnt(4)
    v_mfma_f32_16x16x32_bf16 v[16:19], v[100:103], v[120:123], v[16:19]
    v_mfma_f32_16x16x32_bf16 v[52:55], v[100:103], v[124:127], v[52:55]
    ds_read_b128 v[96:99], v5 offset:23552
    s_waitcnt lgkmcnt(4)
    v_mfma_f32_16x16x32_bf16 v[20:23], v[104:107], v[120:123], v[20:23]
    v_mfma_f32_16x16x32_bf16 v[56:59], v[104:107], v[124:127], v[56:59]
    buffer_load_dwordx4 v[152:155], v1, s[12:15], s38 offen offset:1024 sc1
    ds_read_b128 v[100:103], v5 offset:24576
    s_waitcnt lgkmcnt(4)
    v_mfma_f32_16x16x32_bf16 v[24:27], v[108:111], v[120:123], v[24:27]
    v_mfma_f32_16x16x32_bf16 v[60:63], v[108:111], v[124:127], v[60:63]
    ds_read_b128 v[104:107], v5 offset:25600
    s_waitcnt lgkmcnt(4)
    v_mfma_f32_16x16x32_bf16 v[28:31], v[88:91], v[120:123], v[28:31]
    v_mfma_f32_16x16x32_bf16 v[64:67], v[88:91], v[124:127], v[64:67]
    buffer_load_dwordx4 v[156:159], v1, s[12:15], s39 offen offset:1024 sc1
    ds_read_b128 v[108:111], v5 offset:26624
    s_waitcnt lgkmcnt(4)
    v_mfma_f32_16x16x32_bf16 v[32:35], v[92:95], v[120:123], v[32:35]
    v_mfma_f32_16x16x32_bf16 v[68:71], v[92:95], v[124:127], v[68:71]
    s_waitcnt vmcnt(13)
    s_barrier
    ds_read_b128 v[88:91], v6 offset:0
    s_waitcnt lgkmcnt(4)
    v_mfma_f32_16x16x32_bf16 v[36:39], v[96:99], v[120:123], v[36:39]
    v_mfma_f32_16x16x32_bf16 v[72:75], v[96:99], v[124:127], v[72:75]
    s_add_u32 m0, s20, 0
    s_add_u32 s26, s33, s20
    s_add_u32 s26, s26, 258048
    buffer_load_dwordx4 v1, s[8:11], s26 offen offset:0 sc1 lds
    ds_read_b128 v[92:95], v6 offset:1024
    s_waitcnt lgkmcnt(4)
    v_mfma_f32_16x16x32_bf16 v[40:43], v[100:103], v[120:123], v[40:43]
    v_mfma_f32_16x16x32_bf16 v[76:79], v[100:103], v[124:127], v[76:79]
    ds_read_b128 v[96:99], v6 offset:2048
    s_waitcnt lgkmcnt(4)
    v_mfma_f32_16x16x32_bf16 v[44:47], v[104:107], v[120:123], v[44:47]
    v_mfma_f32_16x16x32_bf16 v[80:83], v[104:107], v[124:127], v[80:83]
    buffer_load_dwordx4 v1, s[8:11], s26 offen offset:1024 sc1 lds
    ds_read_b128 v[100:103], v6 offset:3072
    s_waitcnt lgkmcnt(4)
    v_mfma_f32_16x16x32_bf16 v[48:51], v[108:111], v[120:123], v[48:51]
    v_mfma_f32_16x16x32_bf16 v[84:87], v[108:111], v[124:127], v[84:87]
    ds_read_b128 v[104:107], v6 offset:4096
    s_waitcnt vmcnt(13) lgkmcnt(4)
    v_mfma_f32_16x16x32_bf16 v[16:19], v[88:91], v[128:131], v[16:19]
    v_mfma_f32_16x16x32_bf16 v[52:55], v[88:91], v[132:135], v[52:55]
    buffer_load_dwordx4 v1, s[8:11], s26 offen offset:2048 sc1 lds
    ds_read_b128 v[108:111], v6 offset:5120
    s_waitcnt lgkmcnt(4)
    v_mfma_f32_16x16x32_bf16 v[20:23], v[92:95], v[128:131], v[20:23]
    v_mfma_f32_16x16x32_bf16 v[56:59], v[92:95], v[132:135], v[56:59]
    ds_read_b128 v[88:91], v6 offset:6144
    s_waitcnt lgkmcnt(4)
    v_mfma_f32_16x16x32_bf16 v[24:27], v[96:99], v[128:131], v[24:27]
    v_mfma_f32_16x16x32_bf16 v[60:63], v[96:99], v[132:135], v[60:63]
    buffer_load_dwordx4 v1, s[8:11], s26 offen offset:3072 sc1 lds
    ds_read_b128 v[92:95], v6 offset:7168
    s_waitcnt lgkmcnt(4)
    v_mfma_f32_16x16x32_bf16 v[28:31], v[100:103], v[128:131], v[28:31]
    v_mfma_f32_16x16x32_bf16 v[64:67], v[100:103], v[132:135], v[64:67]
    ds_read_b128 v[96:99], v6 offset:8192
    s_waitcnt lgkmcnt(4)
    v_mfma_f32_16x16x32_bf16 v[32:35], v[104:107], v[128:131], v[32:35]
    v_mfma_f32_16x16x32_bf16 v[68:71], v[104:107], v[132:135], v[68:71]
    s_add_u32 m0, m0, 4096
    s_add_u32 s26, s26, 4096
    s_mov_b64 exec, s[22:23]
    buffer_load_dwordx4 v1, s[8:11], s26 offen sc1 lds
    s_mov_b64 exec, -1
    ds_read_b128 v[100:103], v6 offset:18432
    s_waitcnt lgkmcnt(4)
    v_mfma_f32_16x16x32_bf16 v[36:39], v[108:111], v[128:131], v[36:39]
    v_mfma_f32_16x16x32_bf16 v[72:75], v[108:111], v[132:135], v[72:75]
    ds_read_b128 v[104:107], v6 offset:19456
    s_waitcnt lgkmcnt(4)
    v_mfma_f32_16x16x32_bf16 v[40:43], v[88:91], v[128:131], v[40:43]
    v_mfma_f32_16x16x32_bf16 v[76:79], v[88:91], v[132:135], v[76:79]
    buffer_load_dwordx4 v[160:163], v1, s[12:15], s38 offen offset:2048 sc1
    ds_read_b128 v[108:111], v6 offset:20480
    s_waitcnt lgkmcnt(4)
    v_mfma_f32_16x16x32_bf16 v[44:47], v[92:95], v[128:131], v[44:47]
    v_mfma_f32_16x16x32_bf16 v[80:83], v[92:95], v[132:135], v[80:83]
    ds_read_b128 v[88:91], v6 offset:21504
    s_waitcnt lgkmcnt(4)
    v_mfma_f32_16x16x32_bf16 v[48:51], v[96:99], v[128:131], v[48:51]
    v_mfma_f32_16x16x32_bf16 v[84:87], v[96:99], v[132:135], v[84:87]
    buffer_load_dwordx4 v[164:167], v1, s[12:15], s39 offen offset:2048 sc1
    ds_read_b128 v[92:95], v6 offset:22528
    s_waitcnt vmcnt(16) lgkmcnt(4)
    v_mfma_f32_16x16x32_bf16 v[16:19], v[100:103], v[136:139], v[16:19]
    v_mfma_f32_16x16x32_bf16 v[52:55], v[100:103], v[140:143], v[52:55]
    ds_read_b128 v[96:99], v6 offset:23552
    s_waitcnt lgkmcnt(4)
    v_mfma_f32_16x16x32_bf16 v[20:23], v[104:107], v[136:139], v[20:23]
    v_mfma_f32_16x16x32_bf16 v[56:59], v[104:107], v[140:143], v[56:59]
    buffer_load_dwordx4 v[168:171], v1, s[12:15], s38 offen offset:3072 sc1
    ds_read_b128 v[100:103], v6 offset:24576
    s_waitcnt lgkmcnt(4)
    v_mfma_f32_16x16x32_bf16 v[24:27], v[108:111], v[136:139], v[24:27]
    v_mfma_f32_16x16x32_bf16 v[60:63], v[108:111], v[140:143], v[60:63]
    ds_read_b128 v[104:107], v6 offset:25600
    s_waitcnt lgkmcnt(4)
    v_mfma_f32_16x16x32_bf16 v[28:31], v[88:91], v[136:139], v[28:31]
    v_mfma_f32_16x16x32_bf16 v[64:67], v[88:91], v[140:143], v[64:67]
    buffer_load_dwordx4 v[172:175], v1, s[12:15], s39 offen offset:3072 sc1
    ds_read_b128 v[108:111], v6 offset:26624
    s_waitcnt lgkmcnt(4)
    v_mfma_f32_16x16x32_bf16 v[32:35], v[92:95], v[136:139], v[32:35]
    v_mfma_f32_16x16x32_bf16 v[68:71], v[92:95], v[140:143], v[68:71]
    s_waitcnt vmcnt(13)
    s_barrier
    ds_read_b128 v[88:91], v7 offset:0
    s_waitcnt lgkmcnt(4)
    v_mfma_f32_16x16x32_bf16 v[36:39], v[96:99], v[136:139], v[36:39]
    v_mfma_f32_16x16x32_bf16 v[72:75], v[96:99], v[140:143], v[72:75]
    s_add_u32 m0, s20, 36864
    s_add_u32 s26, s33, s20
    s_add_u32 s26, s26, 294912
    buffer_load_dwordx4 v1, s[8:11], s26 offen offset:0 sc1 lds
    ds_read_b128 v[92:95], v7 offset:1024
    s_waitcnt lgkmcnt(4)
    v_mfma_f32_16x16x32_bf16 v[40:43], v[100:103], v[136:139], v[40:43]
    v_mfma_f32_16x16x32_bf16 v[76:79], v[100:103], v[140:143], v[76:79]
    ds_read_b128 v[96:99], v7 offset:2048
    s_waitcnt lgkmcnt(4)
    v_mfma_f32_16x16x32_bf16 v[44:47], v[104:107], v[136:139], v[44:47]
    v_mfma_f32_16x16x32_bf16 v[80:83], v[104:107], v[140:143], v[80:83]
    buffer_load_dwordx4 v1, s[8:11], s26 offen offset:1024 sc1 lds
    ds_read_b128 v[100:103], v7 offset:3072
    s_waitcnt lgkmcnt(4)
    v_mfma_f32_16x16x32_bf16 v[48:51], v[108:111], v[136:139], v[48:51]
    v_mfma_f32_16x16x32_bf16 v[84:87], v[108:111], v[140:143], v[84:87]
    ds_read_b128 v[104:107], v7 offset:4096
    s_waitcnt vmcnt(13) lgkmcnt(4)
    v_mfma_f32_16x16x32_bf16 v[16:19], v[88:91], v[144:147], v[16:19]
    v_mfma_f32_16x16x32_bf16 v[52:55], v[88:91], v[148:151], v[52:55]
    buffer_load_dwordx4 v1, s[8:11], s26 offen offset:2048 sc1 lds
    ds_read_b128 v[108:111], v7 offset:5120
    s_waitcnt lgkmcnt(4)
    v_mfma_f32_16x16x32_bf16 v[20:23], v[92:95], v[144:147], v[20:23]
    v_mfma_f32_16x16x32_bf16 v[56:59], v[92:95], v[148:151], v[56:59]
    ds_read_b128 v[88:91], v7 offset:6144
    s_waitcnt lgkmcnt(4)
    v_mfma_f32_16x16x32_bf16 v[24:27], v[96:99], v[144:147], v[24:27]
    v_mfma_f32_16x16x32_bf16 v[60:63], v[96:99], v[148:151], v[60:63]
    buffer_load_dwordx4 v1, s[8:11], s26 offen offset:3072 sc1 lds
    ds_read_b128 v[92:95], v7 offset:7168
    s_waitcnt lgkmcnt(4)
    v_mfma_f32_16x16x32_bf16 v[28:31], v[100:103], v[144:147], v[28:31]
    v_mfma_f32_16x16x32_bf16 v[64:67], v[100:103], v[148:151], v[64:67]
    ds_read_b128 v[96:99], v7 offset:8192
    s_waitcnt lgkmcnt(4)
    v_mfma_f32_16x16x32_bf16 v[32:35], v[104:107], v[144:147], v[32:35]
    v_mfma_f32_16x16x32_bf16 v[68:71], v[104:107], v[148:151], v[68:71]
    s_add_u32 m0, m0, 4096
    s_add_u32 s26, s26, 4096
    s_mov_b64 exec, s[22:23]
    buffer_load_dwordx4 v1, s[8:11], s26 offen sc1 lds
    s_mov_b64 exec, -1
    ds_read_b128 v[100:103], v7 offset:18432
    s_waitcnt lgkmcnt(4)
    v_mfma_f32_16x16x32_bf16 v[36:39], v[108:111], v[144:147], v[36:39]
    v_mfma_f32_16x16x32_bf16 v[72:75], v[108:111], v[148:151], v[72:75]
    ds_read_b128 v[104:107], v7 offset:19456
    s_waitcnt lgkmcnt(4)
    v_mfma_f32_16x16x32_bf16 v[40:43], v[88:91], v[144:147], v[40:43]
    v_mfma_f32_16x16x32_bf16 v[76:79], v[88:91], v[148:151], v[76:79]
    s_add_u32 s38, s38, 4096
    buffer_load_dwordx4 v[112:115], v1, s[12:15], s38 offen offset:0 sc1
    ds_read_b128 v[108:111], v7 offset:20480
    s_waitcnt lgkmcnt(4)
    v_mfma_f32_16x16x32_bf16 v[44:47], v[92:95], v[144:147], v[44:47]
    v_mfma_f32_16x16x32_bf16 v[80:83], v[92:95], v[148:151], v[80:83]
    ds_read_b128 v[88:91], v7 offset:21504
    s_waitcnt lgkmcnt(4)
    v_mfma_f32_16x16x32_bf16 v[48:51], v[96:99], v[144:147], v[48:51]
    v_mfma_f32_16x16x32_bf16 v[84:87], v[96:99], v[148:151], v[84:87]
    s_add_u32 s39, s39, 4096
    buffer_load_dwordx4 v[116:119], v1, s[12:15], s39 offen offset:0 sc1
    ds_read_b128 v[92:95], v7 offset:22528
    s_waitcnt vmcnt(16) lgkmcnt(4)
    v_mfma_f32_16x16x32_bf16 v[16:19], v[100:103], v[152:155], v[16:19]
    v_mfma_f32_16x16x32_bf16 v[52:55], v[100:103], v[156:159], v[52:55]
    ds_read_b128 v[96:99], v7 offset:23552
    s_waitcnt lgkmcnt(4)
    v_mfma_f32_16x16x32_bf16 v[20:23], v[104:107], v[152:155], v[20:23]
    v_mfma_f32_16x16x32_bf16 v[56:59], v[104:107], v[156:159], v[56:59]
    buffer_load_dwordx4 v[120:123], v1, s[12:15], s38 offen offset:1024 sc1
    ds_read_b128 v[100:103], v7 offset:24576
    s_waitcnt lgkmcnt(4)
    v_mfma_f32_16x16x32_bf16 v[24:27], v[108:111], v[152:155], v[24:27]
    v_mfma_f32_16x16x32_bf16 v[60:63], v[108:111], v[156:159], v[60:63]
    ds_read_b128 v[104:107], v7 offset:25600
    s_waitcnt lgkmcnt(4)
    v_mfma_f32_16x16x32_bf16 v[28:31], v[88:91], v[152:155], v[28:31]
    v_mfma_f32_16x16x32_bf16 v[64:67], v[88:91], v[156:159], v[64:67]
    buffer_load_dwordx4 v[124:127], v1, s[12:15], s39 offen offset:1024 sc1
    ds_read_b128 v[108:111], v7 offset:26624
    s_waitcnt lgkmcnt(4)
    v_mfma_f32_16x16x32_bf16 v[32:35], v[92:95], v[152:155], v[32:35]
    v_mfma_f32_16x16x32_bf16 v[68:71], v[92:95], v[156:159], v[68:71]
    s_waitcnt vmcnt(13)
    s_barrier
    ds_read_b128 v[88:91], v4 offset:0
    s_waitcnt lgkmcnt(4)
    v_mfma_f32_16x16x32_bf16 v[36:39], v[96:99], v[152:155], v[36:39]
    v_mfma_f32_16x16x32_bf16 v[72:75], v[96:99], v[156:159], v[72:75]
    ds_read_b128 v[92:95], v4 offset:1024
    s_waitcnt lgkmcnt(4)
    v_mfma_f32_16x16x32_bf16 v[40:43], v[100:103], v[152:155], v[40:43]
    v_mfma_f32_16x16x32_bf16 v[76:79], v[100:103], v[156:159], v[76:79]
    ds_read_b128 v[96:99], v4 offset:2048
    s_waitcnt lgkmcnt(4)
    v_mfma_f32_16x16x32_bf16 v[44:47], v[104:107], v[152:155], v[44:47]
    v_mfma_f32_16x16x32_bf16 v[80:83], v[104:107], v[156:159], v[80:83]
    ds_read_b128 v[100:103], v4 offset:3072
    s_waitcnt lgkmcnt(4)
    v_mfma_f32_16x16x32_bf16 v[48:51], v[108:111], v[152:155], v[48:51]
    v_mfma_f32_16x16x32_bf16 v[84:87], v[108:111], v[156:159], v[84:87]
    ds_read_b128 v[104:107], v4 offset:4096
    s_waitcnt vmcnt(11) lgkmcnt(4)
    v_mfma_f32_16x16x32_bf16 v[16:19], v[88:91], v[160:163], v[16:19]
    v_mfma_f32_16x16x32_bf16 v[52:55], v[88:91], v[164:167], v[52:55]
    ds_read_b128 v[108:111], v4 offset:5120
    s_waitcnt lgkmcnt(4)
    v_mfma_f32_16x16x32_bf16 v[20:23], v[92:95], v[160:163], v[20:23]
    v_mfma_f32_16x16x32_bf16 v[56:59], v[92:95], v[164:167], v[56:59]
    ds_read_b128 v[88:91], v4 offset:6144
    s_waitcnt lgkmcnt(4)
    v_mfma_f32_16x16x32_bf16 v[24:27], v[96:99], v[160:163], v[24:27]
    v_mfma_f32_16x16x32_bf16 v[60:63], v[96:99], v[164:167], v[60:63]
    ds_read_b128 v[92:95], v4 offset:7168
    s_waitcnt lgkmcnt(4)
    v_mfma_f32_16x16x32_bf16 v[28:31], v[100:103], v[160:163], v[28:31]
    v_mfma_f32_16x16x32_bf16 v[64:67], v[100:103], v[164:167], v[64:67]
    ds_read_b128 v[96:99], v4 offset:8192
    s_waitcnt lgkmcnt(4)
    v_mfma_f32_16x16x32_bf16 v[32:35], v[104:107], v[160:163], v[32:35]
    v_mfma_f32_16x16x32_bf16 v[68:71], v[104:107], v[164:167], v[68:71]
    ds_read_b128 v[100:103], v4 offset:18432
    s_waitcnt lgkmcnt(4)
    v_mfma_f32_16x16x32_bf16 v[36:39], v[108:111], v[160:163], v[36:39]
    v_mfma_f32_16x16x32_bf16 v[72:75], v[108:111], v[164:167], v[72:75]
    ds_read_b128 v[104:107], v4 offset:19456
    s_waitcnt lgkmcnt(4)
    v_mfma_f32_16x16x32_bf16 v[40:43], v[88:91], v[160:163], v[40:43]
    v_mfma_f32_16x16x32_bf16 v[76:79], v[88:91], v[164:167], v[76:79]
    ds_read_b128 v[108:111], v4 offset:20480
    s_waitcnt lgkmcnt(4)
    v_mfma_f32_16x16x32_bf16 v[44:47], v[92:95], v[160:163], v[44:47]
    v_mfma_f32_16x16x32_bf16 v[80:83], v[92:95], v[164:167], v[80:83]
    ds_read_b128 v[88:91], v4 offset:21504
    s_waitcnt lgkmcnt(4)
    v_mfma_f32_16x16x32_bf16 v[48:51], v[96:99], v[160:163], v[48:51]
    v_mfma_f32_16x16x32_bf16 v[84:87], v[96:99], v[164:167], v[84:87]
    ds_read_b128 v[92:95], v4 offset:22528
    s_waitcnt vmcnt(9) lgkmcnt(4)
    v_mfma_f32_16x16x32_bf16 v[16:19], v[100:103], v[168:171], v[16:19]
    v_mfma_f32_16x16x32_bf16 v[52:55], v[100:103], v[172:175], v[52:55]
    ds_read_b128 v[96:99], v4 offset:23552
    s_waitcnt lgkmcnt(4)
    v_mfma_f32_16x16x32_bf16 v[20:23], v[104:107], v[168:171], v[20:23]
    v_mfma_f32_16x16x32_bf16 v[56:59], v[104:107], v[172:175], v[56:59]
    ds_read_b128 v[100:103], v4 offset:24576
    s_waitcnt lgkmcnt(4)
    v_mfma_f32_16x16x32_bf16 v[24:27], v[108:111], v[168:171], v[24:27]
    v_mfma_f32_16x16x32_bf16 v[60:63], v[108:111], v[172:175], v[60:63]
    ds_read_b128 v[104:107], v4 offset:25600
    s_waitcnt lgkmcnt(4)
    v_mfma_f32_16x16x32_bf16 v[28:31], v[88:91], v[168:171], v[28:31]
    v_mfma_f32_16x16x32_bf16 v[64:67], v[88:91], v[172:175], v[64:67]
    ds_read_b128 v[108:111], v4 offset:26624
    s_waitcnt lgkmcnt(4)
    v_mfma_f32_16x16x32_bf16 v[32:35], v[92:95], v[168:171], v[32:35]
    v_mfma_f32_16x16x32_bf16 v[68:71], v[92:95], v[172:175], v[68:71]
    s_waitcnt vmcnt(4)
    s_barrier
    ds_read_b128 v[88:91], v5 offset:0
    s_waitcnt lgkmcnt(4)
    v_mfma_f32_16x16x32_bf16 v[36:39], v[96:99], v[168:171], v[36:39]
    v_mfma_f32_16x16x32_bf16 v[72:75], v[96:99], v[172:175], v[72:75]
    ds_read_b128 v[92:95], v5 offset:1024
    s_waitcnt lgkmcnt(4)
    v_mfma_f32_16x16x32_bf16 v[40:43], v[100:103], v[168:171], v[40:43]
    v_mfma_f32_16x16x32_bf16 v[76:79], v[100:103], v[172:175], v[76:79]
    ds_read_b128 v[96:99], v5 offset:2048
    s_waitcnt lgkmcnt(4)
    v_mfma_f32_16x16x32_bf16 v[44:47], v[104:107], v[168:171], v[44:47]
    v_mfma_f32_16x16x32_bf16 v[80:83], v[104:107], v[172:175], v[80:83]
    ds_read_b128 v[100:103], v5 offset:3072
    s_waitcnt lgkmcnt(4)
    v_mfma_f32_16x16x32_bf16 v[48:51], v[108:111], v[168:171], v[48:51]
    v_mfma_f32_16x16x32_bf16 v[84:87], v[108:111], v[172:175], v[84:87]
    ds_read_b128 v[104:107], v5 offset:4096
    s_waitcnt vmcnt(2) lgkmcnt(4)
    v_mfma_f32_16x16x32_bf16 v[16:19], v[88:91], v[112:115], v[16:19]
    v_mfma_f32_16x16x32_bf16 v[52:55], v[88:91], v[116:119], v[52:55]
    ds_read_b128 v[108:111], v5 offset:5120
    s_waitcnt lgkmcnt(4)
    v_mfma_f32_16x16x32_bf16 v[20:23], v[92:95], v[112:115], v[20:23]
    v_mfma_f32_16x16x32_bf16 v[56:59], v[92:95], v[116:119], v[56:59]
    ds_read_b128 v[88:91], v5 offset:6144
    s_waitcnt lgkmcnt(4)
    v_mfma_f32_16x16x32_bf16 v[24:27], v[96:99], v[112:115], v[24:27]
    v_mfma_f32_16x16x32_bf16 v[60:63], v[96:99], v[116:119], v[60:63]
    ds_read_b128 v[92:95], v5 offset:7168
    s_waitcnt lgkmcnt(4)
    v_mfma_f32_16x16x32_bf16 v[28:31], v[100:103], v[112:115], v[28:31]
    v_mfma_f32_16x16x32_bf16 v[64:67], v[100:103], v[116:119], v[64:67]
    ds_read_b128 v[96:99], v5 offset:8192
    s_waitcnt lgkmcnt(4)
    v_mfma_f32_16x16x32_bf16 v[32:35], v[104:107], v[112:115], v[32:35]
    v_mfma_f32_16x16x32_bf16 v[68:71], v[104:107], v[116:119], v[68:71]
    ds_read_b128 v[100:103], v5 offset:18432
    s_waitcnt lgkmcnt(4)
    v_mfma_f32_16x16x32_bf16 v[36:39], v[108:111], v[112:115], v[36:39]
    v_mfma_f32_16x16x32_bf16 v[72:75], v[108:111], v[116:119], v[72:75]
    ds_read_b128 v[104:107], v5 offset:19456
    s_waitcnt lgkmcnt(4)
    v_mfma_f32_16x16x32_bf16 v[40:43], v[88:91], v[112:115], v[40:43]
    v_mfma_f32_16x16x32_bf16 v[76:79], v[88:91], v[116:119], v[76:79]
    ds_read_b128 v[108:111], v5 offset:20480
    s_waitcnt lgkmcnt(4)
    v_mfma_f32_16x16x32_bf16 v[44:47], v[92:95], v[112:115], v[44:47]
    v_mfma_f32_16x16x32_bf16 v[80:83], v[92:95], v[116:119], v[80:83]
    ds_read_b128 v[88:91], v5 offset:21504
    s_waitcnt lgkmcnt(4)
    v_mfma_f32_16x16x32_bf16 v[48:51], v[96:99], v[112:115], v[48:51]
    v_mfma_f32_16x16x32_bf16 v[84:87], v[96:99], v[116:119], v[84:87]
    ds_read_b128 v[92:95], v5 offset:22528
    s_waitcnt vmcnt(0) lgkmcnt(4)
    v_mfma_f32_16x16x32_bf16 v[16:19], v[100:103], v[120:123], v[16:19]
    v_mfma_f32_16x16x32_bf16 v[52:55], v[100:103], v[124:127], v[52:55]
    ds_read_b128 v[96:99], v5 offset:23552
    s_waitcnt lgkmcnt(4)
    v_mfma_f32_16x16x32_bf16 v[20:23], v[104:107], v[120:123], v[20:23]
    v_mfma_f32_16x16x32_bf16 v[56:59], v[104:107], v[124:127], v[56:59]
    ds_read_b128 v[100:103], v5 offset:24576
    s_waitcnt lgkmcnt(4)
    v_mfma_f32_16x16x32_bf16 v[24:27], v[108:111], v[120:123], v[24:27]
    v_mfma_f32_16x16x32_bf16 v[60:63], v[108:111], v[124:127], v[60:63]
    ds_read_b128 v[104:107], v5 offset:25600
    s_waitcnt lgkmcnt(4)
    v_mfma_f32_16x16x32_bf16 v[28:31], v[88:91], v[120:123], v[28:31]
    v_mfma_f32_16x16x32_bf16 v[64:67], v[88:91], v[124:127], v[64:67]
    ds_read_b128 v[108:111], v5 offset:26624
    s_waitcnt lgkmcnt(4)
    v_mfma_f32_16x16x32_bf16 v[32:35], v[92:95], v[120:123], v[32:35]
    v_mfma_f32_16x16x32_bf16 v[68:71], v[92:95], v[124:127], v[68:71]
    s_waitcnt lgkmcnt(3)
    v_mfma_f32_16x16x32_bf16 v[36:39], v[96:99], v[120:123], v[36:39]
    v_mfma_f32_16x16x32_bf16 v[72:75], v[96:99], v[124:127], v[72:75]
    s_waitcnt lgkmcnt(2)
    v_mfma_f32_16x16x32_bf16 v[40:43], v[100:103], v[120:123], v[40:43]
    v_mfma_f32_16x16x32_bf16 v[76:79], v[100:103], v[124:127], v[76:79]
    s_waitcnt lgkmcnt(1)
    v_mfma_f32_16x16x32_bf16 v[44:47], v[104:107], v[120:123], v[44:47]
    v_mfma_f32_16x16x32_bf16 v[80:83], v[104:107], v[124:127], v[80:83]
    s_waitcnt lgkmcnt(0)
    v_mfma_f32_16x16x32_bf16 v[48:51], v[108:111], v[120:123], v[48:51]
    v_mfma_f32_16x16x32_bf16 v[84:87], v[108:111], v[124:127], v[84:87]
    s_mul_i32 s26, s16, 9216
    s_add_u32 s26, s26, 73728
    v_add_u32 v8, s26, v1
    s_xor_b32 s26, s16, 4
    s_mul_i32 s26, s26, 9216
    s_add_u32 s26, s26, 73728
    v_add_u32 v9, s26, v1
    ds_write_b128 v8, v[52:55] offset:0
    ds_write_b128 v8, v[56:59] offset:1024
    ds_write_b128 v8, v[60:63] offset:2048
    ds_write_b128 v8, v[64:67] offset:3072
    ds_write_b128 v8, v[68:71] offset:4096
    ds_write_b128 v8, v[72:75] offset:5120
    ds_write_b128 v8, v[76:79] offset:6144
    ds_write_b128 v8, v[80:83] offset:7168
    ds_write_b128 v8, v[84:87] offset:8192
    s_lshl_b32 s40, s36, 2
    s_add_u32 s40, s40, s32
    s_mul_i32 s41, s40, 4608
    s_mul_i32 s40, s40, 20480
    s_add_u32 s40, s40, 33816576
    s_mul_i32 s45, s30, 5120
    s_add_u32 s45, s40, s45
    v_lshlrev_b32 v12, 3, v0
    v_add_u32 v7, 4096, v12
    s_lshl_b32 s44, s30, 10
    v_add_u32 v10, s44, v1
    v_lshrrev_b32 v11, 1, v3
    v_lshlrev_b32 v11, 8, v11
    v_lshl_add_u32 v11, v2, 4, v11
    v_and_b32 v4, 1, v3
    v_lshl_add_u32 v11, v4, 3, v11
    v_add_u32 v11, 4096, v11
    s_add_u32 s44, s41, 2424832
    buffer_load_dwordx4 v[112:115], v10, s[12:15], s44 offen sc1
    buffer_load_dwordx2 v[116:117], v11, s[12:15], s44 offen sc1
    s_lshl_b32 s44, s30, 10
    v_add_u32 v15, s44, v1
    s_lshl_b32 s44, s30, 4
    s_lshl_b64 s[42:43], 0xffff, s44
    v_mov_b32 v4, 0x00003f80
    v_mov_b32 v5, 0x3f800000
    v_mov_b32 v6, 0x3f803f80
    s_waitcnt lgkmcnt(0)
    s_barrier
    ds_read_b128 v[52:55], v9 offset:0
    ds_read_b128 v[56:59], v9 offset:1024
    ds_read_b128 v[60:63], v9 offset:2048
    ds_read_b128 v[64:67], v9 offset:3072
    ds_read_b128 v[68:71], v9 offset:4096
    ds_read_b128 v[72:75], v9 offset:5120
    ds_read_b128 v[76:79], v9 offset:6144
    ds_read_b128 v[80:83], v9 offset:7168
    ds_read_b128 v[84:87], v9 offset:8192
    s_waitcnt lgkmcnt(8)
    v_add_f32 v16, v16, v52
    v_add_f32 v17, v17, v53
    v_add_f32 v18, v18, v54
    v_add_f32 v19, v19, v55
    s_waitcnt lgkmcnt(7)
    v_add_f32 v20, v20, v56
    v_add_f32 v21, v21, v57
    v_add_f32 v22, v22, v58
    v_add_f32 v23, v23, v59
    s_waitcnt lgkmcnt(6)
    v_add_f32 v24, v24, v60
    v_add_f32 v25, v25, v61
    v_add_f32 v26, v26, v62
    v_add_f32 v27, v27, v63
    s_waitcnt lgkmcnt(5)
    v_add_f32 v28, v28, v64
    v_add_f32 v29, v29, v65
    v_add_f32 v30, v30, v66
    v_add_f32 v31, v31, v67
    s_waitcnt lgkmcnt(4)
    v_add_f32 v32, v32, v68
    v_add_f32 v33, v33, v69
    v_add_f32 v34, v34, v70
    v_add_f32 v35, v35, v71
    s_waitcnt lgkmcnt(3)
    v_add_f32 v36, v36, v72
    v_add_f32 v37, v37, v73
    v_add_f32 v38, v38, v74
    v_add_f32 v39, v39, v75
    s_waitcnt lgkmcnt(2)
    v_add_f32 v40, v40, v76
    v_add_f32 v41, v41, v77
    v_add_f32 v42, v42, v78
    v_add_f32 v43, v43, v79
    s_waitcnt lgkmcnt(1)
    v_add_f32 v44, v44, v80
    v_add_f32 v45, v45, v81
    v_add_f32 v46, v46, v82
    v_add_f32 v47, v47, v83
    s_waitcnt lgkmcnt(0)
    v_add_f32 v48, v48, v84
    v_add_f32 v49, v49, v85
    v_add_f32 v50, v50, v86
    v_add_f32 v51, v51, v87
    s_cmp_eq_u32 s30, 0
    s_cbranch_scc1 Lm115_own
    v_cvt_pk_bf16_f32 v88, v16, v20
    v_cvt_pk_bf16_f32 v89, v24, v28
    v_cvt_pk_bf16_f32 v90, v32, v36
    v_cvt_pk_bf16_f32 v91, v40, v44
    buffer_store_dwordx4 v[88:91], v1, s[12:15], s45 offen offset:0 sc1
    s_branch Lm116_nxt
Lm115_own:
    v_mov_b32 v168, v16
    v_mov_b32 v169, v20
    v_mov_b32 v170, v24
    v_mov_b32 v171, v28
    v_mov_b32 v172, v32
    v_mov_b32 v173, v36
    v_mov_b32 v174, v40
    v_mov_b32 v175, v44
Lm116_nxt:
    s_cmp_eq_u32 s30, 1
    s_cbranch_scc1 Lm117_own
    v_cvt_pk_bf16_f32 v92, v17, v21
    v_cvt_pk_bf16_f32 v93, v25, v29
    v_cvt_pk_bf16_f32 v94, v33, v37
    v_cvt_pk_bf16_f32 v95, v41, v45
    buffer_store_dwordx4 v[92:95], v1, s[12:15], s45 offen offset:1024 sc1
    s_branch Lm118_nxt
Lm117_own:
    v_mov_b32 v168, v17
    v_mov_b32 v169, v21
    v_mov_b32 v170, v25
    v_mov_b32 v171, v29
    v_mov_b32 v172, v33
    v_mov_b32 v173, v37
    v_mov_b32 v174, v41
    v_mov_b32 v175, v45
Lm118_nxt:
    s_cmp_eq_u32 s30, 2
    s_cbranch_scc1 Lm119_own
    v_cvt_pk_bf16_f32 v96, v18, v22
    v_cvt_pk_bf16_f32 v97, v26, v30
    v_cvt_pk_bf16_f32 v98, v34, v38
    v_cvt_pk_bf16_f32 v99, v42, v46
    buffer_store_dwordx4 v[96:99], v1, s[12:15], s45 offen offset:2048 sc1
    s_branch Lm120_nxt
Lm119_own:
    v_mov_b32 v168, v18
    v_mov_b32 v169, v22
    v_mov_b32 v170, v26
    v_mov_b32 v171, v30
    v_mov_b32 v172, v34
    v_mov_b32 v173, v38
    v_mov_b32 v174, v42
    v_mov_b32 v175, v46
Lm120_nxt:
    s_cmp_eq_u32 s30, 3
    s_cbranch_scc1 Lm121_own
    v_cvt_pk_bf16_f32 v100, v19, v23
    v_cvt_pk_bf16_f32 v101, v27, v31
    v_cvt_pk_bf16_f32 v102, v35, v39
    v_cvt_pk_bf16_f32 v103, v43, v47
    buffer_store_dwordx4 v[100:103], v1, s[12:15], s45 offen offset:3072 sc1
    s_branch Lm122_nxt
Lm121_own:
    v_mov_b32 v168, v19
    v_mov_b32 v169, v23
    v_mov_b32 v170, v27
    v_mov_b32 v171, v31
    v_mov_b32 v172, v35
    v_mov_b32 v173, v39
    v_mov_b32 v174, v43
    v_mov_b32 v175, v47
Lm122_nxt:
    v_cvt_pk_bf16_f32 v104, v48, v49
    v_cvt_pk_bf16_f32 v105, v50, v51
    buffer_store_dwordx2 v[104:105], v7, s[12:15], s45 offen sc1
    v_mov_b32 v176, v48
    v_mov_b32 v177, v49
    v_mov_b32 v178, v50
    v_mov_b32 v179, v51
    s_waitcnt vmcnt(0) lgkmcnt(0)
    s_barrier
    s_cmp_lg_u32 s16, 0
    s_cbranch_scc1 Lm123_pub
    v_mov_b32 v13, s79
    v_mov_b32 v14, s80
    s_mov_b64 exec, 1
    buffer_store_dword v14, v13, s[12:15], s19 offen sc1
    s_mov_b64 exec, -1
Lm123_pub:
    s_cmp_eq_u32 s16, 7
    s_cbranch_scc1 Lm124_p
    s_cmp_lg_u32 s79, 0
    s_cbranch_scc1 Lm128_pq
    s_cmp_ge_u32 s2, 192
    s_cbranch_scc1 Lm128_pq
    s_add_u32 m0, s20, 0
    s_add_u32 s26, s46, s20
    s_add_u32 s26, s26, 0
    buffer_load_dwordx4 v1, s[8:11], s26 offen offset:0 sc1 lds
    buffer_load_dwordx4 v1, s[8:11], s26 offen offset:1024 sc1 lds
    buffer_load_dwordx4 v1, s[8:11], s26 offen offset:2048 sc1 lds
    buffer_load_dwordx4 v1, s[8:11], s26 offen offset:3072 sc1 lds
    s_add_u32 m0, m0, 4096
    s_add_u32 s26, s26, 4096
    s_mov_b64 exec, s[22:23]
    buffer_load_dwordx4 v1, s[8:11], s26 offen sc1 lds
    s_mov_b64 exec, -1
    s_add_u32 m0, s20, 36864
    s_add_u32 s26, s46, s20
    s_add_u32 s26, s26, 36864
    buffer_load_dwordx4 v1, s[8:11], s26 offen offset:0 sc1 lds
    buffer_load_dwordx4 v1, s[8:11], s26 offen offset:1024 sc1 lds
    buffer_load_dwordx4 v1, s[8:11], s26 offen offset:2048 sc1 lds
    buffer_load_dwordx4 v1, s[8:11], s26 offen offset:3072 sc1 lds
    s_add_u32 m0, m0, 4096
    s_add_u32 s26, s26, 4096
    s_mov_b64 exec, s[22:23]
    buffer_load_dwordx4 v1, s[8:11], s26 offen sc1 lds
    s_mov_b64 exec, -1
Lm128_pq:
    s_barrier
    s_branch Lm125_j
Lm124_p:
    v_lshl_add_u32 v13, v0, 7, s79
    s_mov_b32 s3, 0x40000
    s_mov_b32 exec_lo, 15
    s_mov_b32 exec_hi, 0
Lm126_l:
    buffer_load_dword v14, v13, s[12:15], s28 offen sc1
    s_waitcnt vmcnt(0)
    v_cmp_ne_u32 vcc, s80, v14
    s_sub_u32 s3, s3, 1
    s_cbranch_scc1 Lm127_d
    s_nop 2
    s_cbranch_vccz Lm127_d
    s_sleep 4
    s_branch Lm126_l
Lm127_d:
    s_mov_b64 exec, -1
    s_barrier
    s_cmp_lg_u32 s79, 0
    s_cbranch_scc1 Lm129_pq
    s_cmp_ge_u32 s2, 192
    s_cbranch_scc1 Lm129_pq
    s_add_u32 m0, s20, 0
    s_add_u32 s26, s46, s20
    s_add_u32 s26, s26, 0
    buffer_load_dwordx4 v1, s[8:11], s26 offen offset:0 sc1 lds
    buffer_load_dwordx4 v1, s[8:11], s26 offen offset:1024 sc1 lds
    buffer_load_dwordx4 v1, s[8:11], s26 offen offset:2048 sc1 lds
    buffer_load_dwordx4 v1, s[8:11], s26 offen offset:3072 sc1 lds
    s_add_u32 m0, m0, 4096
    s_add_u32 s26, s26, 4096
    s_mov_b64 exec, s[22:23]
    buffer_load_dwordx4 v1, s[8:11], s26 offen sc1 lds
    s_mov_b64 exec, -1
    s_add_u32 m0, s20, 36864
    s_add_u32 s26, s46, s20
    s_add_u32 s26, s26, 36864
    buffer_load_dwordx4 v1, s[8:11], s26 offen offset:0 sc1 lds
    buffer_load_dwordx4 v1, s[8:11], s26 offen offset:1024 sc1 lds
    buffer_load_dwordx4 v1, s[8:11], s26 offen offset:2048 sc1 lds
    buffer_load_dwordx4 v1, s[8:11], s26 offen offset:3072 sc1 lds
    s_add_u32 m0, m0, 4096
    s_add_u32 s26, s26, 4096
    s_mov_b64 exec, s[22:23]
    buffer_load_dwordx4 v1, s[8:11], s26 offen sc1 lds
    s_mov_b64 exec, -1
Lm129_pq:
Lm125_j:
    s_add_u32 s44, s30, 1
    s_and_b32 s44, s44, 3
    s_mul_i32 s44, s44, 5120
    s_add_u32 s44, s44, s40
    buffer_load_dwordx4 v[120:123], v15, s[12:15], s44 offen sc1
    buffer_load_dwordx2 v[124:125], v7, s[12:15], s44 offen sc1
    s_add_u32 s44, s30, 2
    s_and_b32 s44, s44, 3
    s_mul_i32 s44, s44, 5120
    s_add_u32 s44, s44, s40
    buffer_load_dwordx4 v[126:129], v15, s[12:15], s44 offen sc1
    buffer_load_dwordx2 v[130:131], v7, s[12:15], s44 offen sc1
    s_add_u32 s44, s30, 3
    s_and_b32 s44, s44, 3
    s_mul_i32 s44, s44, 5120
    s_add_u32 s44, s44, s40
    buffer_load_dwordx4 v[132:135], v15, s[12:15], s44 offen sc1
    buffer_load_dwordx2 v[136:137], v7, s[12:15], s44 offen sc1
    s_waitcnt vmcnt(4)
    v_dot2c_f32_bf16 v168, v120, v4
    v_dot2c_f32_bf16 v169, v120, v5
    v_dot2c_f32_bf16 v170, v121, v4
    v_dot2c_f32_bf16 v171, v121, v5
    v_dot2c_f32_bf16 v172, v122, v4
    v_dot2c_f32_bf16 v173, v122, v5
    v_dot2c_f32_bf16 v174, v123, v4
    v_dot2c_f32_bf16 v175, v123, v5
    v_dot2c_f32_bf16 v176, v124, v4
    v_dot2c_f32_bf16 v177, v124, v5
    v_dot2c_f32_bf16 v178, v125, v4
    v_dot2c_f32_bf16 v179, v125, v5
    s_waitcnt vmcnt(2)
    v_dot2c_f32_bf16 v168, v126, v4
    v_dot2c_f32_bf16 v169, v126, v5
    v_dot2c_f32_bf16 v170, v127, v4
    v_dot2c_f32_bf16 v171, v127, v5
    v_dot2c_f32_bf16 v172, v128, v4
    v_dot2c_f32_bf16 v173, v128, v5
    v_dot2c_f32_bf16 v174, v129, v4
    v_dot2c_f32_bf16 v175, v129, v5
    v_dot2c_f32_bf16 v176, v130, v4
    v_dot2c_f32_bf16 v177, v130, v5
    v_dot2c_f32_bf16 v178, v131, v4
    v_dot2c_f32_bf16 v179, v131, v5
    s_waitcnt vmcnt(0)
    v_dot2c_f32_bf16 v168, v132, v4
    v_dot2c_f32_bf16 v169, v132, v5
    v_dot2c_f32_bf16 v170, v133, v4
    v_dot2c_f32_bf16 v171, v133, v5
    v_dot2c_f32_bf16 v172, v134, v4
    v_dot2c_f32_bf16 v173, v134, v5
    v_dot2c_f32_bf16 v174, v135, v4
    v_dot2c_f32_bf16 v175, v135, v5
    v_dot2c_f32_bf16 v176, v136, v4
    v_dot2c_f32_bf16 v177, v136, v5
    v_dot2c_f32_bf16 v178, v137, v4
    v_dot2c_f32_bf16 v179, v137, v5
    s_nop 2
    v_cvt_pk_bf16_f32 v88, v168, v169
    v_cvt_pk_bf16_f32 v89, v170, v171
    v_lshlrev_b32 v96, 16, v112
    v_and_b32 v97, 0xffff0000, v112
    v_lshlrev_b32 v98, 16, v113
    v_and_b32 v99, 0xffff0000, v113
    v_lshlrev_b32 v168, 16, v88
    v_and_b32 v169, 0xffff0000, v88
    v_lshlrev_b32 v170, 16, v89
    v_and_b32 v171, 0xffff0000, v89
    v_add_f32 v168, v168, v96
    v_add_f32 v169, v169, v97
    v_add_f32 v170, v170, v98
    v_add_f32 v171, v171, v99
    v_cvt_pk_bf16_f32 v88, v168, v169
    v_cvt_pk_bf16_f32 v89, v170, v171
    v_cvt_pk_bf16_f32 v90, v172, v173
    v_cvt_pk_bf16_f32 v91, v174, v175
    v_lshlrev_b32 v96, 16, v114
    v_and_b32 v97, 0xffff0000, v114
    v_lshlrev_b32 v98, 16, v115
    v_and_b32 v99, 0xffff0000, v115
    v_lshlrev_b32 v172, 16, v90
    v_and_b32 v173, 0xffff0000, v90
    v_lshlrev_b32 v174, 16, v91
    v_and_b32 v175, 0xffff0000, v91
    v_add_f32 v172, v172, v96
    v_add_f32 v173, v173, v97
    v_add_f32 v174, v174, v98
    v_add_f32 v175, v175, v99
    v_cvt_pk_bf16_f32 v90, v172, v173
    v_cvt_pk_bf16_f32 v91, v174, v175
    v_cvt_pk_bf16_f32 v92, v176, v177
    v_cvt_pk_bf16_f32 v93, v178, v179
    v_lshlrev_b32 v96, 16, v116
    v_and_b32 v97, 0xffff0000, v116
    v_lshlrev_b32 v98, 16, v117
    v_and_b32 v99, 0xffff0000, v117
    v_lshlrev_b32 v176, 16, v92
    v_and_b32 v177, 0xffff0000, v92
    v_lshlrev_b32 v178, 16, v93
    v_and_b32 v179, 0xffff0000, v93
    v_add_f32 v176, v176, v96
    v_add_f32 v177, v177, v97
    v_add_f32 v178, v178, v98
    v_add_f32 v179, v179, v99
    v_cvt_pk_bf16_f32 v92, v176, v177
    v_cvt_pk_bf16_f32 v93, v178, v179
    s_cmp_lg_u32 s79, 0
    s_cbranch_scc1 Lm130_ffin
    s_add_u32 s44, s41, 65536
    v_mov_b32 v16, 0
    v_mov_b32 v17, 0
    buffer_store_dwordx4 v[88:91], v10, s[12:15], s44 offen sc1
    v_dot2c_f32_bf16 v16, v88, v6
    v_dot2c_f32_bf16 v17, v88, v88
    v_dot2c_f32_bf16 v16, v89, v6
    v_dot2c_f32_bf16 v17, v89, v89
    v_dot2c_f32_bf16 v16, v90, v6
    v_dot2c_f32_bf16 v17, v90, v90
    v_dot2c_f32_bf16 v16, v91, v6
    v_dot2c_f32_bf16 v17, v91, v91
    s_mov_b64 exec, s[42:43]
    buffer_store_dwordx2 v[92:93], v11, s[12:15], s44 offen sc1
    v_dot2c_f32_bf16 v16, v92, v6
    v_dot2c_f32_bf16 v17, v92, v92
    v_dot2c_f32_bf16 v16, v93, v6
    v_dot2c_f32_bf16 v17, v93, v93
    s_mov_b64 exec, -1
    s_lshl_b32 s44, s36, 4
    s_lshl_b32 s45, s32, 2
    s_add_u32 s44, s44, s45
    s_add_u32 s44, s44, s30
    s_lshl_b32 s44, s44, 7
    s_add_u32 s44, s44, 45088768
    v_mov_b32 v18, v16
    v_mov_b32 v19, v17
    s_nop 0
    v_permlane32_swap_b32 v16, v18
    v_permlane32_swap_b32 v17, v19
    v_add_f32 v16, v16, v18
    v_add_f32 v17, v17, v19
    v_mov_b32 v18, v16
    v_mov_b32 v19, v17
    s_nop 0
    v_permlane16_swap_b32 v16, v18
    v_permlane16_swap_b32 v17, v19
    v_add_f32 v16, v16, v18
    v_add_f32 v17, v17, v19
    s_mov_b64 exec, 0xffff
    buffer_store_dwordx2 v[16:17], v12, s[12:15], s44 offen sc1
    s_mov_b64 exec, -1
    s_waitcnt vmcnt(0) lgkmcnt(0)
    s_barrier
    s_cmp_lg_u32 s16, 0
    s_cbranch_scc1 Lm132_pub
    v_mov_b32 v13, s79
    v_mov_b32 v14, s80
    s_mov_b64 exec, 1
    buffer_store_dword v14, v13, s[12:15], s29 offen sc1
    s_mov_b64 exec, -1
Lm132_pub:
    s_mov_b32 s79, 262144
    s_branch Lm2_loop
Lm130_ffin:
    s_mov_b32 s44, s6
    s_mov_b32 s45, s7
    s_mov_b32 s46, 2359296
    s_mov_b32 s47, 0x20000
    s_mul_i32 s40, s36, 18432
    s_mul_i32 s41, s32, 288
    s_add_u32 s40, s40, s41
    s_lshl_b32 s41, s30, 6
    s_add_u32 s41, s41, s40
    v_mul_u32_u24 v10, 1152, v2
    v_lshl_add_u32 v11, v3, 3, v10
    v_lshl_add_u32 v10, v3, 4, v10
    buffer_store_dwordx4 v[88:91], v10, s[44:47], s41 offen
    s_mov_b64 exec, s[42:43]
    buffer_store_dwordx2 v[92:93], v11, s[44:47], s40 offen offset:256
    s_mov_b64 exec, -1
Lm1_exit:
    s_endpgm
Lm_code_end:
.section .rodata,"a"
.p2align 6
.amdhsa_kernel interleave_layers__softmax_full_mha__glu_gated_swiglu__prompt_kernel
  .amdhsa_next_free_vgpr 256
  .amdhsa_next_free_sgpr 82
  .amdhsa_accum_offset 256
  .amdhsa_group_segment_fixed_size 0
  .amdhsa_kernarg_size 80
  .amdhsa_user_sgpr_count 2
  .amdhsa_user_sgpr_kernarg_segment_ptr 1
  .amdhsa_system_sgpr_workgroup_id_x 1
.end_amdhsa_kernel
```
